```python
import torch

def _softmax(x, axis=-1):
    return torch.softmax(x, dim=axis)
def _gelu(x):
    return torch.nn.functional.gelu(x, approximate="tanh")
def _silu(x):
    return torch.nn.functional.silu(x)
def _sigmoid(x):
    return torch.sigmoid(x)
def _layernorm(x, axis=-1, eps=1e-5):
    m = x.mean(dim=axis, keepdim=True)
    v = x.var(dim=axis, keepdim=True, unbiased=False)
    return (x - m) / torch.sqrt(v + eps)
def _scatter_add(tgt, idx, src, axis=0):
    return tgt.clone().index_add_(axis, idx, src)
def _segment_sum(src, seg, n):
    out = torch.zeros((n,) + src.shape[1:], dtype=src.dtype)
    return out.index_add_(0, seg, src)
def _pad(x, pw):
    flat = tuple(v for pair in reversed(pw) for v in pair)
    return torch.nn.functional.pad(x, flat)

kernel_name = 'gated_mix__ssm_conv_s5__glu_gated_reglu__prompt'

def setup_inputs():

    _w = (lambda a: (lambda t: t.to(torch.bfloat16) if t.is_floating_point() else t)(torch.as_tensor(a)))
    def _A_setup():
        B, S, D = 1, 2048, 1024
        P = D
        Lambda_re = -0.5 * (lambda _x: torch.exp(torch.as_tensor(_x)))((lambda *s: torch.randn(*s, dtype=torch.bfloat16) * 0.2)(P))
        Lambda_im = (lambda *s: torch.randn(*s, dtype=torch.bfloat16) * 0.4)(P) * 1.0
        B_re = (lambda *s: torch.randn(*s, dtype=torch.bfloat16) * 0.2)(P, D) * (D ** -0.5)
        B_im = (lambda *s: torch.randn(*s, dtype=torch.bfloat16) * 0.2)(P, D) * (D ** -0.5)
        C_re = (lambda *s: torch.randn(*s, dtype=torch.bfloat16) * 0.2)(D, P) * (P ** -0.5)
        C_im = (lambda *s: torch.randn(*s, dtype=torch.bfloat16) * 0.2)(D, P) * (P ** -0.5)
        log_dt = (lambda *s: torch.randn(*s, dtype=torch.bfloat16) * 0.2)(P) * 0.3 - 2.0
        Dskip = (lambda *s: torch.randn(*s, dtype=torch.bfloat16) * 0.05)(D)
        return {
            "x": _w((lambda *s: torch.randn(*s, dtype=torch.bfloat16) * 0.05)(B, S, D)),
            "Lambda_re": _w(Lambda_re),
            "Lambda_im": _w(Lambda_im),
            "B_re": _w(B_re),
            "B_im": _w(B_im),
            "C_re": _w(C_re),
            "C_im": _w(C_im),
            "log_dt": _w(log_dt),
            "Dskip": _w(Dskip),
        }
    _A_in = _A_setup()

    def _B_setup():
        B, S, D, F = 1, 2048, 1024, 3584
        return {
            "x": _w((lambda *s: torch.randn(*s, dtype=torch.bfloat16) * 0.05)(B, S, D)),
            "W_gate": _w((lambda *s: torch.randn(*s, dtype=torch.bfloat16) * 0.8)(D, F) * (2.0 / D) ** 0.5),
            "W_up": _w((lambda *s: torch.randn(*s, dtype=torch.bfloat16) * 0.8)(D, F) * (2.0 / D) ** 0.5),
            "W_down": _w((lambda *s: torch.randn(*s, dtype=torch.bfloat16) * 0.8)(F, D) * (1.0 / F) ** 0.5),
        }
    _B_in = _B_setup()

    return {
        "A_x": _A_in["x"],
        "A_Lambda_re": _A_in["Lambda_re"],
        "A_Lambda_im": _A_in["Lambda_im"],
        "A_B_re": _A_in["B_re"],
        "A_B_im": _A_in["B_im"],
        "A_C_re": _A_in["C_re"],
        "A_C_im": _A_in["C_im"],
        "A_log_dt": _A_in["log_dt"],
        "A_Dskip": _A_in["Dskip"],
        "B_x": _B_in["x"],
        "B_W_gate": _B_in["W_gate"],
        "B_W_up": _B_in["W_up"],
        "B_W_down": _B_in["W_down"],
        "gate_w": _w((lambda *s: torch.randn(*s, dtype=torch.bfloat16) * 0.05)(1024) * 16.0),
    }

def reference(A_x, A_Lambda_re, A_Lambda_im, A_B_re, A_B_im, A_C_re, A_C_im, A_log_dt, A_Dskip, B_x, B_W_gate, B_W_up, B_W_down, gate_w):
    def _A_ref(x, Lambda_re, Lambda_im, B_re, B_im, C_re, C_im, log_dt, Dskip):
        Bsz, L, H = x.shape
        Lam = Lambda_re + 1j * Lambda_im
        Bmat = B_re + 1j * B_im
        Cmat = C_re + 1j * C_im
        dt = torch.exp(log_dt)
        Lam_bar = torch.exp(dt * Lam)
        B_bar = ((Lam_bar - 1.0) / Lam)[:, None] * Bmat
        Bu = torch.einsum("bld,pd->blp", x + 0j, B_bar)
        h = torch.zeros_like(Bu[:, 0, :])
        hs = []
        for t in range(L):
            h = Lam_bar[None, :] * h + Bu[:, t, :]
            hs.append(h)
        hseq = torch.stack(hs, 1)
        y = 2.0 * torch.einsum("blp,dp->bld", hseq, Cmat).real + x * Dskip[None, None, :]
        return y

    def _B_ref(x, W_gate, W_up, W_down):
        gate = torch.einsum("bsd,df->bsf", x, W_gate)
        up = torch.einsum("bsd,df->bsf", x, W_up)
        gate = gate * (lambda x, dt: x.to(dt))(gate > 0, gate.dtype)
        h = gate * up
        return torch.einsum("bsf,fd->bsd", h, W_down)

    x = A_x
    g = _sigmoid((x * gate_w).sum(-1, keepdims=True))
    a = _A_ref(x, A_Lambda_re, A_Lambda_im, A_B_re, A_B_im, A_C_re, A_C_im, A_log_dt, A_Dskip)
    b = _B_ref(x, B_W_gate, B_W_up, B_W_down)
    return g * a + (1 - g) * b
```

```asm
; @launch grid=(256,1,1) block=(256,1,1) lds=147456
.amdgcn_target "amdgcn-amd-amdhsa--gfx950"
.text
.globl gated_mix__ssm_conv_s5__glu_gated_reglu__prompt_kernel
.p2align 8
.type gated_mix__ssm_conv_s5__glu_gated_reglu__prompt_kernel,@function
gated_mix__ssm_conv_s5__glu_gated_reglu__prompt_kernel:
    s_cmp_ge_u32 s2, 256
    s_cbranch_scc1 k_done
    s_load_dwordx16 s[36:51], s[0:1], 0
    s_load_dwordx16 s[52:67], s[0:1], 64
    s_load_dwordx2 s[68:69], s[0:1], 128
    v_lshrrev_b32 v144, 6, v0
    v_and_b32 v224, 63, v0
    v_readfirstlane_b32 s28, v144
    s_and_b32 s80, s2, 7
    s_lshr_b32 s81, s2, 3
    s_and_b32 s29, s81, 3
    s_and_b32 s82, s80, 1
    s_lshl_b32 s82, s82, 2
    s_add_u32 s29, s29, s82
    s_lshr_b32 s81, s81, 2
    s_lshr_b32 s80, s80, 1
    s_lshl_b32 s80, s80, 3
    s_add_u32 s30, s80, s81
    s_lshr_b32 s100, s30, 3
    s_and_b32 s101, s30, 7
    s_lshl_b32 s80, s29, 3
    s_add_u32 s101, s101, s80
    v_and_b32 v226, 15, v224
    v_lshrrev_b32 v227, 4, v224
    s_lshl_b32 s80, s28, 2
    v_add_u32 v225, s80, v227
    s_lshl_b32 s80, s29, 8
    s_lshl_b32 s81, s28, 6
    s_add_u32 s80, s80, s81
    v_lshrrev_b32 v146, 5, v224
    v_lshlrev_b32 v146, 4, v146
    v_and_b32 v147, 8, v224
    v_add3_u32 v146, v146, v147, s80
    v_bfe_u32 v147, v224, 4, 1
    v_add_u32 v146, v146, v147
    v_lshlrev_b32 v146, 11, v146
    v_and_b32 v147, 7, v224
    v_xor_b32 v147, v147, v227
    v_xor_b32 v148, 4, v147
    v_lshl_add_u32 v147, v147, 4, v146
    v_lshl_add_u32 v148, v148, 4, v146
    v_add_u32 v176, 0x0, v147
    v_add_u32 v177, 0xfc00, v148
    v_add_u32 v178, 0x800, v147
    v_add_u32 v179, 0x10400, v148
    v_add_u32 v180, 0x2000, v147
    v_add_u32 v181, 0x11c00, v148
    v_add_u32 v182, 0x2800, v147
    v_add_u32 v183, 0x12400, v148
    s_and_b32 s81, s28, 1
    s_lshl_b32 s81, s81, 4
    s_lshl_b32 s80, s30, 5
    s_add_u32 s80, s80, s81
    v_lshrrev_b32 v146, 3, v224
    v_add_u32 v146, s80, v146
    v_lshlrev_b32 v146, 11, v146
    v_and_b32 v147, 7, v224
    v_xor_b32 v147, v147, v227
    v_xor_b32 v148, 4, v147
    v_lshl_add_u32 v191, v147, 4, v146
    v_lshl_add_u32 v148, v148, 4, v146
    v_add_u32 v192, 0x3c00, v148
    s_lshl_b32 s80, s28, 13
    s_add_u32 s70, s80, 0x9000
    s_add_u32 s72, s80, 0xa000
    s_mul_i32 s80, s28, 7168
    s_add_u32 s74, s80, 0x2000
    s_add_u32 s76, s80, 0x3000
    s_lshl_b32 s80, s28, 11
    s_add_u32 s78, s80, 0x0
    s_lshl_b32 s80, s28, 13
    s_add_u32 s71, s80, 0x11000
    s_add_u32 s73, s80, 0x12000
    s_mul_i32 s80, s28, 7168
    s_add_u32 s75, s80, 0x1b000
    s_add_u32 s77, s80, 0x1c000
    s_lshl_b32 s80, s28, 11
    s_add_u32 s79, s80, 0x19000
    s_mov_b32 s31, 0
    s_mov_b32 s32, 0
    s_lshr_b32 s80, s2, 3
    s_and_b32 s81, s2, 7
    s_lshl_b32 s82, s80, 5
    s_and_b32 s83, s2, 1
    s_lshl_b32 s83, s83, 10
    s_add_u32 s82, s82, s83
    v_and_b32 v146, 31, v224
    v_add_u32 v146, s82, v146
    s_and_b32 s81, s81, 6
    v_lshlrev_b32 v146, 11, v146
    s_mul_i32 s82, s80, 14336
    s_mul_i32 s83, s81, 896
    s_add_u32 s82, s82, s83
    v_cmp_lt_u32 vcc, 13, v224
    v_mov_b32 v148, 0x1500
    s_nop 0
    v_cndmask_b32 v147, 0, v148, vcc
    v_lshl_add_u32 v147, v224, 7, v147
    v_add_u32 v147, s82, v147
    v_bfrev_b32 v148, -2
    v_cmp_lt_u32 vcc, 27, v224
    s_nop 1
    v_cndmask_b32 v147, v147, v148, vcc
    s_mul_i32 s82, s2, 28672
    v_lshl_add_u32 v149, v224, 7, s82
    v_cmp_lt_u32 vcc, 14, v224
    s_nop 1
    v_cndmask_b32 v149, v149, v148, vcc
    s_cmp_eq_u32 s28, 0
    s_cselect_b64 vcc, -1, 0
    v_cndmask_b32 v147, v147, v146, vcc
    s_mov_b32 s35, 0x70000
    s_cselect_b32 s35, 128, s35
    s_cmp_eq_u32 s28, 3
    s_cselect_b64 vcc, -1, 0
    v_cndmask_b32 v203, v147, v149, vcc
    v_cndmask_b32 v156, v147, v148, vcc
    s_cselect_b32 s89, 0, s35
    s_cselect_b32 s35, 1920, s35
    s_mov_b32 s34, 0
    s_lshl_b32 s81, s81, 7
    s_lshl_b32 s80, s80, 3
    s_add_u32 s80, s80, s81
    s_and_b32 s81, s28, 1
    s_lshl_b32 s82, s81, 2
    s_add_u32 s80, s80, s82
    v_add_u32 v146, s80, v224
    v_lshlrev_b32 v146, 11, v146
    v_cmp_lt_u32 vcc, 3, v224
    s_nop 1
    v_cndmask_b32 v235, v146, v148, vcc
    s_waitcnt lgkmcnt(0)
    s_mov_b32 s4, s36
    s_mov_b32 s5, s37
    s_mov_b32 s6, 0x400000
    s_mov_b32 s7, 0x20000
    s_cmp_lt_u32 s28, 2
    s_cselect_b32 s8, s56, s58
    s_cselect_b32 s9, s57, s59
    s_mov_b32 s10, 0x700000
    s_mov_b32 s11, 0x20000
    s_cselect_b32 s12, s42, s44
    s_cselect_b32 s13, s43, s45
    s_mov_b32 s14, 0x200000
    s_mov_b32 s15, 0x20000
    s_cmp_eq_u32 s28, 0
    s_cselect_b32 s96, s4, s8
    s_cselect_b32 s97, s5, s9
    s_cselect_b32 s98, s6, s10
    s_cmp_eq_u32 s28, 3
    s_cselect_b32 s96, s60, s96
    s_cselect_b32 s97, s61, s97
    s_mov_b32 s99, 0x20000
    s_mov_b32 s34, s89
    s_mov_b32 m0, s78
    s_nop 0
    buffer_load_dwordx4 v191, s[12:15], s31 offen offset:0 lds
    buffer_load_dwordx4 v192, s[12:15], s31 offen offset:1024 lds
    s_mov_b32 m0, s70
    s_nop 0
    buffer_load_dwordx4 v176, s[4:7], s31 offen offset:0 lds
    buffer_load_dwordx4 v177, s[4:7], s31 offen offset:1024 lds
    buffer_load_dwordx4 v178, s[4:7], s31 offen offset:2048 lds
    buffer_load_dwordx4 v179, s[4:7], s31 offen offset:3072 lds
    s_mov_b32 m0, s72
    s_nop 0
    buffer_load_dwordx4 v180, s[4:7], s31 offen offset:0 lds
    buffer_load_dwordx4 v181, s[4:7], s31 offen offset:1024 lds
    buffer_load_dwordx4 v182, s[4:7], s31 offen offset:2048 lds
    buffer_load_dwordx4 v183, s[4:7], s31 offen offset:3072 lds
    buffer_load_dword a255, v156, s[96:99], s34 offen
    s_add_u32 s34, s34, s89
    s_and_b32 s80, s28, 1
    s_mul_i32 s80, s80, 448
    s_and_b32 s81, s30, 1
    s_lshl_b32 s81, s81, 1
    s_mul_i32 s82, s30, 224
    s_movk_i32 s83, 4682
    s_movk_i32 s85, 7168
    v_add_u32 v146, s80, v224
    v_mul_u32_u24 v147, s83, v146
    v_lshrrev_b32 v147, 16, v147
    v_mul_u32_u24 v148, 14, v147
    v_sub_u32 v146, v146, v148
    v_add_u32 v146, s81, v146
    v_subrev_u32 v148, 14, v146
    v_min_u32 v146, v146, v148
    v_and_b32 v148, 0x33, v147
    v_and_b32 v149, 4, v147
    v_lshl_or_b32 v148, v149, 1, v148
    v_and_b32 v149, 8, v147
    v_lshrrev_b32 v149, 1, v149
    v_or_b32 v148, v148, v149
    v_mul_u32_u24 v148, s85, v148
    v_lshl_add_u32 v148, v146, 4, v148
    v_add_u32 v148, s82, v148
    v_subrev_u32 v184, 0x0, v148
    v_add_u32 v146, s80, v224
    v_add_u32 v146, 64, v146
    v_mul_u32_u24 v147, s83, v146
    v_lshrrev_b32 v147, 16, v147
    v_mul_u32_u24 v148, 14, v147
    v_sub_u32 v146, v146, v148
    v_add_u32 v146, s81, v146
    v_subrev_u32 v148, 14, v146
    v_min_u32 v146, v146, v148
    v_and_b32 v148, 0x33, v147
    v_and_b32 v149, 4, v147
    v_lshl_or_b32 v148, v149, 1, v148
    v_and_b32 v149, 8, v147
    v_lshrrev_b32 v149, 1, v149
    v_or_b32 v148, v148, v149
    v_mul_u32_u24 v148, s85, v148
    v_lshl_add_u32 v148, v146, 4, v148
    v_add_u32 v148, s82, v148
    v_subrev_u32 v185, 0x400, v148
    v_add_u32 v146, s80, v224
    v_add_u32 v146, 128, v146
    v_mul_u32_u24 v147, s83, v146
    v_lshrrev_b32 v147, 16, v147
    v_mul_u32_u24 v148, 14, v147
    v_sub_u32 v146, v146, v148
    v_add_u32 v146, s81, v146
    v_subrev_u32 v148, 14, v146
    v_min_u32 v146, v146, v148
    v_and_b32 v148, 0x33, v147
    v_and_b32 v149, 4, v147
    v_lshl_or_b32 v148, v149, 1, v148
    v_and_b32 v149, 8, v147
    v_lshrrev_b32 v149, 1, v149
    v_or_b32 v148, v148, v149
    v_mul_u32_u24 v148, s85, v148
    v_lshl_add_u32 v148, v146, 4, v148
    v_add_u32 v148, s82, v148
    v_subrev_u32 v186, 0x800, v148
    v_add_u32 v146, s80, v224
    v_add_u32 v146, 192, v146
    v_mul_u32_u24 v147, s83, v146
    v_lshrrev_b32 v147, 16, v147
    v_mul_u32_u24 v148, 14, v147
    v_sub_u32 v146, v146, v148
    v_add_u32 v146, s81, v146
    v_subrev_u32 v148, 14, v146
    v_min_u32 v146, v146, v148
    v_and_b32 v148, 0x33, v147
    v_and_b32 v149, 4, v147
    v_lshl_or_b32 v148, v149, 1, v148
    v_and_b32 v149, 8, v147
    v_lshrrev_b32 v149, 1, v149
    v_or_b32 v148, v148, v149
    v_mul_u32_u24 v148, s85, v148
    v_lshl_add_u32 v148, v146, 4, v148
    v_add_u32 v148, s82, v148
    v_subrev_u32 v187, 0xc00, v148
    v_add_u32 v146, s80, v224
    v_add_u32 v146, 256, v146
    v_mul_u32_u24 v147, s83, v146
    v_lshrrev_b32 v147, 16, v147
    v_mul_u32_u24 v148, 14, v147
    v_sub_u32 v146, v146, v148
    v_add_u32 v146, s81, v146
    v_subrev_u32 v148, 14, v146
    v_min_u32 v146, v146, v148
    v_and_b32 v148, 0x33, v147
    v_and_b32 v149, 4, v147
    v_lshl_or_b32 v148, v149, 1, v148
    v_and_b32 v149, 8, v147
    v_lshrrev_b32 v149, 1, v149
    v_or_b32 v148, v148, v149
    v_mul_u32_u24 v148, s85, v148
    v_lshl_add_u32 v148, v146, 4, v148
    v_add_u32 v148, s82, v148
    v_subrev_u32 v188, 0x0, v148
    v_add_u32 v146, s80, v224
    v_add_u32 v146, 320, v146
    v_mul_u32_u24 v147, s83, v146
    v_lshrrev_b32 v147, 16, v147
    v_mul_u32_u24 v148, 14, v147
    v_sub_u32 v146, v146, v148
    v_add_u32 v146, s81, v146
    v_subrev_u32 v148, 14, v146
    v_min_u32 v146, v146, v148
    v_and_b32 v148, 0x33, v147
    v_and_b32 v149, 4, v147
    v_lshl_or_b32 v148, v149, 1, v148
    v_and_b32 v149, 8, v147
    v_lshrrev_b32 v149, 1, v149
    v_or_b32 v148, v148, v149
    v_mul_u32_u24 v148, s85, v148
    v_lshl_add_u32 v148, v146, 4, v148
    v_add_u32 v148, s82, v148
    v_subrev_u32 v189, 0x400, v148
    v_add_u32 v146, s80, v224
    v_add_u32 v146, 384, v146
    v_mul_u32_u24 v147, s83, v146
    v_lshrrev_b32 v147, 16, v147
    v_mul_u32_u24 v148, 14, v147
    v_sub_u32 v146, v146, v148
    v_add_u32 v146, s81, v146
    v_subrev_u32 v148, 14, v146
    v_min_u32 v146, v146, v148
    v_and_b32 v148, 0x33, v147
    v_and_b32 v149, 4, v147
    v_lshl_or_b32 v148, v149, 1, v148
    v_and_b32 v149, 8, v147
    v_lshrrev_b32 v149, 1, v149
    v_or_b32 v148, v148, v149
    v_mul_u32_u24 v148, s85, v148
    v_lshl_add_u32 v148, v146, 4, v148
    v_add_u32 v148, s82, v148
    v_subrev_u32 v190, 0x800, v148
    s_mov_b32 m0, s74
    s_nop 0
    buffer_load_dwordx4 v184, s[8:11], s32 offen offset:0 lds
    buffer_load_dwordx4 v185, s[8:11], s32 offen offset:1024 lds
    buffer_load_dwordx4 v186, s[8:11], s32 offen offset:2048 lds
    buffer_load_dwordx4 v187, s[8:11], s32 offen offset:3072 lds
    s_mov_b32 m0, s76
    s_nop 0
    buffer_load_dwordx4 v188, s[8:11], s32 offen offset:0 lds
    buffer_load_dwordx4 v189, s[8:11], s32 offen offset:1024 lds
    buffer_load_dwordx4 v190, s[8:11], s32 offen offset:2048 lds
    s_add_u32 s31, s31, 128
    s_add_u32 s32, s32, 0x70000
    v_bfrev_b32 v148, -2
    buffer_load_dword a255, v235, s[12:15], 0 offen offset:128
    s_mov_b32 s3, 256
    s_mov_b32 s16, s68
    s_mov_b32 s17, s69
    s_mov_b32 s18, 0x4000000
    s_mov_b32 s19, 0x20000
    s_mov_b32 s20, s66
    s_mov_b32 s21, s67
    s_mov_b32 s22, 0x100
    s_mov_b32 s23, 0x20000
    s_lshl_b32 s80, s29, 2
    s_add_u32 s80, s80, s28
    s_mul_i32 s80, s80, 640
    s_lshl_b32 s81, s30, 2
    s_add_u32 s80, s80, s81
    s_add_u32 s80, s80, 0x1a00000
    v_lshl_add_u32 v248, v224, 7, s80
    s_lshl_b32 s80, s101, 7
    s_lshl_b32 s81, s28, 4
    s_add_u32 s80, s80, s81
    s_lshl_b32 s81, s100, 2
    s_add_u32 s80, s80, s81
    s_add_u32 s80, s80, 0x1a08000
    v_writelane_b32 v248, s80, 5
    s_lshl_b32 s80, s30, 7
    s_lshl_b32 s81, s29, 2
    s_add_u32 s80, s80, s81
    s_add_u32 s80, s80, 0x1a0c000
    v_writelane_b32 v248, s80, 6
    v_mov_b32 v236, 0
    v_mov_b32 v237, 0
    v_mov_b32 v238, 0
    v_mov_b32 v239, 0
    s_mov_b64 exec, 0x7f
    buffer_store_dword v236, v248, s[16:19], 0 offen sc1
    s_mov_b64 exec, -1
    s_lshl_b32 s80, s30, 6
    v_lshl_add_u32 v228, v226, 1, s80
    v_lshlrev_b32 v229, 5, v224
    s_lshl_b32 s80, s2, 3
    s_lshl_b32 s81, s28, 1
    s_add_u32 s84, s80, s81
    s_lshl_b32 s86, s84, 11
    s_and_b32 s81, s28, 1
    s_lshl_b32 s80, s2, 13
    s_lshl_b32 s81, s81, 12
    s_add_u32 s80, s80, s81
    v_lshl_add_u32 v146, v224, 7, s80
    v_cmp_lt_u32 vcc, 31, v224
    s_nop 1
    v_cndmask_b32 v230, v146, v148, vcc
    v_lshrrev_b32 v146, 1, v226
    v_xor_b32 v146, v146, v227
    v_lshlrev_b32 v147, 7, v226
    v_lshl_add_u32 v193, v146, 4, v147
    v_xor_b32 v195, 64, v193
    v_add_u32 v194, 0x19000, v193
    v_add_u32 v196, 0x19000, v195
    s_lshl_b32 s80, s28, 13
    s_add_u32 s80, s80, 0x9000
    v_add_u32 v197, s80, v193
    v_add_u32 v198, 0x8000, v197
    v_add_u32 v199, s80, v195
    v_add_u32 v200, 0x8000, v199
    v_lshrrev_b32 v146, 5, v224
    v_lshlrev_b32 v146, 4, v146
    v_bfe_u32 v147, v224, 2, 3
    v_add_u32 v146, v146, v147
    v_mul_u32_u24 v146, 0xe0, v146
    v_and_b32 v147, 3, v224
    v_lshl_add_u32 v201, v147, 3, v146
    v_add_u32 v202, 0x19000, v201
    v_lshlrev_b32 v146, 4, v0
    v_add_u32 v146, 0x22000, v146
    ds_write_b128 v146, v[236:239]
    s_waitcnt vmcnt(2) lgkmcnt(0)
    s_barrier
    ds_read_b128 a[144:147], v197 offset:0
    ds_read_b128 a[148:151], v197 offset:2048
    s_mov_b32 m0, s75
    s_nop 0
    ds_read_b128 a[152:155], v197 offset:4096
    buffer_load_dwordx4 v184, s[8:11], s32 offen offset:0 lds
    ds_read_b128 a[156:159], v197 offset:6144
    ds_read_b128 a[176:179], v193 offset:0
    ds_read_b128 a[180:183], v193 offset:4096
    ds_read_b128 a[184:187], v193 offset:2048
    buffer_load_dwordx4 v185, s[8:11], s32 offen offset:1024 lds
    ds_read_b128 a[188:191], v193 offset:6144
    ds_read_b64_tr_b16 a[192:193], v201 offset:8192
    ds_read_b64_tr_b16 a[194:195], v201 offset:9984
    ds_read_b64_tr_b16 a[196:197], v201 offset:22528
    buffer_load_dwordx4 v186, s[8:11], s32 offen offset:2048 lds
    ds_read_b64_tr_b16 a[198:199], v201 offset:24320
    buffer_load_dwordx4 v187, s[8:11], s32 offen offset:3072 lds
    ds_read_b64_tr_b16 a[200:201], v201 offset:8224
    s_waitcnt lgkmcnt(8)
    v_mfma_f32_16x16x32_bf16 v[0:3], a[144:147], a[176:179], 0
    v_mfma_f32_16x16x32_bf16 v[4:7], a[148:151], a[176:179], 0
    ds_read_b64_tr_b16 a[202:203], v201 offset:10016
    s_mov_b32 m0, s77
    v_mfma_f32_16x16x32_bf16 v[8:11], a[152:155], a[176:179], 0
    buffer_load_dwordx4 v188, s[8:11], s32 offen offset:0 lds
    v_mfma_f32_16x16x32_bf16 v[12:15], a[156:159], a[176:179], 0
    ds_read_b64_tr_b16 a[204:205], v201 offset:22560
    s_waitcnt lgkmcnt(9)
    v_mfma_f32_16x16x32_bf16 v[28:31], a[156:159], a[180:183], 0
    v_mfma_f32_16x16x32_bf16 v[24:27], a[152:155], a[180:183], 0
    ds_read_b64_tr_b16 a[206:207], v201 offset:24352
    v_mfma_f32_16x16x32_bf16 v[20:23], a[148:151], a[180:183], 0
    buffer_load_dwordx4 v189, s[8:11], s32 offen offset:1024 lds
    v_mfma_f32_16x16x32_bf16 v[16:19], a[144:147], a[180:183], 0
    ds_read_b64_tr_b16 a[176:177], v201 offset:8256
    s_waitcnt lgkmcnt(10)
    v_mfma_f32_16x16x32_bf16 v[32:35], a[144:147], a[184:187], 0
    ds_read_b128 a[160:163], v199 offset:0
    v_mfma_f32_16x16x32_bf16 v[36:39], a[148:151], a[184:187], 0
    ds_read_b64_tr_b16 a[178:179], v201 offset:10048
    v_mfma_f32_16x16x32_bf16 v[40:43], a[152:155], a[184:187], 0
    buffer_load_dwordx4 v190, s[8:11], s32 offen offset:2048 lds
    v_mfma_f32_16x16x32_bf16 v[44:47], a[156:159], a[184:187], 0
    ds_read_b64_tr_b16 a[180:181], v201 offset:22592
    s_waitcnt lgkmcnt(12)
    v_mfma_f32_16x16x32_bf16 v[60:63], a[156:159], a[188:191], 0
    v_mfma_f32_16x16x32_bf16 v[56:59], a[152:155], a[188:191], 0
    ds_read_b64_tr_b16 a[182:183], v201 offset:24384
    v_mfma_f32_16x16x32_bf16 v[52:55], a[148:151], a[188:191], 0
    s_mov_b32 m0, s79
    v_mfma_f32_16x16x32_bf16 v[48:51], a[144:147], a[188:191], 0
    ds_read_b64_tr_b16 a[184:185], v201 offset:8288
    buffer_load_dwordx4 v191, s[12:15], s31 offen offset:0 lds
    s_waitcnt lgkmcnt(12)
    v_mfma_f32_16x16x32_bf16 v[64:67], a[192:195], a[144:147], 0
    ds_read_b128 a[164:167], v199 offset:2048
    v_mfma_f32_16x16x32_bf16 v[68:71], a[192:195], a[148:151], 0
    ds_read_b64_tr_b16 a[186:187], v201 offset:10080
    v_mfma_f32_16x16x32_bf16 v[72:75], a[192:195], a[152:155], 0
    v_mfma_f32_16x16x32_bf16 v[76:79], a[192:195], a[156:159], 0
    ds_read_b64_tr_b16 a[188:189], v201 offset:22624
    buffer_load_dwordx4 v192, s[12:15], s31 offen offset:1024 lds
    s_waitcnt lgkmcnt(13)
    v_mfma_f32_16x16x32_bf16 a[12:15], a[196:199], a[156:159], 0
    v_mfma_f32_16x16x32_bf16 a[8:11], a[196:199], a[152:155], 0
    ds_read_b64_tr_b16 a[190:191], v201 offset:24416
    v_mfma_f32_16x16x32_bf16 a[4:7], a[196:199], a[148:151], 0
    v_mfma_f32_16x16x32_bf16 a[0:3], a[196:199], a[144:147], 0
    ds_read_b64_tr_b16 a[192:193], v201 offset:8320
    s_mov_b32 m0, s71
    s_waitcnt lgkmcnt(13)
    v_mfma_f32_16x16x32_bf16 v[80:83], a[200:203], a[144:147], 0
    ds_read_b128 a[168:171], v199 offset:4096
    buffer_load_dwordx4 v176, s[4:7], s31 offen offset:0 lds
    v_mfma_f32_16x16x32_bf16 v[84:87], a[200:203], a[148:151], 0
    ds_read_b64_tr_b16 a[194:195], v201 offset:10112
    v_mfma_f32_16x16x32_bf16 v[88:91], a[200:203], a[152:155], 0
    v_mfma_f32_16x16x32_bf16 v[92:95], a[200:203], a[156:159], 0
    ds_read_b64_tr_b16 a[196:197], v201 offset:22656
    s_waitcnt lgkmcnt(14)
    v_mfma_f32_16x16x32_bf16 a[28:31], a[204:207], a[156:159], 0
    buffer_load_dwordx4 v177, s[4:7], s31 offen offset:1024 lds
    v_mfma_f32_16x16x32_bf16 a[24:27], a[204:207], a[152:155], 0
    ds_read_b64_tr_b16 a[198:199], v201 offset:24448
    v_mfma_f32_16x16x32_bf16 a[20:23], a[204:207], a[148:151], 0
    v_mfma_f32_16x16x32_bf16 a[16:19], a[204:207], a[144:147], 0
    ds_read_b64_tr_b16 a[200:201], v201 offset:8352
    s_waitcnt lgkmcnt(13)
    v_mfma_f32_16x16x32_bf16 v[96:99], a[176:179], a[144:147], 0
    ds_read_b128 a[172:175], v199 offset:6144
    buffer_load_dwordx4 v178, s[4:7], s31 offen offset:2048 lds
    v_mfma_f32_16x16x32_bf16 v[100:103], a[176:179], a[148:151], 0
    ds_read_b64_tr_b16 a[202:203], v201 offset:10144
    v_mfma_f32_16x16x32_bf16 v[104:107], a[176:179], a[152:155], 0
    v_mfma_f32_16x16x32_bf16 v[108:111], a[176:179], a[156:159], 0
    ds_read_b64_tr_b16 a[204:205], v201 offset:22688
    s_waitcnt lgkmcnt(14)
    v_mfma_f32_16x16x32_bf16 a[44:47], a[180:183], a[156:159], 0
    buffer_load_dwordx4 v179, s[4:7], s31 offen offset:3072 lds
    v_mfma_f32_16x16x32_bf16 a[40:43], a[180:183], a[152:155], 0
    ds_read_b64_tr_b16 a[206:207], v201 offset:24480
    v_mfma_f32_16x16x32_bf16 a[36:39], a[180:183], a[148:151], 0
    v_mfma_f32_16x16x32_bf16 a[32:35], a[180:183], a[144:147], 0
    ds_read_b64_tr_b16 a[176:177], v201 offset:8384
    s_waitcnt lgkmcnt(13)
    v_mfma_f32_16x16x32_bf16 v[112:115], a[184:187], a[144:147], 0
    s_mov_b32 m0, s73
    v_mfma_f32_16x16x32_bf16 v[116:119], a[184:187], a[148:151], 0
    ds_read_b64_tr_b16 a[178:179], v201 offset:10176
    buffer_load_dwordx4 v180, s[4:7], s31 offen offset:0 lds
    v_mfma_f32_16x16x32_bf16 v[120:123], a[184:187], a[152:155], 0
    v_mfma_f32_16x16x32_bf16 v[124:127], a[184:187], a[156:159], 0
    ds_read_b64_tr_b16 a[180:181], v201 offset:22720
    s_waitcnt lgkmcnt(13)
    v_mfma_f32_16x16x32_bf16 a[60:63], a[188:191], a[156:159], 0
    v_mfma_f32_16x16x32_bf16 a[56:59], a[188:191], a[152:155], 0
    ds_read_b64_tr_b16 a[182:183], v201 offset:24512
    buffer_load_dwordx4 v181, s[4:7], s31 offen offset:1024 lds
    v_mfma_f32_16x16x32_bf16 a[52:55], a[188:191], a[148:151], 0
    v_mfma_f32_16x16x32_bf16 a[48:51], a[188:191], a[144:147], 0
    ds_read_b128 a[184:187], v195 offset:0
    s_waitcnt lgkmcnt(12)
    v_mfma_f32_16x16x32_bf16 v[128:131], a[192:195], a[144:147], 0
    v_mfma_f32_16x16x32_bf16 v[132:135], a[192:195], a[148:151], 0
    buffer_load_dwordx4 v182, s[4:7], s31 offen offset:2048 lds
    v_mfma_f32_16x16x32_bf16 v[136:139], a[192:195], a[152:155], 0
    v_mfma_f32_16x16x32_bf16 v[140:143], a[192:195], a[156:159], 0
    ds_read_b128 a[188:191], v195 offset:4096
    s_waitcnt lgkmcnt(11)
    v_mfma_f32_16x16x32_bf16 a[76:79], a[196:199], a[156:159], 0
    v_mfma_f32_16x16x32_bf16 a[72:75], a[196:199], a[152:155], 0
    buffer_load_dwordx4 v183, s[4:7], s31 offen offset:3072 lds
    v_mfma_f32_16x16x32_bf16 a[68:71], a[196:199], a[148:151], 0
    v_mfma_f32_16x16x32_bf16 a[64:67], a[196:199], a[144:147], 0
    ds_read_b128 a[192:195], v195 offset:2048
    s_waitcnt lgkmcnt(9)
    v_mfma_f32_16x16x32_bf16 a[112:115], a[200:203], a[144:147], 0
    v_mfma_f32_16x16x32_bf16 a[116:119], a[200:203], a[148:151], 0
    s_add_u32 s31, s31, 128
    s_add_u32 s32, s32, 0x70000
    buffer_load_dword a255, v203, s[96:99], s34 offen
    v_mfma_f32_16x16x32_bf16 a[120:123], a[200:203], a[152:155], 0
    v_mfma_f32_16x16x32_bf16 a[124:127], a[200:203], a[156:159], 0
    ds_read_b128 a[196:199], v195 offset:6144
    s_waitcnt lgkmcnt(8)
    v_mfma_f32_16x16x32_bf16 a[92:95], a[204:207], a[156:159], 0
    v_mfma_f32_16x16x32_bf16 a[88:91], a[204:207], a[152:155], 0
    s_add_u32 s34, s34, s35
    buffer_load_dword a255, v235, s[12:15], s3 offen
    v_mfma_f32_16x16x32_bf16 a[84:87], a[204:207], a[148:151], 0
    v_mfma_f32_16x16x32_bf16 a[80:83], a[204:207], a[144:147], 0
    ds_read_b64_tr_b16 a[200:201], v201 offset:15360
    s_waitcnt lgkmcnt(7)
    v_mfma_f32_16x16x32_bf16 a[128:131], a[176:179], a[144:147], 0
    v_mfma_f32_16x16x32_bf16 a[132:135], a[176:179], a[148:151], 0
    ds_read_b64_tr_b16 a[202:203], v201 offset:17152
    s_add_u32 s3, s3, 128
    v_mfma_f32_16x16x32_bf16 a[136:139], a[176:179], a[152:155], 0
    v_mfma_f32_16x16x32_bf16 a[140:143], a[176:179], a[156:159], 0
    ds_read_b64_tr_b16 a[204:205], v201 offset:29696
    s_waitcnt lgkmcnt(7)
    v_mfma_f32_16x16x32_bf16 a[108:111], a[180:183], a[156:159], 0
    v_mfma_f32_16x16x32_bf16 a[104:107], a[180:183], a[152:155], 0
    ds_read_b64_tr_b16 a[206:207], v201 offset:31488
    v_mfma_f32_16x16x32_bf16 a[100:103], a[180:183], a[148:151], 0
    v_mfma_f32_16x16x32_bf16 a[96:99], a[180:183], a[144:147], 0
    ds_read_b64_tr_b16 a[176:177], v201 offset:15392
    s_waitcnt lgkmcnt(8)
    v_mfma_f32_16x16x32_bf16 v[0:3], a[160:163], a[184:187], v[0:3]
    v_mfma_f32_16x16x32_bf16 v[4:7], a[164:167], a[184:187], v[4:7]
    ds_read_b64_tr_b16 a[178:179], v201 offset:17184
    v_mfma_f32_16x16x32_bf16 v[8:11], a[168:171], a[184:187], v[8:11]
    v_mfma_f32_16x16x32_bf16 v[12:15], a[172:175], a[184:187], v[12:15]
    ds_read_b64_tr_b16 a[180:181], v201 offset:29728
    s_mov_b32 s24, s62
    s_mov_b32 s25, s63
    s_mov_b32 s26, 0x800
    s_mov_b32 s27, 0x20000
    s_waitcnt lgkmcnt(9)
    v_mfma_f32_16x16x32_bf16 v[28:31], a[172:175], a[188:191], v[28:31]
    buffer_load_dwordx4 v[160:163], v229, s[24:27], 0 offen
    v_mfma_f32_16x16x32_bf16 v[24:27], a[168:171], a[188:191], v[24:27]
    ds_read_b64_tr_b16 a[182:183], v201 offset:31520
    buffer_load_dwordx4 v[164:167], v229, s[24:27], 0 offen offset:16
    v_mfma_f32_16x16x32_bf16 v[20:23], a[164:167], a[188:191], v[20:23]
    buffer_load_dwordx4 v[144:147], v229, s[4:7], s86 offen offset:0
    v_mfma_f32_16x16x32_bf16 v[16:19], a[160:163], a[188:191], v[16:19]
    ds_read_b64_tr_b16 a[184:185], v201 offset:15424
    buffer_load_dwordx4 v[148:151], v229, s[4:7], s86 offen offset:16
    s_waitcnt lgkmcnt(10)
    v_mfma_f32_16x16x32_bf16 v[32:35], a[160:163], a[192:195], v[32:35]
    buffer_load_dwordx4 v[152:155], v229, s[4:7], s86 offen offset:2048
    v_mfma_f32_16x16x32_bf16 v[36:39], a[164:167], a[192:195], v[36:39]
    ds_read_b64_tr_b16 a[186:187], v201 offset:17216
    buffer_load_dwordx4 v[156:159], v229, s[4:7], s86 offen offset:2064
    v_mfma_f32_16x16x32_bf16 v[40:43], a[168:171], a[192:195], v[40:43]
    s_mov_b32 s24, s38
    s_mov_b32 s25, s39
    s_mov_b32 s26, 0x800
    s_mov_b32 s27, 0x20000
    v_mfma_f32_16x16x32_bf16 v[44:47], a[172:175], a[192:195], v[44:47]
    ds_read_b64_tr_b16 a[188:189], v201 offset:29760
    buffer_load_ushort v250, v228, s[24:27], 0 offen
    s_waitcnt lgkmcnt(11)
    v_mfma_f32_16x16x32_bf16 v[60:63], a[172:175], a[196:199], v[60:63]
    buffer_load_ushort v251, v228, s[24:27], 0 offen offset:32
    v_mfma_f32_16x16x32_bf16 v[56:59], a[168:171], a[196:199], v[56:59]
    ds_read_b64_tr_b16 a[190:191], v201 offset:31552
    s_mov_b32 s24, s40
    s_mov_b32 s25, s41
    s_mov_b32 s26, 0x800
    s_mov_b32 s27, 0x20000
    v_mfma_f32_16x16x32_bf16 v[52:55], a[164:167], a[196:199], v[52:55]
    buffer_load_ushort v252, v228, s[24:27], 0 offen
    v_mfma_f32_16x16x32_bf16 v[48:51], a[160:163], a[196:199], v[48:51]
    ds_read_b64_tr_b16 a[192:193], v201 offset:15456
    buffer_load_ushort v253, v228, s[24:27], 0 offen offset:32
    s_waitcnt lgkmcnt(11)
    v_mfma_f32_16x16x32_bf16 v[64:67], a[200:203], a[160:163], v[64:67]
    s_mov_b32 s24, s50
    s_mov_b32 s25, s51
    s_mov_b32 s26, 0x800
    s_mov_b32 s27, 0x20000
    v_mfma_f32_16x16x32_bf16 v[68:71], a[200:203], a[164:167], v[68:71]
    ds_read_b64_tr_b16 a[194:195], v201 offset:17248
    buffer_load_ushort v254, v228, s[24:27], 0 offen
    v_mfma_f32_16x16x32_bf16 v[72:75], a[200:203], a[168:171], v[72:75]
    buffer_load_ushort v255, v228, s[24:27], 0 offen offset:32
    v_mfma_f32_16x16x32_bf16 v[76:79], a[200:203], a[172:175], v[76:79]
    ds_read_b64_tr_b16 a[196:197], v201 offset:29792
    s_cmp_lt_u32 s28, 2
    s_cselect_b32 s24, s46, s48
    s_cselect_b32 s25, s47, s49
    s_mov_b32 s26, 0x200000
    s_waitcnt lgkmcnt(11)
    v_mfma_f32_16x16x32_bf16 a[12:15], a[204:207], a[172:175], a[12:15]
    s_lshr_b32 s80, s2, 3
    s_lshl_b32 s80, s80, 2
    s_add_u32 s80, s80, s28
    v_mfma_f32_16x16x32_bf16 a[8:11], a[204:207], a[168:171], a[8:11]
    ds_read_b64_tr_b16 a[198:199], v201 offset:31584
    s_mul_i32 s80, s80, 512
    v_min_u32 v232, 3, v224
    v_mfma_f32_16x16x32_bf16 a[4:7], a[204:207], a[164:167], a[4:7]
    v_lshl_add_u32 v232, v232, 7, s80
    v_min_u32 v232, 0xbd80, v232
    s_getpc_b64 s[94:95]
k_cp0:
    global_load_dword v232, v232, s[94:95]
    v_mfma_f32_16x16x32_bf16 a[0:3], a[204:207], a[160:163], a[0:3]
    ds_read_b64_tr_b16 a[200:201], v201 offset:15488
    v_mov_b32 v240, -1
    v_mov_b32 v241, -1
    s_waitcnt lgkmcnt(11)
    v_mfma_f32_16x16x32_bf16 v[80:83], a[176:179], a[160:163], v[80:83]
    v_mov_b32 v242, -1
    v_mov_b32 v243, -1
    s_lshl_b32 s80, s30, 3
    v_mfma_f32_16x16x32_bf16 v[84:87], a[176:179], a[164:167], v[84:87]
    ds_read_b64_tr_b16 a[202:203], v201 offset:17280
    s_add_u32 s80, s80, s29
    s_lshl_b32 s80, s80, 8
    v_mfma_f32_16x16x32_bf16 v[88:91], a[176:179], a[168:171], v[88:91]
    s_add_u32 s80, s80, 0x1900000
    v_lshlrev_b32 v234, 4, v226
    buffer_store_dwordx4 v[240:243], v234, s[16:19], s80 offen sc1
    v_mfma_f32_16x16x32_bf16 v[92:95], a[176:179], a[172:175], v[92:95]
    ds_read_b64_tr_b16 a[204:205], v201 offset:29824
    s_waitcnt lgkmcnt(11)
    v_mfma_f32_16x16x32_bf16 a[28:31], a[180:183], a[172:175], a[28:31]
    v_mfma_f32_16x16x32_bf16 a[24:27], a[180:183], a[168:171], a[24:27]
    ds_read_b64_tr_b16 a[206:207], v201 offset:31616
    v_mfma_f32_16x16x32_bf16 a[20:23], a[180:183], a[164:167], a[20:23]
    v_mfma_f32_16x16x32_bf16 a[16:19], a[180:183], a[160:163], a[16:19]
    ds_read_b64_tr_b16 a[176:177], v201 offset:15520
    s_waitcnt lgkmcnt(11)
    v_mfma_f32_16x16x32_bf16 v[96:99], a[184:187], a[160:163], v[96:99]
    v_mfma_f32_16x16x32_bf16 v[100:103], a[184:187], a[164:167], v[100:103]
    ds_read_b64_tr_b16 a[178:179], v201 offset:17312
    v_mfma_f32_16x16x32_bf16 v[104:107], a[184:187], a[168:171], v[104:107]
    v_mfma_f32_16x16x32_bf16 v[108:111], a[184:187], a[172:175], v[108:111]
    ds_read_b64_tr_b16 a[180:181], v201 offset:29856
    s_waitcnt lgkmcnt(11)
    v_mfma_f32_16x16x32_bf16 a[44:47], a[188:191], a[172:175], a[44:47]
    v_mfma_f32_16x16x32_bf16 a[40:43], a[188:191], a[168:171], a[40:43]
    ds_read_b64_tr_b16 a[182:183], v201 offset:31648
    v_mfma_f32_16x16x32_bf16 a[36:39], a[188:191], a[164:167], a[36:39]
    v_mfma_f32_16x16x32_bf16 a[32:35], a[188:191], a[160:163], a[32:35]
    ds_read_b64_tr_b16 a[184:185], v201 offset:15552
    s_waitcnt lgkmcnt(11)
    v_mfma_f32_16x16x32_bf16 v[112:115], a[192:195], a[160:163], v[112:115]
    v_mfma_f32_16x16x32_bf16 v[116:119], a[192:195], a[164:167], v[116:119]
    ds_read_b64_tr_b16 a[186:187], v201 offset:17344
    v_mfma_f32_16x16x32_bf16 v[120:123], a[192:195], a[168:171], v[120:123]
    v_mfma_f32_16x16x32_bf16 v[124:127], a[192:195], a[172:175], v[124:127]
    ds_read_b64_tr_b16 a[188:189], v201 offset:29888
    s_waitcnt lgkmcnt(11)
    v_mfma_f32_16x16x32_bf16 a[60:63], a[196:199], a[172:175], a[60:63]
    v_mfma_f32_16x16x32_bf16 a[56:59], a[196:199], a[168:171], a[56:59]
    ds_read_b64_tr_b16 a[190:191], v201 offset:31680
    v_mfma_f32_16x16x32_bf16 a[52:55], a[196:199], a[164:167], a[52:55]
    v_mfma_f32_16x16x32_bf16 a[48:51], a[196:199], a[160:163], a[48:51]
    s_waitcnt lgkmcnt(10)
    v_mfma_f32_16x16x32_bf16 v[128:131], a[200:203], a[160:163], v[128:131]
    v_mfma_f32_16x16x32_bf16 v[132:135], a[200:203], a[164:167], v[132:135]
    v_mfma_f32_16x16x32_bf16 v[136:139], a[200:203], a[168:171], v[136:139]
    v_mfma_f32_16x16x32_bf16 v[140:143], a[200:203], a[172:175], v[140:143]
    s_waitcnt lgkmcnt(8)
    v_mfma_f32_16x16x32_bf16 a[76:79], a[204:207], a[172:175], a[76:79]
    v_mfma_f32_16x16x32_bf16 a[72:75], a[204:207], a[168:171], a[72:75]
    v_mfma_f32_16x16x32_bf16 a[68:71], a[204:207], a[164:167], a[68:71]
    v_mfma_f32_16x16x32_bf16 a[64:67], a[204:207], a[160:163], a[64:67]
    s_waitcnt vmcnt(16) lgkmcnt(0)
    s_barrier
    ds_read_b128 a[144:147], v198 offset:0
    v_mfma_f32_16x16x32_bf16 a[112:115], a[176:179], a[160:163], a[112:115]
    ds_read_b128 a[148:151], v198 offset:2048
    s_mov_b32 m0, s74
    v_mfma_f32_16x16x32_bf16 a[116:119], a[176:179], a[164:167], a[116:119]
    ds_read_b128 a[152:155], v198 offset:4096
    buffer_load_dwordx4 v184, s[8:11], s32 offen offset:0 lds
    v_mfma_f32_16x16x32_bf16 a[120:123], a[176:179], a[168:171], a[120:123]
    ds_read_b128 a[156:159], v198 offset:6144
    v_mfma_f32_16x16x32_bf16 a[124:127], a[176:179], a[172:175], a[124:127]
    ds_read_b128 a[192:195], v194 offset:0
    v_mfma_f32_16x16x32_bf16 a[92:95], a[180:183], a[172:175], a[92:95]
    ds_read_b128 a[196:199], v194 offset:4096
    v_mfma_f32_16x16x32_bf16 a[88:91], a[180:183], a[168:171], a[88:91]
    ds_read_b128 a[200:203], v194 offset:2048
    buffer_load_dwordx4 v185, s[8:11], s32 offen offset:1024 lds
    v_mfma_f32_16x16x32_bf16 a[84:87], a[180:183], a[164:167], a[84:87]
    ds_read_b128 a[204:207], v194 offset:6144
    v_mfma_f32_16x16x32_bf16 a[80:83], a[180:183], a[160:163], a[80:83]
    ds_read_b64_tr_b16 a[176:177], v202 offset:8192
    v_mfma_f32_16x16x32_bf16 a[128:131], a[184:187], a[160:163], a[128:131]
    ds_read_b64_tr_b16 a[178:179], v202 offset:9984
    v_mfma_f32_16x16x32_bf16 a[132:135], a[184:187], a[164:167], a[132:135]
    ds_read_b64_tr_b16 a[180:181], v202 offset:22528
    buffer_load_dwordx4 v186, s[8:11], s32 offen offset:2048 lds
    v_mfma_f32_16x16x32_bf16 a[136:139], a[184:187], a[168:171], a[136:139]
    ds_read_b64_tr_b16 a[182:183], v202 offset:24320
    v_mfma_f32_16x16x32_bf16 a[140:143], a[184:187], a[172:175], a[140:143]
    v_mfma_f32_16x16x32_bf16 a[108:111], a[188:191], a[172:175], a[108:111]
    v_mfma_f32_16x16x32_bf16 a[104:107], a[188:191], a[168:171], a[104:107]
    buffer_load_dwordx4 v187, s[8:11], s32 offen offset:3072 lds
    v_mfma_f32_16x16x32_bf16 a[100:103], a[188:191], a[164:167], a[100:103]
    v_mfma_f32_16x16x32_bf16 a[96:99], a[188:191], a[160:163], a[96:99]
    ds_read_b64_tr_b16 a[184:185], v202 offset:8224
    s_waitcnt lgkmcnt(8)
    v_mfma_f32_16x16x32_bf16 v[0:3], a[144:147], a[192:195], v[0:3]
    v_mfma_f32_16x16x32_bf16 v[4:7], a[148:151], a[192:195], v[4:7]
    ds_read_b64_tr_b16 a[186:187], v202 offset:10016
    s_mov_b32 m0, s76
    v_mfma_f32_16x16x32_bf16 v[8:11], a[152:155], a[192:195], v[8:11]
    buffer_load_dwordx4 v188, s[8:11], s32 offen offset:0 lds
    v_mfma_f32_16x16x32_bf16 v[12:15], a[156:159], a[192:195], v[12:15]
    ds_read_b64_tr_b16 a[188:189], v202 offset:22560
    s_waitcnt lgkmcnt(9)
    v_mfma_f32_16x16x32_bf16 v[28:31], a[156:159], a[196:199], v[28:31]
    v_mfma_f32_16x16x32_bf16 v[24:27], a[152:155], a[196:199], v[24:27]
    ds_read_b64_tr_b16 a[190:191], v202 offset:24352
    v_mfma_f32_16x16x32_bf16 v[20:23], a[148:151], a[196:199], v[20:23]
    buffer_load_dwordx4 v189, s[8:11], s32 offen offset:1024 lds
    v_mfma_f32_16x16x32_bf16 v[16:19], a[144:147], a[196:199], v[16:19]
    ds_read_b64_tr_b16 a[192:193], v202 offset:8256
    s_waitcnt vmcnt(14)
    v_mov_b32 v174, 0
    s_waitcnt lgkmcnt(10)
    v_mfma_f32_16x16x32_bf16 v[32:35], a[144:147], a[200:203], v[32:35]
    ds_read_b128 a[160:163], v200 offset:0
    v_mov_b32 v175, 0
    v_lshlrev_b32 v168, 16, v160
    v_mfma_f32_16x16x32_bf16 v[36:39], a[148:151], a[200:203], v[36:39]
    ds_read_b64_tr_b16 a[194:195], v202 offset:10048
    v_and_b32 v169, 0xffff0000, v160
    v_lshlrev_b32 v170, 16, v144
    v_mfma_f32_16x16x32_bf16 v[40:43], a[152:155], a[200:203], v[40:43]
    buffer_load_dwordx4 v190, s[8:11], s32 offen offset:2048 lds
    v_and_b32 v171, 0xffff0000, v144
    v_mul_f32 v170, v170, v168
    v_mfma_f32_16x16x32_bf16 v[44:47], a[156:159], a[200:203], v[44:47]
    ds_read_b64_tr_b16 a[196:197], v202 offset:22592
    v_mul_f32 v171, v171, v169
    v_cvt_pk_bf16_f32 v170, v170, v171
    s_waitcnt lgkmcnt(12)
    v_mfma_f32_16x16x32_bf16 v[60:63], a[156:159], a[204:207], v[60:63]
    v_lshlrev_b32 v171, 16, v170
    v_and_b32 v170, 0xffff0000, v170
    v_add_f32 v174, v174, v171
    v_mfma_f32_16x16x32_bf16 v[56:59], a[152:155], a[204:207], v[56:59]
    ds_read_b64_tr_b16 a[198:199], v202 offset:24384
    v_add_f32 v174, v174, v170
    v_lshlrev_b32 v170, 16, v152
    v_mfma_f32_16x16x32_bf16 v[52:55], a[148:151], a[204:207], v[52:55]
    s_mov_b32 m0, s78
    v_and_b32 v171, 0xffff0000, v152
    v_mul_f32 v170, v170, v168
    v_mfma_f32_16x16x32_bf16 v[48:51], a[144:147], a[204:207], v[48:51]
    ds_read_b64_tr_b16 a[200:201], v202 offset:8288
    buffer_load_dwordx4 v191, s[12:15], s31 offen offset:0 lds
    v_mul_f32 v171, v171, v169
    s_waitcnt lgkmcnt(12)
    v_mfma_f32_16x16x32_bf16 v[64:67], a[176:179], a[144:147], v[64:67]
    ds_read_b128 a[164:167], v200 offset:2048
    v_cvt_pk_bf16_f32 v170, v170, v171
    v_lshlrev_b32 v171, 16, v170
    v_mfma_f32_16x16x32_bf16 v[68:71], a[176:179], a[148:151], v[68:71]
    ds_read_b64_tr_b16 a[202:203], v202 offset:10080
    v_and_b32 v170, 0xffff0000, v170
    v_add_f32 v175, v175, v171
    v_mfma_f32_16x16x32_bf16 v[72:75], a[176:179], a[152:155], v[72:75]
    v_add_f32 v175, v175, v170
    v_lshlrev_b32 v168, 16, v161
    v_and_b32 v169, 0xffff0000, v161
    v_mfma_f32_16x16x32_bf16 v[76:79], a[176:179], a[156:159], v[76:79]
    ds_read_b64_tr_b16 a[204:205], v202 offset:22624
    buffer_load_dwordx4 v192, s[12:15], s31 offen offset:1024 lds
    v_lshlrev_b32 v170, 16, v145
    s_waitcnt lgkmcnt(13)
    v_mfma_f32_16x16x32_bf16 a[12:15], a[180:183], a[156:159], a[12:15]
    v_and_b32 v171, 0xffff0000, v145
    v_mul_f32 v170, v170, v168
    v_mul_f32 v171, v171, v169
    v_mfma_f32_16x16x32_bf16 a[8:11], a[180:183], a[152:155], a[8:11]
    ds_read_b64_tr_b16 a[206:207], v202 offset:24416
    v_cvt_pk_bf16_f32 v170, v170, v171
    v_lshlrev_b32 v171, 16, v170
    v_mfma_f32_16x16x32_bf16 a[4:7], a[180:183], a[148:151], a[4:7]
    v_and_b32 v170, 0xffff0000, v170
    v_add_f32 v174, v174, v171
    v_add_f32 v174, v174, v170
    v_mfma_f32_16x16x32_bf16 a[0:3], a[180:183], a[144:147], a[0:3]
    ds_read_b64_tr_b16 a[176:177], v202 offset:8320
    s_mov_b32 m0, s70
    v_lshlrev_b32 v170, 16, v153
    s_waitcnt lgkmcnt(13)
    v_mfma_f32_16x16x32_bf16 v[80:83], a[184:187], a[144:147], v[80:83]
    ds_read_b128 a[168:171], v200 offset:4096
    buffer_load_dwordx4 v176, s[4:7], s31 offen offset:0 lds
    v_and_b32 v171, 0xffff0000, v153
    v_mfma_f32_16x16x32_bf16 v[84:87], a[184:187], a[148:151], v[84:87]
    ds_read_b64_tr_b16 a[178:179], v202 offset:10112
    v_mul_f32 v170, v170, v168
    v_mul_f32 v171, v171, v169
    v_mfma_f32_16x16x32_bf16 v[88:91], a[184:187], a[152:155], v[88:91]
    v_cvt_pk_bf16_f32 v170, v170, v171
    v_lshlrev_b32 v171, 16, v170
    v_and_b32 v170, 0xffff0000, v170
    v_mfma_f32_16x16x32_bf16 v[92:95], a[184:187], a[156:159], v[92:95]
    ds_read_b64_tr_b16 a[180:181], v202 offset:22656
    v_add_f32 v175, v175, v171
    v_add_f32 v175, v175, v170
    s_waitcnt lgkmcnt(14)
    v_mfma_f32_16x16x32_bf16 a[28:31], a[188:191], a[156:159], a[28:31]
    buffer_load_dwordx4 v177, s[4:7], s31 offen offset:1024 lds
    v_lshlrev_b32 v168, 16, v162
    v_and_b32 v169, 0xffff0000, v162
    v_mfma_f32_16x16x32_bf16 a[24:27], a[188:191], a[152:155], a[24:27]
    ds_read_b64_tr_b16 a[182:183], v202 offset:24448
    v_lshlrev_b32 v170, 16, v146
    v_and_b32 v171, 0xffff0000, v146
    v_mfma_f32_16x16x32_bf16 a[20:23], a[188:191], a[148:151], a[20:23]
    v_mul_f32 v170, v170, v168
    v_mul_f32 v171, v171, v169
    v_cvt_pk_bf16_f32 v170, v170, v171
    v_mfma_f32_16x16x32_bf16 a[16:19], a[188:191], a[144:147], a[16:19]
    ds_read_b64_tr_b16 a[184:185], v202 offset:8352
    v_lshlrev_b32 v171, 16, v170
    v_and_b32 v170, 0xffff0000, v170
    s_waitcnt lgkmcnt(13)
    v_mfma_f32_16x16x32_bf16 v[96:99], a[192:195], a[144:147], v[96:99]
    ds_read_b128 a[172:175], v200 offset:6144
    buffer_load_dwordx4 v178, s[4:7], s31 offen offset:2048 lds
    v_add_f32 v174, v174, v171
    v_mfma_f32_16x16x32_bf16 v[100:103], a[192:195], a[148:151], v[100:103]
    ds_read_b64_tr_b16 a[186:187], v202 offset:10144
    v_add_f32 v174, v174, v170
    v_lshlrev_b32 v170, 16, v154
    v_mfma_f32_16x16x32_bf16 v[104:107], a[192:195], a[152:155], v[104:107]
    v_and_b32 v171, 0xffff0000, v154
    v_mul_f32 v170, v170, v168
    v_mul_f32 v171, v171, v169
    v_mfma_f32_16x16x32_bf16 v[108:111], a[192:195], a[156:159], v[108:111]
    ds_read_b64_tr_b16 a[188:189], v202 offset:22688
    v_cvt_pk_bf16_f32 v170, v170, v171
    v_lshlrev_b32 v171, 16, v170
    s_waitcnt lgkmcnt(14)
    v_mfma_f32_16x16x32_bf16 a[44:47], a[196:199], a[156:159], a[44:47]
    buffer_load_dwordx4 v179, s[4:7], s31 offen offset:3072 lds
    v_and_b32 v170, 0xffff0000, v170
    v_add_f32 v175, v175, v171
    v_mfma_f32_16x16x32_bf16 a[40:43], a[196:199], a[152:155], a[40:43]
    ds_read_b64_tr_b16 a[190:191], v202 offset:24480
    v_add_f32 v175, v175, v170
    v_lshlrev_b32 v168, 16, v163
    v_mfma_f32_16x16x32_bf16 a[36:39], a[196:199], a[148:151], a[36:39]
    v_and_b32 v169, 0xffff0000, v163
    v_lshlrev_b32 v170, 16, v147
    v_and_b32 v171, 0xffff0000, v147
    v_mfma_f32_16x16x32_bf16 a[32:35], a[196:199], a[144:147], a[32:35]
    ds_read_b64_tr_b16 a[192:193], v202 offset:8384
    v_mul_f32 v170, v170, v168
    v_mul_f32 v171, v171, v169
    s_waitcnt lgkmcnt(13)
    v_mfma_f32_16x16x32_bf16 v[112:115], a[200:203], a[144:147], v[112:115]
    s_mov_b32 m0, s72
    v_cvt_pk_bf16_f32 v170, v170, v171
    v_lshlrev_b32 v171, 16, v170
    v_mfma_f32_16x16x32_bf16 v[116:119], a[200:203], a[148:151], v[116:119]
    ds_read_b64_tr_b16 a[194:195], v202 offset:10176
    buffer_load_dwordx4 v180, s[4:7], s31 offen offset:0 lds
    v_and_b32 v170, 0xffff0000, v170
    v_mfma_f32_16x16x32_bf16 v[120:123], a[200:203], a[152:155], v[120:123]
    v_add_f32 v174, v174, v171
    v_add_f32 v174, v174, v170
    v_lshlrev_b32 v170, 16, v155
    v_mfma_f32_16x16x32_bf16 v[124:127], a[200:203], a[156:159], v[124:127]
    ds_read_b64_tr_b16 a[196:197], v202 offset:22720
    v_and_b32 v171, 0xffff0000, v155
    v_mul_f32 v170, v170, v168
    s_waitcnt lgkmcnt(13)
    v_mfma_f32_16x16x32_bf16 a[60:63], a[204:207], a[156:159], a[60:63]
    v_mul_f32 v171, v171, v169
    v_cvt_pk_bf16_f32 v170, v170, v171
    v_lshlrev_b32 v171, 16, v170
    v_mfma_f32_16x16x32_bf16 a[56:59], a[204:207], a[152:155], a[56:59]
    ds_read_b64_tr_b16 a[198:199], v202 offset:24512
    buffer_load_dwordx4 v181, s[4:7], s31 offen offset:1024 lds
    v_and_b32 v170, 0xffff0000, v170
    v_mfma_f32_16x16x32_bf16 a[52:55], a[204:207], a[148:151], a[52:55]
    v_add_f32 v175, v175, v171
    v_add_f32 v175, v175, v170
    v_lshlrev_b32 v168, 16, v164
    v_mfma_f32_16x16x32_bf16 a[48:51], a[204:207], a[144:147], a[48:51]
    ds_read_b128 a[200:203], v196 offset:0
    v_and_b32 v169, 0xffff0000, v164
    v_lshlrev_b32 v170, 16, v148
    s_waitcnt lgkmcnt(12)
    v_mfma_f32_16x16x32_bf16 v[128:131], a[176:179], a[144:147], v[128:131]
    v_and_b32 v171, 0xffff0000, v148
    v_mul_f32 v170, v170, v168
    v_mul_f32 v171, v171, v169
    v_mfma_f32_16x16x32_bf16 v[132:135], a[176:179], a[148:151], v[132:135]
    buffer_load_dwordx4 v182, s[4:7], s31 offen offset:2048 lds
    v_cvt_pk_bf16_f32 v170, v170, v171
    v_lshlrev_b32 v171, 16, v170
    v_mfma_f32_16x16x32_bf16 v[136:139], a[176:179], a[152:155], v[136:139]
    v_and_b32 v170, 0xffff0000, v170
    v_add_f32 v174, v174, v171
    v_add_f32 v174, v174, v170
    v_mfma_f32_16x16x32_bf16 v[140:143], a[176:179], a[156:159], v[140:143]
    ds_read_b128 a[204:207], v196 offset:4096
    v_lshlrev_b32 v170, 16, v156
    v_and_b32 v171, 0xffff0000, v156
    s_waitcnt lgkmcnt(11)
    v_mfma_f32_16x16x32_bf16 a[76:79], a[180:183], a[156:159], a[76:79]
    v_mul_f32 v170, v170, v168
    v_mul_f32 v171, v171, v169
    v_cvt_pk_bf16_f32 v170, v170, v171
    v_mfma_f32_16x16x32_bf16 a[72:75], a[180:183], a[152:155], a[72:75]
    buffer_load_dwordx4 v183, s[4:7], s31 offen offset:3072 lds
    v_lshlrev_b32 v171, 16, v170
    v_and_b32 v170, 0xffff0000, v170
    v_mfma_f32_16x16x32_bf16 a[68:71], a[180:183], a[148:151], a[68:71]
    v_add_f32 v175, v175, v171
    v_add_f32 v175, v175, v170
    v_lshlrev_b32 v168, 16, v165
    v_mfma_f32_16x16x32_bf16 a[64:67], a[180:183], a[144:147], a[64:67]
    ds_read_b128 a[176:179], v196 offset:2048
    v_and_b32 v169, 0xffff0000, v165
    v_lshlrev_b32 v170, 16, v149
    s_waitcnt lgkmcnt(9)
    v_mfma_f32_16x16x32_bf16 a[112:115], a[184:187], a[144:147], a[112:115]
    v_and_b32 v171, 0xffff0000, v149
    v_mul_f32 v170, v170, v168
    v_mul_f32 v171, v171, v169
    v_mfma_f32_16x16x32_bf16 a[116:119], a[184:187], a[148:151], a[116:119]
    s_add_u32 s31, s31, 128
    s_add_u32 s32, s32, 0x70000
    buffer_load_dword a255, v203, s[96:99], s34 offen
    v_mfma_f32_16x16x32_bf16 a[120:123], a[184:187], a[152:155], a[120:123]
    v_cvt_pk_bf16_f32 v170, v170, v171
    v_lshlrev_b32 v171, 16, v170
    v_and_b32 v170, 0xffff0000, v170
    v_mfma_f32_16x16x32_bf16 a[124:127], a[184:187], a[156:159], a[124:127]
    ds_read_b128 a[180:183], v196 offset:6144
    v_add_f32 v174, v174, v171
    v_add_f32 v174, v174, v170
    s_waitcnt lgkmcnt(8)
    v_mfma_f32_16x16x32_bf16 a[92:95], a[188:191], a[156:159], a[92:95]
    v_lshlrev_b32 v170, 16, v157
    v_and_b32 v171, 0xffff0000, v157
    v_mul_f32 v170, v170, v168
    v_mfma_f32_16x16x32_bf16 a[88:91], a[188:191], a[152:155], a[88:91]
    s_add_u32 s34, s34, s35
    buffer_load_dword a255, v235, s[12:15], s3 offen
    v_mul_f32 v171, v171, v169
    v_mfma_f32_16x16x32_bf16 a[84:87], a[188:191], a[148:151], a[84:87]
    v_cvt_pk_bf16_f32 v170, v170, v171
    v_lshlrev_b32 v171, 16, v170
    v_and_b32 v170, 0xffff0000, v170
    v_mfma_f32_16x16x32_bf16 a[80:83], a[188:191], a[144:147], a[80:83]
    ds_read_b64_tr_b16 a[184:185], v202 offset:15360
    v_add_f32 v175, v175, v171
    v_add_f32 v175, v175, v170
    s_waitcnt lgkmcnt(7)
    v_mfma_f32_16x16x32_bf16 a[128:131], a[192:195], a[144:147], a[128:131]
    v_lshlrev_b32 v168, 16, v166
    v_and_b32 v169, 0xffff0000, v166
    v_lshlrev_b32 v170, 16, v150
    v_mfma_f32_16x16x32_bf16 a[132:135], a[192:195], a[148:151], a[132:135]
    ds_read_b64_tr_b16 a[186:187], v202 offset:17152
    s_add_u32 s3, s3, 128
    buffer_load_dword a255, v203, s[96:99], s34 offen
    v_mfma_f32_16x16x32_bf16 a[136:139], a[192:195], a[152:155], a[136:139]
    v_and_b32 v171, 0xffff0000, v150
    v_mul_f32 v170, v170, v168
    v_mul_f32 v171, v171, v169
    v_mfma_f32_16x16x32_bf16 a[140:143], a[192:195], a[156:159], a[140:143]
    ds_read_b64_tr_b16 a[188:189], v202 offset:29696
    v_cvt_pk_bf16_f32 v170, v170, v171
    v_lshlrev_b32 v171, 16, v170
    s_waitcnt lgkmcnt(7)
    v_mfma_f32_16x16x32_bf16 a[108:111], a[196:199], a[156:159], a[108:111]
    v_and_b32 v170, 0xffff0000, v170
    v_add_f32 v174, v174, v171
    v_add_f32 v174, v174, v170
    v_mfma_f32_16x16x32_bf16 a[104:107], a[196:199], a[152:155], a[104:107]
    ds_read_b64_tr_b16 a[190:191], v202 offset:31488
    s_add_u32 s34, s34, s35
    buffer_load_dword a255, v235, s[12:15], s3 offen
    v_mfma_f32_16x16x32_bf16 a[100:103], a[196:199], a[148:151], a[100:103]
    v_lshlrev_b32 v170, 16, v158
    v_and_b32 v171, 0xffff0000, v158
    v_mul_f32 v170, v170, v168
    v_mfma_f32_16x16x32_bf16 a[96:99], a[196:199], a[144:147], a[96:99]
    ds_read_b64_tr_b16 a[192:193], v202 offset:15392
    v_mul_f32 v171, v171, v169
    v_cvt_pk_bf16_f32 v170, v170, v171
    s_waitcnt lgkmcnt(8)
    v_mfma_f32_16x16x32_bf16 v[0:3], a[160:163], a[200:203], v[0:3]
    v_lshlrev_b32 v171, 16, v170
    v_and_b32 v170, 0xffff0000, v170
    v_add_f32 v175, v175, v171
    v_mfma_f32_16x16x32_bf16 v[4:7], a[164:167], a[200:203], v[4:7]
    ds_read_b64_tr_b16 a[194:195], v202 offset:17184
    s_add_u32 s3, s3, 128
    v_add_f32 v175, v175, v170
    v_mfma_f32_16x16x32_bf16 v[8:11], a[168:171], a[200:203], v[8:11]
    v_lshlrev_b32 v168, 16, v167
    v_and_b32 v169, 0xffff0000, v167
    v_lshlrev_b32 v170, 16, v151
    v_mfma_f32_16x16x32_bf16 v[12:15], a[172:175], a[200:203], v[12:15]
    ds_read_b64_tr_b16 a[196:197], v202 offset:29728
    v_and_b32 v171, 0xffff0000, v151
    v_mul_f32 v170, v170, v168
    s_waitcnt lgkmcnt(9)
    v_mfma_f32_16x16x32_bf16 v[28:31], a[172:175], a[204:207], v[28:31]
    v_mul_f32 v171, v171, v169
    v_cvt_pk_bf16_f32 v170, v170, v171
    v_lshlrev_b32 v171, 16, v170
    v_mfma_f32_16x16x32_bf16 v[24:27], a[168:171], a[204:207], v[24:27]
    ds_read_b64_tr_b16 a[198:199], v202 offset:31520
    v_and_b32 v170, 0xffff0000, v170
    v_add_f32 v174, v174, v171
    v_mfma_f32_16x16x32_bf16 v[20:23], a[164:167], a[204:207], v[20:23]
    v_add_f32 v174, v174, v170
    v_lshlrev_b32 v170, 16, v159
    v_and_b32 v171, 0xffff0000, v159
    v_mfma_f32_16x16x32_bf16 v[16:19], a[160:163], a[204:207], v[16:19]
    ds_read_b64_tr_b16 a[200:201], v202 offset:15424
    v_mul_f32 v170, v170, v168
    v_mul_f32 v171, v171, v169
    s_waitcnt lgkmcnt(10)
    v_mfma_f32_16x16x32_bf16 v[32:35], a[160:163], a[176:179], v[32:35]
    v_cvt_pk_bf16_f32 v170, v170, v171
    v_lshlrev_b32 v171, 16, v170
    v_and_b32 v170, 0xffff0000, v170
    v_mfma_f32_16x16x32_bf16 v[36:39], a[164:167], a[176:179], v[36:39]
    ds_read_b64_tr_b16 a[202:203], v202 offset:17216
    v_add_f32 v175, v175, v171
    v_add_f32 v175, v175, v170
    v_mfma_f32_16x16x32_bf16 v[40:43], a[168:171], a[176:179], v[40:43]
    s_nop 1
    v_add_f32_dpp v174, v174, v174 row_shr:1 row_mask:0xf bank_mask:0xf bound_ctrl:0
    v_add_f32_dpp v175, v175, v175 row_shr:1 row_mask:0xf bank_mask:0xf bound_ctrl:0
    v_mfma_f32_16x16x32_bf16 v[44:47], a[172:175], a[176:179], v[44:47]
    ds_read_b64_tr_b16 a[204:205], v202 offset:29760
    s_nop 1
    v_add_f32_dpp v174, v174, v174 row_shr:2 row_mask:0xf bank_mask:0xf bound_ctrl:0
    v_add_f32_dpp v175, v175, v175 row_shr:2 row_mask:0xf bank_mask:0xf bound_ctrl:0
    s_waitcnt lgkmcnt(11)
    v_mfma_f32_16x16x32_bf16 v[60:63], a[172:175], a[180:183], v[60:63]
    s_nop 1
    v_add_f32_dpp v174, v174, v174 row_shr:4 row_mask:0xf bank_mask:0xf bound_ctrl:0
    v_add_f32_dpp v175, v175, v175 row_shr:4 row_mask:0xf bank_mask:0xf bound_ctrl:0
    v_mfma_f32_16x16x32_bf16 v[56:59], a[168:171], a[180:183], v[56:59]
    ds_read_b64_tr_b16 a[206:207], v202 offset:31552
    s_nop 1
    v_add_f32_dpp v174, v174, v174 row_shr:8 row_mask:0xf bank_mask:0xf bound_ctrl:0
    v_add_f32_dpp v175, v175, v175 row_shr:8 row_mask:0xf bank_mask:0xf bound_ctrl:0
    v_mfma_f32_16x16x32_bf16 v[52:55], a[164:167], a[180:183], v[52:55]
    s_nop 1
    v_add_f32_dpp v174, v174, v174 row_bcast:15 row_mask:0xa bank_mask:0xf
    v_add_f32_dpp v175, v175, v175 row_bcast:15 row_mask:0xa bank_mask:0xf
    v_mfma_f32_16x16x32_bf16 v[48:51], a[160:163], a[180:183], v[48:51]
    ds_read_b64_tr_b16 a[176:177], v202 offset:15456
    s_nop 1
    v_add_f32_dpp v174, v174, v174 row_bcast:31 row_mask:0xc bank_mask:0xf
    v_add_f32_dpp v175, v175, v175 row_bcast:31 row_mask:0xc bank_mask:0xf
    s_waitcnt lgkmcnt(11)
    v_mfma_f32_16x16x32_bf16 v[64:67], a[184:187], a[160:163], v[64:67]
    v_cvt_pk_bf16_f32 v168, v174, v175
    v_lshlrev_b32 v174, 16, v168
    v_and_b32 v175, 0xffff0000, v168
    v_mfma_f32_16x16x32_bf16 v[68:71], a[184:187], a[164:167], v[68:71]
    ds_read_b64_tr_b16 a[178:179], v202 offset:17248
    v_mul_f32 v174, 0xbfb8aa3b, v174
    v_mul_f32 v175, 0xbfb8aa3b, v175
    v_mfma_f32_16x16x32_bf16 v[72:75], a[184:187], a[168:171], v[72:75]
    v_exp_f32 v174, v174
    v_exp_f32 v175, v175
    s_nop 0
    v_mfma_f32_16x16x32_bf16 v[76:79], a[184:187], a[172:175], v[76:79]
    ds_read_b64_tr_b16 a[180:181], v202 offset:29792
    v_add_f32 v174, 1.0, v174
    v_add_f32 v175, 1.0, v175
    s_waitcnt lgkmcnt(11)
    v_mfma_f32_16x16x32_bf16 a[12:15], a[188:191], a[172:175], a[12:15]
    v_rcp_f32 v174, v174
    v_rcp_f32 v175, v175
    s_nop 0
    v_mfma_f32_16x16x32_bf16 a[8:11], a[188:191], a[168:171], a[8:11]
    ds_read_b64_tr_b16 a[182:183], v202 offset:31584
    v_cvt_pk_bf16_f32 v168, v174, v175
    v_lshlrev_b32 v174, 16, v168
    v_mfma_f32_16x16x32_bf16 a[4:7], a[188:191], a[164:167], a[4:7]
    v_and_b32 v175, 0xffff0000, v168
    v_sub_u32 v168, 63, v224
    v_lshlrev_b32 v168, 26, v168
    v_mfma_f32_16x16x32_bf16 a[0:3], a[188:191], a[160:163], a[0:3]
    ds_read_b64_tr_b16 a[184:185], v202 offset:15488
    s_lshl_b32 s80, s2, 3
    s_add_u32 s80, s80, s28
    s_waitcnt lgkmcnt(11)
    v_mfma_f32_16x16x32_bf16 v[80:83], a[192:195], a[160:163], v[80:83]
    s_lshl_b32 s80, s80, 2
    s_add_u32 s80, s80, 0x1800000
    buffer_store_dword v174, v168, s[16:19], s80 offen sc1
    v_mfma_f32_16x16x32_bf16 v[84:87], a[192:195], a[164:167], v[84:87]
    ds_read_b64_tr_b16 a[186:187], v202 offset:17280
    buffer_store_dword v175, v168, s[16:19], s80 offen offset:16 sc1
    v_mfma_f32_16x16x32_bf16 v[88:91], a[192:195], a[168:171], v[88:91]
    v_mfma_f32_16x16x32_bf16 v[92:95], a[192:195], a[172:175], v[92:95]
    ds_read_b64_tr_b16 a[188:189], v202 offset:29824
    s_waitcnt lgkmcnt(11)
    v_mfma_f32_16x16x32_bf16 a[28:31], a[196:199], a[172:175], a[28:31]
    v_mfma_f32_16x16x32_bf16 a[24:27], a[196:199], a[168:171], a[24:27]
    ds_read_b64_tr_b16 a[190:191], v202 offset:31616
    v_mfma_f32_16x16x32_bf16 a[20:23], a[196:199], a[164:167], a[20:23]
    v_mfma_f32_16x16x32_bf16 a[16:19], a[196:199], a[160:163], a[16:19]
    ds_read_b64_tr_b16 a[192:193], v202 offset:15520
    s_waitcnt lgkmcnt(11)
    v_mfma_f32_16x16x32_bf16 v[96:99], a[200:203], a[160:163], v[96:99]
    v_mfma_f32_16x16x32_bf16 v[100:103], a[200:203], a[164:167], v[100:103]
    ds_read_b64_tr_b16 a[194:195], v202 offset:17312
    v_mfma_f32_16x16x32_bf16 v[104:107], a[200:203], a[168:171], v[104:107]
    v_mfma_f32_16x16x32_bf16 v[108:111], a[200:203], a[172:175], v[108:111]
    ds_read_b64_tr_b16 a[196:197], v202 offset:29856
    s_waitcnt lgkmcnt(11)
    v_mfma_f32_16x16x32_bf16 a[44:47], a[204:207], a[172:175], a[44:47]
    v_mfma_f32_16x16x32_bf16 a[40:43], a[204:207], a[168:171], a[40:43]
    ds_read_b64_tr_b16 a[198:199], v202 offset:31648
    v_mfma_f32_16x16x32_bf16 a[36:39], a[204:207], a[164:167], a[36:39]
    v_mfma_f32_16x16x32_bf16 a[32:35], a[204:207], a[160:163], a[32:35]
    ds_read_b64_tr_b16 a[200:201], v202 offset:15552
    s_waitcnt lgkmcnt(11)
    v_mfma_f32_16x16x32_bf16 v[112:115], a[176:179], a[160:163], v[112:115]
    v_mfma_f32_16x16x32_bf16 v[116:119], a[176:179], a[164:167], v[116:119]
    ds_read_b64_tr_b16 a[202:203], v202 offset:17344
    v_mfma_f32_16x16x32_bf16 v[120:123], a[176:179], a[168:171], v[120:123]
    v_mfma_f32_16x16x32_bf16 v[124:127], a[176:179], a[172:175], v[124:127]
    ds_read_b64_tr_b16 a[204:205], v202 offset:29888
    s_waitcnt lgkmcnt(11)
    v_mfma_f32_16x16x32_bf16 a[60:63], a[180:183], a[172:175], a[60:63]
    v_mfma_f32_16x16x32_bf16 a[56:59], a[180:183], a[168:171], a[56:59]
    ds_read_b64_tr_b16 a[206:207], v202 offset:31680
    v_mfma_f32_16x16x32_bf16 a[52:55], a[180:183], a[164:167], a[52:55]
    v_mfma_f32_16x16x32_bf16 a[48:51], a[180:183], a[160:163], a[48:51]
    s_waitcnt lgkmcnt(10)
    v_mfma_f32_16x16x32_bf16 v[128:131], a[184:187], a[160:163], v[128:131]
    v_mfma_f32_16x16x32_bf16 v[132:135], a[184:187], a[164:167], v[132:135]
    v_mfma_f32_16x16x32_bf16 v[136:139], a[184:187], a[168:171], v[136:139]
    v_mfma_f32_16x16x32_bf16 v[140:143], a[184:187], a[172:175], v[140:143]
    s_waitcnt lgkmcnt(8)
    v_mfma_f32_16x16x32_bf16 a[76:79], a[188:191], a[172:175], a[76:79]
    v_mfma_f32_16x16x32_bf16 a[72:75], a[188:191], a[168:171], a[72:75]
    v_mfma_f32_16x16x32_bf16 a[68:71], a[188:191], a[164:167], a[68:71]
    v_mfma_f32_16x16x32_bf16 a[64:67], a[188:191], a[160:163], a[64:67]
    s_waitcnt vmcnt(6) lgkmcnt(0)
    s_barrier
    s_mov_b32 s33, 6
    .p2align 6
k1_loop:
    s_lshl_b32 s80, s28, 3
    s_or_b32 s80, s80, s33
    s_cmp_lg_u32 s80, 5
    s_cbranch_scc1 k1_noarr
    v_mov_b32 v144, 1
    s_mov_b64 exec, 1
    buffer_atomic_add v144, off, s[20:23], 0 sc1
    s_mov_b64 exec, -1
k1_noarr:
    ds_read_b128 a[144:147], v197 offset:0
    v_mfma_f32_16x16x32_bf16 a[112:115], a[192:195], a[160:163], a[112:115]
    ds_read_b128 a[148:151], v197 offset:2048
    s_mov_b32 m0, s75
    v_mfma_f32_16x16x32_bf16 a[116:119], a[192:195], a[164:167], a[116:119]
    ds_read_b128 a[152:155], v197 offset:4096
    buffer_load_dwordx4 v184, s[8:11], s32 offen offset:0 lds
    v_mfma_f32_16x16x32_bf16 a[120:123], a[192:195], a[168:171], a[120:123]
    ds_read_b128 a[156:159], v197 offset:6144
    v_mfma_f32_16x16x32_bf16 a[124:127], a[192:195], a[172:175], a[124:127]
    ds_read_b128 a[176:179], v193 offset:0
    v_mfma_f32_16x16x32_bf16 a[92:95], a[196:199], a[172:175], a[92:95]
    ds_read_b128 a[180:183], v193 offset:4096
    v_mfma_f32_16x16x32_bf16 a[88:91], a[196:199], a[168:171], a[88:91]
    ds_read_b128 a[184:187], v193 offset:2048
    buffer_load_dwordx4 v185, s[8:11], s32 offen offset:1024 lds
    v_mfma_f32_16x16x32_bf16 a[84:87], a[196:199], a[164:167], a[84:87]
    ds_read_b128 a[188:191], v193 offset:6144
    v_mfma_f32_16x16x32_bf16 a[80:83], a[196:199], a[160:163], a[80:83]
    ds_read_b64_tr_b16 a[192:193], v201 offset:8192
    v_mfma_f32_16x16x32_bf16 a[128:131], a[200:203], a[160:163], a[128:131]
    ds_read_b64_tr_b16 a[194:195], v201 offset:9984
    v_mfma_f32_16x16x32_bf16 a[132:135], a[200:203], a[164:167], a[132:135]
    ds_read_b64_tr_b16 a[196:197], v201 offset:22528
    buffer_load_dwordx4 v186, s[8:11], s32 offen offset:2048 lds
    v_mfma_f32_16x16x32_bf16 a[136:139], a[200:203], a[168:171], a[136:139]
    ds_read_b64_tr_b16 a[198:199], v201 offset:24320
    v_mfma_f32_16x16x32_bf16 a[140:143], a[200:203], a[172:175], a[140:143]
    v_mfma_f32_16x16x32_bf16 a[108:111], a[204:207], a[172:175], a[108:111]
    v_mfma_f32_16x16x32_bf16 a[104:107], a[204:207], a[168:171], a[104:107]
    buffer_load_dwordx4 v187, s[8:11], s32 offen offset:3072 lds
    v_mfma_f32_16x16x32_bf16 a[100:103], a[204:207], a[164:167], a[100:103]
    v_mfma_f32_16x16x32_bf16 a[96:99], a[204:207], a[160:163], a[96:99]
    ds_read_b64_tr_b16 a[200:201], v201 offset:8224
    s_waitcnt lgkmcnt(8)
    v_mfma_f32_16x16x32_bf16 v[0:3], a[144:147], a[176:179], v[0:3]
    v_mfma_f32_16x16x32_bf16 v[4:7], a[148:151], a[176:179], v[4:7]
    ds_read_b64_tr_b16 a[202:203], v201 offset:10016
    s_mov_b32 m0, s77
    v_mfma_f32_16x16x32_bf16 v[8:11], a[152:155], a[176:179], v[8:11]
    buffer_load_dwordx4 v188, s[8:11], s32 offen offset:0 lds
    v_mfma_f32_16x16x32_bf16 v[12:15], a[156:159], a[176:179], v[12:15]
    ds_read_b64_tr_b16 a[204:205], v201 offset:22560
    s_waitcnt lgkmcnt(9)
    v_mfma_f32_16x16x32_bf16 v[28:31], a[156:159], a[180:183], v[28:31]
    v_mfma_f32_16x16x32_bf16 v[24:27], a[152:155], a[180:183], v[24:27]
    ds_read_b64_tr_b16 a[206:207], v201 offset:24352
    v_mfma_f32_16x16x32_bf16 v[20:23], a[148:151], a[180:183], v[20:23]
    buffer_load_dwordx4 v189, s[8:11], s32 offen offset:1024 lds
    v_mfma_f32_16x16x32_bf16 v[16:19], a[144:147], a[180:183], v[16:19]
    ds_read_b64_tr_b16 a[176:177], v201 offset:8256
    s_waitcnt lgkmcnt(10)
    v_mfma_f32_16x16x32_bf16 v[32:35], a[144:147], a[184:187], v[32:35]
    ds_read_b128 a[160:163], v199 offset:0
    v_mfma_f32_16x16x32_bf16 v[36:39], a[148:151], a[184:187], v[36:39]
    ds_read_b64_tr_b16 a[178:179], v201 offset:10048
    v_mfma_f32_16x16x32_bf16 v[40:43], a[152:155], a[184:187], v[40:43]
    buffer_load_dwordx4 v190, s[8:11], s32 offen offset:2048 lds
    v_mfma_f32_16x16x32_bf16 v[44:47], a[156:159], a[184:187], v[44:47]
    ds_read_b64_tr_b16 a[180:181], v201 offset:22592
    s_waitcnt lgkmcnt(12)
    v_mfma_f32_16x16x32_bf16 v[60:63], a[156:159], a[188:191], v[60:63]
    v_mfma_f32_16x16x32_bf16 v[56:59], a[152:155], a[188:191], v[56:59]
    ds_read_b64_tr_b16 a[182:183], v201 offset:24384
    v_mfma_f32_16x16x32_bf16 v[52:55], a[148:151], a[188:191], v[52:55]
    s_mov_b32 m0, s79
    v_mfma_f32_16x16x32_bf16 v[48:51], a[144:147], a[188:191], v[48:51]
    ds_read_b64_tr_b16 a[184:185], v201 offset:8288
    buffer_load_dwordx4 v191, s[12:15], s31 offen offset:0 lds
    s_waitcnt lgkmcnt(12)
    v_mfma_f32_16x16x32_bf16 v[64:67], a[192:195], a[144:147], v[64:67]
    ds_read_b128 a[164:167], v199 offset:2048
    v_mfma_f32_16x16x32_bf16 v[68:71], a[192:195], a[148:151], v[68:71]
    ds_read_b64_tr_b16 a[186:187], v201 offset:10080
    v_mfma_f32_16x16x32_bf16 v[72:75], a[192:195], a[152:155], v[72:75]
    v_mfma_f32_16x16x32_bf16 v[76:79], a[192:195], a[156:159], v[76:79]
    ds_read_b64_tr_b16 a[188:189], v201 offset:22624
    buffer_load_dwordx4 v192, s[12:15], s31 offen offset:1024 lds
    s_waitcnt lgkmcnt(13)
    v_mfma_f32_16x16x32_bf16 a[12:15], a[196:199], a[156:159], a[12:15]
    v_mfma_f32_16x16x32_bf16 a[8:11], a[196:199], a[152:155], a[8:11]
    ds_read_b64_tr_b16 a[190:191], v201 offset:24416
    v_mfma_f32_16x16x32_bf16 a[4:7], a[196:199], a[148:151], a[4:7]
    v_mfma_f32_16x16x32_bf16 a[0:3], a[196:199], a[144:147], a[0:3]
    ds_read_b64_tr_b16 a[192:193], v201 offset:8320
    s_mov_b32 m0, s71
    s_waitcnt lgkmcnt(13)
    v_mfma_f32_16x16x32_bf16 v[80:83], a[200:203], a[144:147], v[80:83]
    ds_read_b128 a[168:171], v199 offset:4096
    buffer_load_dwordx4 v176, s[4:7], s31 offen offset:0 lds
    v_mfma_f32_16x16x32_bf16 v[84:87], a[200:203], a[148:151], v[84:87]
    ds_read_b64_tr_b16 a[194:195], v201 offset:10112
    v_mfma_f32_16x16x32_bf16 v[88:91], a[200:203], a[152:155], v[88:91]
    v_mfma_f32_16x16x32_bf16 v[92:95], a[200:203], a[156:159], v[92:95]
    ds_read_b64_tr_b16 a[196:197], v201 offset:22656
    s_waitcnt lgkmcnt(14)
    v_mfma_f32_16x16x32_bf16 a[28:31], a[204:207], a[156:159], a[28:31]
    buffer_load_dwordx4 v177, s[4:7], s31 offen offset:1024 lds
    v_mfma_f32_16x16x32_bf16 a[24:27], a[204:207], a[152:155], a[24:27]
    ds_read_b64_tr_b16 a[198:199], v201 offset:24448
    v_mfma_f32_16x16x32_bf16 a[20:23], a[204:207], a[148:151], a[20:23]
    v_mfma_f32_16x16x32_bf16 a[16:19], a[204:207], a[144:147], a[16:19]
    ds_read_b64_tr_b16 a[200:201], v201 offset:8352
    s_waitcnt lgkmcnt(13)
    v_mfma_f32_16x16x32_bf16 v[96:99], a[176:179], a[144:147], v[96:99]
    ds_read_b128 a[172:175], v199 offset:6144
    buffer_load_dwordx4 v178, s[4:7], s31 offen offset:2048 lds
    v_mfma_f32_16x16x32_bf16 v[100:103], a[176:179], a[148:151], v[100:103]
    ds_read_b64_tr_b16 a[202:203], v201 offset:10144
    v_mfma_f32_16x16x32_bf16 v[104:107], a[176:179], a[152:155], v[104:107]
    v_mfma_f32_16x16x32_bf16 v[108:111], a[176:179], a[156:159], v[108:111]
    ds_read_b64_tr_b16 a[204:205], v201 offset:22688
    s_waitcnt lgkmcnt(14)
    v_mfma_f32_16x16x32_bf16 a[44:47], a[180:183], a[156:159], a[44:47]
    buffer_load_dwordx4 v179, s[4:7], s31 offen offset:3072 lds
    v_mfma_f32_16x16x32_bf16 a[40:43], a[180:183], a[152:155], a[40:43]
    ds_read_b64_tr_b16 a[206:207], v201 offset:24480
    v_mfma_f32_16x16x32_bf16 a[36:39], a[180:183], a[148:151], a[36:39]
    v_mfma_f32_16x16x32_bf16 a[32:35], a[180:183], a[144:147], a[32:35]
    ds_read_b64_tr_b16 a[176:177], v201 offset:8384
    s_waitcnt lgkmcnt(13)
    v_mfma_f32_16x16x32_bf16 v[112:115], a[184:187], a[144:147], v[112:115]
    s_mov_b32 m0, s73
    v_mfma_f32_16x16x32_bf16 v[116:119], a[184:187], a[148:151], v[116:119]
    ds_read_b64_tr_b16 a[178:179], v201 offset:10176
    buffer_load_dwordx4 v180, s[4:7], s31 offen offset:0 lds
    v_mfma_f32_16x16x32_bf16 v[120:123], a[184:187], a[152:155], v[120:123]
    v_mfma_f32_16x16x32_bf16 v[124:127], a[184:187], a[156:159], v[124:127]
    ds_read_b64_tr_b16 a[180:181], v201 offset:22720
    s_waitcnt lgkmcnt(13)
    v_mfma_f32_16x16x32_bf16 a[60:63], a[188:191], a[156:159], a[60:63]
    v_mfma_f32_16x16x32_bf16 a[56:59], a[188:191], a[152:155], a[56:59]
    ds_read_b64_tr_b16 a[182:183], v201 offset:24512
    buffer_load_dwordx4 v181, s[4:7], s31 offen offset:1024 lds
    v_mfma_f32_16x16x32_bf16 a[52:55], a[188:191], a[148:151], a[52:55]
    v_mfma_f32_16x16x32_bf16 a[48:51], a[188:191], a[144:147], a[48:51]
    ds_read_b128 a[184:187], v195 offset:0
    s_waitcnt lgkmcnt(12)
    v_mfma_f32_16x16x32_bf16 v[128:131], a[192:195], a[144:147], v[128:131]
    v_mfma_f32_16x16x32_bf16 v[132:135], a[192:195], a[148:151], v[132:135]
    buffer_load_dwordx4 v182, s[4:7], s31 offen offset:2048 lds
    v_mfma_f32_16x16x32_bf16 v[136:139], a[192:195], a[152:155], v[136:139]
    v_mfma_f32_16x16x32_bf16 v[140:143], a[192:195], a[156:159], v[140:143]
    ds_read_b128 a[188:191], v195 offset:4096
    s_waitcnt lgkmcnt(11)
    v_mfma_f32_16x16x32_bf16 a[76:79], a[196:199], a[156:159], a[76:79]
    v_mfma_f32_16x16x32_bf16 a[72:75], a[196:199], a[152:155], a[72:75]
    buffer_load_dwordx4 v183, s[4:7], s31 offen offset:3072 lds
    v_mfma_f32_16x16x32_bf16 a[68:71], a[196:199], a[148:151], a[68:71]
    v_mfma_f32_16x16x32_bf16 a[64:67], a[196:199], a[144:147], a[64:67]
    ds_read_b128 a[192:195], v195 offset:2048
    s_waitcnt lgkmcnt(9)
    v_mfma_f32_16x16x32_bf16 a[112:115], a[200:203], a[144:147], a[112:115]
    v_mfma_f32_16x16x32_bf16 a[116:119], a[200:203], a[148:151], a[116:119]
    s_add_u32 s31, s31, 128
    s_add_u32 s32, s32, 0x70000
    buffer_load_dword a255, v203, s[96:99], s34 offen
    v_mfma_f32_16x16x32_bf16 a[120:123], a[200:203], a[152:155], a[120:123]
    v_mfma_f32_16x16x32_bf16 a[124:127], a[200:203], a[156:159], a[124:127]
    ds_read_b128 a[196:199], v195 offset:6144
    s_waitcnt lgkmcnt(8)
    v_mfma_f32_16x16x32_bf16 a[92:95], a[204:207], a[156:159], a[92:95]
    v_mfma_f32_16x16x32_bf16 a[88:91], a[204:207], a[152:155], a[88:91]
    s_add_u32 s34, s34, s35
    buffer_load_dword a255, v235, s[12:15], s3 offen
    v_mfma_f32_16x16x32_bf16 a[84:87], a[204:207], a[148:151], a[84:87]
    v_mfma_f32_16x16x32_bf16 a[80:83], a[204:207], a[144:147], a[80:83]
    ds_read_b64_tr_b16 a[200:201], v201 offset:15360
    s_waitcnt lgkmcnt(7)
    v_mfma_f32_16x16x32_bf16 a[128:131], a[176:179], a[144:147], a[128:131]
    v_mfma_f32_16x16x32_bf16 a[132:135], a[176:179], a[148:151], a[132:135]
    ds_read_b64_tr_b16 a[202:203], v201 offset:17152
    s_add_u32 s3, s3, 128
    v_mfma_f32_16x16x32_bf16 a[136:139], a[176:179], a[152:155], a[136:139]
    v_mfma_f32_16x16x32_bf16 a[140:143], a[176:179], a[156:159], a[140:143]
    ds_read_b64_tr_b16 a[204:205], v201 offset:29696
    s_waitcnt lgkmcnt(7)
    v_mfma_f32_16x16x32_bf16 a[108:111], a[180:183], a[156:159], a[108:111]
    v_mfma_f32_16x16x32_bf16 a[104:107], a[180:183], a[152:155], a[104:107]
    ds_read_b64_tr_b16 a[206:207], v201 offset:31488
    v_mfma_f32_16x16x32_bf16 a[100:103], a[180:183], a[148:151], a[100:103]
    v_mfma_f32_16x16x32_bf16 a[96:99], a[180:183], a[144:147], a[96:99]
    ds_read_b64_tr_b16 a[176:177], v201 offset:15392
    s_waitcnt lgkmcnt(8)
    v_mfma_f32_16x16x32_bf16 v[0:3], a[160:163], a[184:187], v[0:3]
    v_mfma_f32_16x16x32_bf16 v[4:7], a[164:167], a[184:187], v[4:7]
    ds_read_b64_tr_b16 a[178:179], v201 offset:17184
    v_mfma_f32_16x16x32_bf16 v[8:11], a[168:171], a[184:187], v[8:11]
    v_mfma_f32_16x16x32_bf16 v[12:15], a[172:175], a[184:187], v[12:15]
    ds_read_b64_tr_b16 a[180:181], v201 offset:29728
    s_waitcnt lgkmcnt(9)
    v_mfma_f32_16x16x32_bf16 v[28:31], a[172:175], a[188:191], v[28:31]
    v_mfma_f32_16x16x32_bf16 v[24:27], a[168:171], a[188:191], v[24:27]
    ds_read_b64_tr_b16 a[182:183], v201 offset:31520
    v_mfma_f32_16x16x32_bf16 v[20:23], a[164:167], a[188:191], v[20:23]
    v_mfma_f32_16x16x32_bf16 v[16:19], a[160:163], a[188:191], v[16:19]
    ds_read_b64_tr_b16 a[184:185], v201 offset:15424
    s_waitcnt lgkmcnt(10)
    v_mfma_f32_16x16x32_bf16 v[32:35], a[160:163], a[192:195], v[32:35]
    v_mfma_f32_16x16x32_bf16 v[36:39], a[164:167], a[192:195], v[36:39]
    ds_read_b64_tr_b16 a[186:187], v201 offset:17216
    v_mfma_f32_16x16x32_bf16 v[40:43], a[168:171], a[192:195], v[40:43]
    v_mfma_f32_16x16x32_bf16 v[44:47], a[172:175], a[192:195], v[44:47]
    ds_read_b64_tr_b16 a[188:189], v201 offset:29760
    s_waitcnt lgkmcnt(11)
    v_mfma_f32_16x16x32_bf16 v[60:63], a[172:175], a[196:199], v[60:63]
    v_mfma_f32_16x16x32_bf16 v[56:59], a[168:171], a[196:199], v[56:59]
    ds_read_b64_tr_b16 a[190:191], v201 offset:31552
    v_mfma_f32_16x16x32_bf16 v[52:55], a[164:167], a[196:199], v[52:55]
    v_mfma_f32_16x16x32_bf16 v[48:51], a[160:163], a[196:199], v[48:51]
    ds_read_b64_tr_b16 a[192:193], v201 offset:15456
    s_waitcnt lgkmcnt(11)
    v_mfma_f32_16x16x32_bf16 v[64:67], a[200:203], a[160:163], v[64:67]
    v_mfma_f32_16x16x32_bf16 v[68:71], a[200:203], a[164:167], v[68:71]
    ds_read_b64_tr_b16 a[194:195], v201 offset:17248
    v_mfma_f32_16x16x32_bf16 v[72:75], a[200:203], a[168:171], v[72:75]
    v_mfma_f32_16x16x32_bf16 v[76:79], a[200:203], a[172:175], v[76:79]
    ds_read_b64_tr_b16 a[196:197], v201 offset:29792
    s_waitcnt lgkmcnt(11)
    v_mfma_f32_16x16x32_bf16 a[12:15], a[204:207], a[172:175], a[12:15]
    v_mfma_f32_16x16x32_bf16 a[8:11], a[204:207], a[168:171], a[8:11]
    ds_read_b64_tr_b16 a[198:199], v201 offset:31584
    v_mfma_f32_16x16x32_bf16 a[4:7], a[204:207], a[164:167], a[4:7]
    v_mfma_f32_16x16x32_bf16 a[0:3], a[204:207], a[160:163], a[0:3]
    ds_read_b64_tr_b16 a[200:201], v201 offset:15488
    s_waitcnt lgkmcnt(11)
    v_mfma_f32_16x16x32_bf16 v[80:83], a[176:179], a[160:163], v[80:83]
    v_mfma_f32_16x16x32_bf16 v[84:87], a[176:179], a[164:167], v[84:87]
    ds_read_b64_tr_b16 a[202:203], v201 offset:17280
    v_mfma_f32_16x16x32_bf16 v[88:91], a[176:179], a[168:171], v[88:91]
    v_mfma_f32_16x16x32_bf16 v[92:95], a[176:179], a[172:175], v[92:95]
    ds_read_b64_tr_b16 a[204:205], v201 offset:29824
    s_waitcnt lgkmcnt(11)
    v_mfma_f32_16x16x32_bf16 a[28:31], a[180:183], a[172:175], a[28:31]
    v_mfma_f32_16x16x32_bf16 a[24:27], a[180:183], a[168:171], a[24:27]
    ds_read_b64_tr_b16 a[206:207], v201 offset:31616
    v_mfma_f32_16x16x32_bf16 a[20:23], a[180:183], a[164:167], a[20:23]
    v_mfma_f32_16x16x32_bf16 a[16:19], a[180:183], a[160:163], a[16:19]
    ds_read_b64_tr_b16 a[176:177], v201 offset:15520
    s_waitcnt lgkmcnt(11)
    v_mfma_f32_16x16x32_bf16 v[96:99], a[184:187], a[160:163], v[96:99]
    v_mfma_f32_16x16x32_bf16 v[100:103], a[184:187], a[164:167], v[100:103]
    ds_read_b64_tr_b16 a[178:179], v201 offset:17312
    v_mfma_f32_16x16x32_bf16 v[104:107], a[184:187], a[168:171], v[104:107]
    v_mfma_f32_16x16x32_bf16 v[108:111], a[184:187], a[172:175], v[108:111]
    ds_read_b64_tr_b16 a[180:181], v201 offset:29856
    s_waitcnt lgkmcnt(11)
    v_mfma_f32_16x16x32_bf16 a[44:47], a[188:191], a[172:175], a[44:47]
    v_mfma_f32_16x16x32_bf16 a[40:43], a[188:191], a[168:171], a[40:43]
    ds_read_b64_tr_b16 a[182:183], v201 offset:31648
    v_mfma_f32_16x16x32_bf16 a[36:39], a[188:191], a[164:167], a[36:39]
    v_mfma_f32_16x16x32_bf16 a[32:35], a[188:191], a[160:163], a[32:35]
    ds_read_b64_tr_b16 a[184:185], v201 offset:15552
    s_waitcnt lgkmcnt(11)
    v_mfma_f32_16x16x32_bf16 v[112:115], a[192:195], a[160:163], v[112:115]
    v_mfma_f32_16x16x32_bf16 v[116:119], a[192:195], a[164:167], v[116:119]
    ds_read_b64_tr_b16 a[186:187], v201 offset:17344
    v_mfma_f32_16x16x32_bf16 v[120:123], a[192:195], a[168:171], v[120:123]
    v_mfma_f32_16x16x32_bf16 v[124:127], a[192:195], a[172:175], v[124:127]
    ds_read_b64_tr_b16 a[188:189], v201 offset:29888
    s_waitcnt lgkmcnt(11)
    v_mfma_f32_16x16x32_bf16 a[60:63], a[196:199], a[172:175], a[60:63]
    v_mfma_f32_16x16x32_bf16 a[56:59], a[196:199], a[168:171], a[56:59]
    ds_read_b64_tr_b16 a[190:191], v201 offset:31680
    v_mfma_f32_16x16x32_bf16 a[52:55], a[196:199], a[164:167], a[52:55]
    v_mfma_f32_16x16x32_bf16 a[48:51], a[196:199], a[160:163], a[48:51]
    s_waitcnt lgkmcnt(10)
    v_mfma_f32_16x16x32_bf16 v[128:131], a[200:203], a[160:163], v[128:131]
    v_mfma_f32_16x16x32_bf16 v[132:135], a[200:203], a[164:167], v[132:135]
    v_mfma_f32_16x16x32_bf16 v[136:139], a[200:203], a[168:171], v[136:139]
    v_mfma_f32_16x16x32_bf16 v[140:143], a[200:203], a[172:175], v[140:143]
    s_waitcnt lgkmcnt(8)
    v_mfma_f32_16x16x32_bf16 a[76:79], a[204:207], a[172:175], a[76:79]
    v_mfma_f32_16x16x32_bf16 a[72:75], a[204:207], a[168:171], a[72:75]
    v_mfma_f32_16x16x32_bf16 a[68:71], a[204:207], a[164:167], a[68:71]
    v_mfma_f32_16x16x32_bf16 a[64:67], a[204:207], a[160:163], a[64:67]
    s_waitcnt vmcnt(2) lgkmcnt(0)
    s_barrier
    ds_read_b128 a[144:147], v198 offset:0
    v_mfma_f32_16x16x32_bf16 a[112:115], a[176:179], a[160:163], a[112:115]
    ds_read_b128 a[148:151], v198 offset:2048
    s_mov_b32 m0, s74
    v_mfma_f32_16x16x32_bf16 a[116:119], a[176:179], a[164:167], a[116:119]
    ds_read_b128 a[152:155], v198 offset:4096
    buffer_load_dwordx4 v184, s[8:11], s32 offen offset:0 lds
    v_mfma_f32_16x16x32_bf16 a[120:123], a[176:179], a[168:171], a[120:123]
    ds_read_b128 a[156:159], v198 offset:6144
    v_mfma_f32_16x16x32_bf16 a[124:127], a[176:179], a[172:175], a[124:127]
    ds_read_b128 a[192:195], v194 offset:0
    v_mfma_f32_16x16x32_bf16 a[92:95], a[180:183], a[172:175], a[92:95]
    ds_read_b128 a[196:199], v194 offset:4096
    v_mfma_f32_16x16x32_bf16 a[88:91], a[180:183], a[168:171], a[88:91]
    ds_read_b128 a[200:203], v194 offset:2048
    buffer_load_dwordx4 v185, s[8:11], s32 offen offset:1024 lds
    v_mfma_f32_16x16x32_bf16 a[84:87], a[180:183], a[164:167], a[84:87]
    ds_read_b128 a[204:207], v194 offset:6144
    v_mfma_f32_16x16x32_bf16 a[80:83], a[180:183], a[160:163], a[80:83]
    ds_read_b64_tr_b16 a[176:177], v202 offset:8192
    v_mfma_f32_16x16x32_bf16 a[128:131], a[184:187], a[160:163], a[128:131]
    ds_read_b64_tr_b16 a[178:179], v202 offset:9984
    v_mfma_f32_16x16x32_bf16 a[132:135], a[184:187], a[164:167], a[132:135]
    ds_read_b64_tr_b16 a[180:181], v202 offset:22528
    buffer_load_dwordx4 v186, s[8:11], s32 offen offset:2048 lds
    v_mfma_f32_16x16x32_bf16 a[136:139], a[184:187], a[168:171], a[136:139]
    ds_read_b64_tr_b16 a[182:183], v202 offset:24320
    v_mfma_f32_16x16x32_bf16 a[140:143], a[184:187], a[172:175], a[140:143]
    v_mfma_f32_16x16x32_bf16 a[108:111], a[188:191], a[172:175], a[108:111]
    v_mfma_f32_16x16x32_bf16 a[104:107], a[188:191], a[168:171], a[104:107]
    buffer_load_dwordx4 v187, s[8:11], s32 offen offset:3072 lds
    v_mfma_f32_16x16x32_bf16 a[100:103], a[188:191], a[164:167], a[100:103]
    v_mfma_f32_16x16x32_bf16 a[96:99], a[188:191], a[160:163], a[96:99]
    ds_read_b64_tr_b16 a[184:185], v202 offset:8224
    s_waitcnt lgkmcnt(8)
    v_mfma_f32_16x16x32_bf16 v[0:3], a[144:147], a[192:195], v[0:3]
    v_mfma_f32_16x16x32_bf16 v[4:7], a[148:151], a[192:195], v[4:7]
    ds_read_b64_tr_b16 a[186:187], v202 offset:10016
    s_mov_b32 m0, s76
    v_mfma_f32_16x16x32_bf16 v[8:11], a[152:155], a[192:195], v[8:11]
    buffer_load_dwordx4 v188, s[8:11], s32 offen offset:0 lds
    v_mfma_f32_16x16x32_bf16 v[12:15], a[156:159], a[192:195], v[12:15]
    ds_read_b64_tr_b16 a[188:189], v202 offset:22560
    s_waitcnt lgkmcnt(9)
    v_mfma_f32_16x16x32_bf16 v[28:31], a[156:159], a[196:199], v[28:31]
    v_mfma_f32_16x16x32_bf16 v[24:27], a[152:155], a[196:199], v[24:27]
    ds_read_b64_tr_b16 a[190:191], v202 offset:24352
    v_mfma_f32_16x16x32_bf16 v[20:23], a[148:151], a[196:199], v[20:23]
    buffer_load_dwordx4 v189, s[8:11], s32 offen offset:1024 lds
    v_mfma_f32_16x16x32_bf16 v[16:19], a[144:147], a[196:199], v[16:19]
    ds_read_b64_tr_b16 a[192:193], v202 offset:8256
    s_waitcnt lgkmcnt(10)
    v_mfma_f32_16x16x32_bf16 v[32:35], a[144:147], a[200:203], v[32:35]
    ds_read_b128 a[160:163], v200 offset:0
    v_mfma_f32_16x16x32_bf16 v[36:39], a[148:151], a[200:203], v[36:39]
    ds_read_b64_tr_b16 a[194:195], v202 offset:10048
    v_mfma_f32_16x16x32_bf16 v[40:43], a[152:155], a[200:203], v[40:43]
    buffer_load_dwordx4 v190, s[8:11], s32 offen offset:2048 lds
    v_mfma_f32_16x16x32_bf16 v[44:47], a[156:159], a[200:203], v[44:47]
    ds_read_b64_tr_b16 a[196:197], v202 offset:22592
    s_waitcnt lgkmcnt(12)
    v_mfma_f32_16x16x32_bf16 v[60:63], a[156:159], a[204:207], v[60:63]
    v_mfma_f32_16x16x32_bf16 v[56:59], a[152:155], a[204:207], v[56:59]
    ds_read_b64_tr_b16 a[198:199], v202 offset:24384
    v_mfma_f32_16x16x32_bf16 v[52:55], a[148:151], a[204:207], v[52:55]
    s_mov_b32 m0, s78
    v_mfma_f32_16x16x32_bf16 v[48:51], a[144:147], a[204:207], v[48:51]
    ds_read_b64_tr_b16 a[200:201], v202 offset:8288
    buffer_load_dwordx4 v191, s[12:15], s31 offen offset:0 lds
    s_waitcnt lgkmcnt(12)
    v_mfma_f32_16x16x32_bf16 v[64:67], a[176:179], a[144:147], v[64:67]
    ds_read_b128 a[164:167], v200 offset:2048
    v_mfma_f32_16x16x32_bf16 v[68:71], a[176:179], a[148:151], v[68:71]
    ds_read_b64_tr_b16 a[202:203], v202 offset:10080
    v_mfma_f32_16x16x32_bf16 v[72:75], a[176:179], a[152:155], v[72:75]
    v_mfma_f32_16x16x32_bf16 v[76:79], a[176:179], a[156:159], v[76:79]
    ds_read_b64_tr_b16 a[204:205], v202 offset:22624
    buffer_load_dwordx4 v192, s[12:15], s31 offen offset:1024 lds
    s_waitcnt lgkmcnt(13)
    v_mfma_f32_16x16x32_bf16 a[12:15], a[180:183], a[156:159], a[12:15]
    v_mfma_f32_16x16x32_bf16 a[8:11], a[180:183], a[152:155], a[8:11]
    ds_read_b64_tr_b16 a[206:207], v202 offset:24416
    v_mfma_f32_16x16x32_bf16 a[4:7], a[180:183], a[148:151], a[4:7]
    v_mfma_f32_16x16x32_bf16 a[0:3], a[180:183], a[144:147], a[0:3]
    ds_read_b64_tr_b16 a[176:177], v202 offset:8320
    s_mov_b32 m0, s70
    s_waitcnt lgkmcnt(13)
    v_mfma_f32_16x16x32_bf16 v[80:83], a[184:187], a[144:147], v[80:83]
    ds_read_b128 a[168:171], v200 offset:4096
    buffer_load_dwordx4 v176, s[4:7], s31 offen offset:0 lds
    v_mfma_f32_16x16x32_bf16 v[84:87], a[184:187], a[148:151], v[84:87]
    ds_read_b64_tr_b16 a[178:179], v202 offset:10112
    v_mfma_f32_16x16x32_bf16 v[88:91], a[184:187], a[152:155], v[88:91]
    v_mfma_f32_16x16x32_bf16 v[92:95], a[184:187], a[156:159], v[92:95]
    ds_read_b64_tr_b16 a[180:181], v202 offset:22656
    s_waitcnt lgkmcnt(14)
    v_mfma_f32_16x16x32_bf16 a[28:31], a[188:191], a[156:159], a[28:31]
    buffer_load_dwordx4 v177, s[4:7], s31 offen offset:1024 lds
    v_mfma_f32_16x16x32_bf16 a[24:27], a[188:191], a[152:155], a[24:27]
    ds_read_b64_tr_b16 a[182:183], v202 offset:24448
    v_mfma_f32_16x16x32_bf16 a[20:23], a[188:191], a[148:151], a[20:23]
    v_mfma_f32_16x16x32_bf16 a[16:19], a[188:191], a[144:147], a[16:19]
    ds_read_b64_tr_b16 a[184:185], v202 offset:8352
    s_waitcnt lgkmcnt(13)
    v_mfma_f32_16x16x32_bf16 v[96:99], a[192:195], a[144:147], v[96:99]
    ds_read_b128 a[172:175], v200 offset:6144
    buffer_load_dwordx4 v178, s[4:7], s31 offen offset:2048 lds
    v_mfma_f32_16x16x32_bf16 v[100:103], a[192:195], a[148:151], v[100:103]
    ds_read_b64_tr_b16 a[186:187], v202 offset:10144
    v_mfma_f32_16x16x32_bf16 v[104:107], a[192:195], a[152:155], v[104:107]
    v_mfma_f32_16x16x32_bf16 v[108:111], a[192:195], a[156:159], v[108:111]
    ds_read_b64_tr_b16 a[188:189], v202 offset:22688
    s_waitcnt lgkmcnt(14)
    v_mfma_f32_16x16x32_bf16 a[44:47], a[196:199], a[156:159], a[44:47]
    buffer_load_dwordx4 v179, s[4:7], s31 offen offset:3072 lds
    v_mfma_f32_16x16x32_bf16 a[40:43], a[196:199], a[152:155], a[40:43]
    ds_read_b64_tr_b16 a[190:191], v202 offset:24480
    v_mfma_f32_16x16x32_bf16 a[36:39], a[196:199], a[148:151], a[36:39]
    v_mfma_f32_16x16x32_bf16 a[32:35], a[196:199], a[144:147], a[32:35]
    ds_read_b64_tr_b16 a[192:193], v202 offset:8384
    s_waitcnt lgkmcnt(13)
    v_mfma_f32_16x16x32_bf16 v[112:115], a[200:203], a[144:147], v[112:115]
    s_mov_b32 m0, s72
    v_mfma_f32_16x16x32_bf16 v[116:119], a[200:203], a[148:151], v[116:119]
    ds_read_b64_tr_b16 a[194:195], v202 offset:10176
    buffer_load_dwordx4 v180, s[4:7], s31 offen offset:0 lds
    v_mfma_f32_16x16x32_bf16 v[120:123], a[200:203], a[152:155], v[120:123]
    v_mfma_f32_16x16x32_bf16 v[124:127], a[200:203], a[156:159], v[124:127]
    ds_read_b64_tr_b16 a[196:197], v202 offset:22720
    s_waitcnt lgkmcnt(13)
    v_mfma_f32_16x16x32_bf16 a[60:63], a[204:207], a[156:159], a[60:63]
    v_mfma_f32_16x16x32_bf16 a[56:59], a[204:207], a[152:155], a[56:59]
    ds_read_b64_tr_b16 a[198:199], v202 offset:24512
    buffer_load_dwordx4 v181, s[4:7], s31 offen offset:1024 lds
    v_mfma_f32_16x16x32_bf16 a[52:55], a[204:207], a[148:151], a[52:55]
    v_mfma_f32_16x16x32_bf16 a[48:51], a[204:207], a[144:147], a[48:51]
    ds_read_b128 a[200:203], v196 offset:0
    s_waitcnt lgkmcnt(12)
    v_mfma_f32_16x16x32_bf16 v[128:131], a[176:179], a[144:147], v[128:131]
    v_mfma_f32_16x16x32_bf16 v[132:135], a[176:179], a[148:151], v[132:135]
    buffer_load_dwordx4 v182, s[4:7], s31 offen offset:2048 lds
    v_mfma_f32_16x16x32_bf16 v[136:139], a[176:179], a[152:155], v[136:139]
    v_mfma_f32_16x16x32_bf16 v[140:143], a[176:179], a[156:159], v[140:143]
    ds_read_b128 a[204:207], v196 offset:4096
    s_waitcnt lgkmcnt(11)
    v_mfma_f32_16x16x32_bf16 a[76:79], a[180:183], a[156:159], a[76:79]
    v_mfma_f32_16x16x32_bf16 a[72:75], a[180:183], a[152:155], a[72:75]
    buffer_load_dwordx4 v183, s[4:7], s31 offen offset:3072 lds
    v_mfma_f32_16x16x32_bf16 a[68:71], a[180:183], a[148:151], a[68:71]
    v_mfma_f32_16x16x32_bf16 a[64:67], a[180:183], a[144:147], a[64:67]
    ds_read_b128 a[176:179], v196 offset:2048
    s_waitcnt lgkmcnt(9)
    v_mfma_f32_16x16x32_bf16 a[112:115], a[184:187], a[144:147], a[112:115]
    v_mfma_f32_16x16x32_bf16 a[116:119], a[184:187], a[148:151], a[116:119]
    s_add_u32 s31, s31, 128
    s_add_u32 s32, s32, 0x70000
    buffer_load_dword a255, v203, s[96:99], s34 offen
    v_mfma_f32_16x16x32_bf16 a[120:123], a[184:187], a[152:155], a[120:123]
    v_mfma_f32_16x16x32_bf16 a[124:127], a[184:187], a[156:159], a[124:127]
    ds_read_b128 a[180:183], v196 offset:6144
    s_waitcnt lgkmcnt(8)
    v_mfma_f32_16x16x32_bf16 a[92:95], a[188:191], a[156:159], a[92:95]
    v_mfma_f32_16x16x32_bf16 a[88:91], a[188:191], a[152:155], a[88:91]
    s_add_u32 s34, s34, s35
    buffer_load_dword a255, v235, s[12:15], s3 offen
    v_mfma_f32_16x16x32_bf16 a[84:87], a[188:191], a[148:151], a[84:87]
    v_mfma_f32_16x16x32_bf16 a[80:83], a[188:191], a[144:147], a[80:83]
    ds_read_b64_tr_b16 a[184:185], v202 offset:15360
    s_waitcnt lgkmcnt(7)
    v_mfma_f32_16x16x32_bf16 a[128:131], a[192:195], a[144:147], a[128:131]
    v_mfma_f32_16x16x32_bf16 a[132:135], a[192:195], a[148:151], a[132:135]
    ds_read_b64_tr_b16 a[186:187], v202 offset:17152
    s_add_u32 s3, s3, 128
    v_mfma_f32_16x16x32_bf16 a[136:139], a[192:195], a[152:155], a[136:139]
    v_mfma_f32_16x16x32_bf16 a[140:143], a[192:195], a[156:159], a[140:143]
    ds_read_b64_tr_b16 a[188:189], v202 offset:29696
    s_waitcnt lgkmcnt(7)
    v_mfma_f32_16x16x32_bf16 a[108:111], a[196:199], a[156:159], a[108:111]
    v_mfma_f32_16x16x32_bf16 a[104:107], a[196:199], a[152:155], a[104:107]
    ds_read_b64_tr_b16 a[190:191], v202 offset:31488
    v_mfma_f32_16x16x32_bf16 a[100:103], a[196:199], a[148:151], a[100:103]
    v_mfma_f32_16x16x32_bf16 a[96:99], a[196:199], a[144:147], a[96:99]
    ds_read_b64_tr_b16 a[192:193], v202 offset:15392
    s_waitcnt lgkmcnt(8)
    v_mfma_f32_16x16x32_bf16 v[0:3], a[160:163], a[200:203], v[0:3]
    v_mfma_f32_16x16x32_bf16 v[4:7], a[164:167], a[200:203], v[4:7]
    ds_read_b64_tr_b16 a[194:195], v202 offset:17184
    v_mfma_f32_16x16x32_bf16 v[8:11], a[168:171], a[200:203], v[8:11]
    v_mfma_f32_16x16x32_bf16 v[12:15], a[172:175], a[200:203], v[12:15]
    ds_read_b64_tr_b16 a[196:197], v202 offset:29728
    s_waitcnt lgkmcnt(9)
    v_mfma_f32_16x16x32_bf16 v[28:31], a[172:175], a[204:207], v[28:31]
    v_mfma_f32_16x16x32_bf16 v[24:27], a[168:171], a[204:207], v[24:27]
    ds_read_b64_tr_b16 a[198:199], v202 offset:31520
    v_mfma_f32_16x16x32_bf16 v[20:23], a[164:167], a[204:207], v[20:23]
    v_mfma_f32_16x16x32_bf16 v[16:19], a[160:163], a[204:207], v[16:19]
    ds_read_b64_tr_b16 a[200:201], v202 offset:15424
    s_waitcnt lgkmcnt(10)
    v_mfma_f32_16x16x32_bf16 v[32:35], a[160:163], a[176:179], v[32:35]
    v_mfma_f32_16x16x32_bf16 v[36:39], a[164:167], a[176:179], v[36:39]
    ds_read_b64_tr_b16 a[202:203], v202 offset:17216
    v_mfma_f32_16x16x32_bf16 v[40:43], a[168:171], a[176:179], v[40:43]
    v_mfma_f32_16x16x32_bf16 v[44:47], a[172:175], a[176:179], v[44:47]
    ds_read_b64_tr_b16 a[204:205], v202 offset:29760
    s_waitcnt lgkmcnt(11)
    v_mfma_f32_16x16x32_bf16 v[60:63], a[172:175], a[180:183], v[60:63]
    v_mfma_f32_16x16x32_bf16 v[56:59], a[168:171], a[180:183], v[56:59]
    ds_read_b64_tr_b16 a[206:207], v202 offset:31552
    v_mfma_f32_16x16x32_bf16 v[52:55], a[164:167], a[180:183], v[52:55]
    v_mfma_f32_16x16x32_bf16 v[48:51], a[160:163], a[180:183], v[48:51]
    ds_read_b64_tr_b16 a[176:177], v202 offset:15456
    s_waitcnt lgkmcnt(11)
    v_mfma_f32_16x16x32_bf16 v[64:67], a[184:187], a[160:163], v[64:67]
    v_mfma_f32_16x16x32_bf16 v[68:71], a[184:187], a[164:167], v[68:71]
    ds_read_b64_tr_b16 a[178:179], v202 offset:17248
    v_mfma_f32_16x16x32_bf16 v[72:75], a[184:187], a[168:171], v[72:75]
    v_mfma_f32_16x16x32_bf16 v[76:79], a[184:187], a[172:175], v[76:79]
    ds_read_b64_tr_b16 a[180:181], v202 offset:29792
    s_waitcnt lgkmcnt(11)
    v_mfma_f32_16x16x32_bf16 a[12:15], a[188:191], a[172:175], a[12:15]
    v_mfma_f32_16x16x32_bf16 a[8:11], a[188:191], a[168:171], a[8:11]
    ds_read_b64_tr_b16 a[182:183], v202 offset:31584
    v_mfma_f32_16x16x32_bf16 a[4:7], a[188:191], a[164:167], a[4:7]
    v_mfma_f32_16x16x32_bf16 a[0:3], a[188:191], a[160:163], a[0:3]
    ds_read_b64_tr_b16 a[184:185], v202 offset:15488
    s_waitcnt lgkmcnt(11)
    v_mfma_f32_16x16x32_bf16 v[80:83], a[192:195], a[160:163], v[80:83]
    v_mfma_f32_16x16x32_bf16 v[84:87], a[192:195], a[164:167], v[84:87]
    ds_read_b64_tr_b16 a[186:187], v202 offset:17280
    v_mfma_f32_16x16x32_bf16 v[88:91], a[192:195], a[168:171], v[88:91]
    v_mfma_f32_16x16x32_bf16 v[92:95], a[192:195], a[172:175], v[92:95]
    ds_read_b64_tr_b16 a[188:189], v202 offset:29824
    s_waitcnt lgkmcnt(11)
    v_mfma_f32_16x16x32_bf16 a[28:31], a[196:199], a[172:175], a[28:31]
    v_mfma_f32_16x16x32_bf16 a[24:27], a[196:199], a[168:171], a[24:27]
    ds_read_b64_tr_b16 a[190:191], v202 offset:31616
    v_mfma_f32_16x16x32_bf16 a[20:23], a[196:199], a[164:167], a[20:23]
    v_mfma_f32_16x16x32_bf16 a[16:19], a[196:199], a[160:163], a[16:19]
    ds_read_b64_tr_b16 a[192:193], v202 offset:15520
    s_waitcnt lgkmcnt(11)
    v_mfma_f32_16x16x32_bf16 v[96:99], a[200:203], a[160:163], v[96:99]
    v_mfma_f32_16x16x32_bf16 v[100:103], a[200:203], a[164:167], v[100:103]
    ds_read_b64_tr_b16 a[194:195], v202 offset:17312
    v_mfma_f32_16x16x32_bf16 v[104:107], a[200:203], a[168:171], v[104:107]
    v_mfma_f32_16x16x32_bf16 v[108:111], a[200:203], a[172:175], v[108:111]
    ds_read_b64_tr_b16 a[196:197], v202 offset:29856
    s_waitcnt lgkmcnt(11)
    v_mfma_f32_16x16x32_bf16 a[44:47], a[204:207], a[172:175], a[44:47]
    v_mfma_f32_16x16x32_bf16 a[40:43], a[204:207], a[168:171], a[40:43]
    ds_read_b64_tr_b16 a[198:199], v202 offset:31648
    v_mfma_f32_16x16x32_bf16 a[36:39], a[204:207], a[164:167], a[36:39]
    v_mfma_f32_16x16x32_bf16 a[32:35], a[204:207], a[160:163], a[32:35]
    ds_read_b64_tr_b16 a[200:201], v202 offset:15552
    s_waitcnt lgkmcnt(11)
    v_mfma_f32_16x16x32_bf16 v[112:115], a[176:179], a[160:163], v[112:115]
    v_mfma_f32_16x16x32_bf16 v[116:119], a[176:179], a[164:167], v[116:119]
    ds_read_b64_tr_b16 a[202:203], v202 offset:17344
    v_mfma_f32_16x16x32_bf16 v[120:123], a[176:179], a[168:171], v[120:123]
    v_mfma_f32_16x16x32_bf16 v[124:127], a[176:179], a[172:175], v[124:127]
    ds_read_b64_tr_b16 a[204:205], v202 offset:29888
    s_waitcnt lgkmcnt(11)
    v_mfma_f32_16x16x32_bf16 a[60:63], a[180:183], a[172:175], a[60:63]
    v_mfma_f32_16x16x32_bf16 a[56:59], a[180:183], a[168:171], a[56:59]
    ds_read_b64_tr_b16 a[206:207], v202 offset:31680
    v_mfma_f32_16x16x32_bf16 a[52:55], a[180:183], a[164:167], a[52:55]
    v_mfma_f32_16x16x32_bf16 a[48:51], a[180:183], a[160:163], a[48:51]
    s_waitcnt lgkmcnt(10)
    v_mfma_f32_16x16x32_bf16 v[128:131], a[184:187], a[160:163], v[128:131]
    v_mfma_f32_16x16x32_bf16 v[132:135], a[184:187], a[164:167], v[132:135]
    v_mfma_f32_16x16x32_bf16 v[136:139], a[184:187], a[168:171], v[136:139]
    v_mfma_f32_16x16x32_bf16 v[140:143], a[184:187], a[172:175], v[140:143]
    s_waitcnt lgkmcnt(8)
    v_mfma_f32_16x16x32_bf16 a[76:79], a[188:191], a[172:175], a[76:79]
    v_mfma_f32_16x16x32_bf16 a[72:75], a[188:191], a[168:171], a[72:75]
    v_mfma_f32_16x16x32_bf16 a[68:71], a[188:191], a[164:167], a[68:71]
    v_mfma_f32_16x16x32_bf16 a[64:67], a[188:191], a[160:163], a[64:67]
    s_waitcnt vmcnt(2) lgkmcnt(0)
    s_barrier
    s_sub_u32 s33, s33, 1
    s_cmp_lg_u32 s33, 0
    s_cbranch_scc1 k1_loop
    ds_read_b128 a[144:147], v197 offset:0
    v_mfma_f32_16x16x32_bf16 a[112:115], a[192:195], a[160:163], a[112:115]
    ds_read_b128 a[148:151], v197 offset:2048
    s_mov_b32 m0, s75
    v_mfma_f32_16x16x32_bf16 a[116:119], a[192:195], a[164:167], a[116:119]
    ds_read_b128 a[152:155], v197 offset:4096
    buffer_load_dwordx4 v184, s[8:11], s32 offen offset:0 lds
    v_mfma_f32_16x16x32_bf16 a[120:123], a[192:195], a[168:171], a[120:123]
    ds_read_b128 a[156:159], v197 offset:6144
    v_mfma_f32_16x16x32_bf16 a[124:127], a[192:195], a[172:175], a[124:127]
    ds_read_b64_tr_b16 a[176:177], v201 offset:8192
    v_mfma_f32_16x16x32_bf16 a[92:95], a[196:199], a[172:175], a[92:95]
    ds_read_b64_tr_b16 a[178:179], v201 offset:9984
    buffer_load_dwordx4 v185, s[8:11], s32 offen offset:1024 lds
    v_mfma_f32_16x16x32_bf16 a[88:91], a[196:199], a[168:171], a[88:91]
    ds_read_b64_tr_b16 a[180:181], v201 offset:22528
    v_mfma_f32_16x16x32_bf16 a[84:87], a[196:199], a[164:167], a[84:87]
    ds_read_b64_tr_b16 a[182:183], v201 offset:24320
    v_mfma_f32_16x16x32_bf16 a[80:83], a[196:199], a[160:163], a[80:83]
    ds_read_b64_tr_b16 a[184:185], v201 offset:8224
    buffer_load_dwordx4 v186, s[8:11], s32 offen offset:2048 lds
    v_mfma_f32_16x16x32_bf16 a[128:131], a[200:203], a[160:163], a[128:131]
    ds_read_b64_tr_b16 a[186:187], v201 offset:10016
    v_mfma_f32_16x16x32_bf16 a[132:135], a[200:203], a[164:167], a[132:135]
    ds_read_b64_tr_b16 a[188:189], v201 offset:22560
    v_mfma_f32_16x16x32_bf16 a[136:139], a[200:203], a[168:171], a[136:139]
    ds_read_b64_tr_b16 a[190:191], v201 offset:24352
    buffer_load_dwordx4 v187, s[8:11], s32 offen offset:3072 lds
    v_mfma_f32_16x16x32_bf16 a[140:143], a[200:203], a[172:175], a[140:143]
    ds_read_b64_tr_b16 a[192:193], v201 offset:8256
    v_mfma_f32_16x16x32_bf16 a[108:111], a[204:207], a[172:175], a[108:111]
    ds_read_b64_tr_b16 a[194:195], v201 offset:10048
    v_mfma_f32_16x16x32_bf16 a[104:107], a[204:207], a[168:171], a[104:107]
    ds_read_b64_tr_b16 a[196:197], v201 offset:22592
    s_mov_b32 m0, s77
    v_mfma_f32_16x16x32_bf16 a[100:103], a[204:207], a[164:167], a[100:103]
    ds_read_b64_tr_b16 a[198:199], v201 offset:24384
    buffer_load_dwordx4 v188, s[8:11], s32 offen offset:0 lds
    v_mfma_f32_16x16x32_bf16 a[96:99], a[204:207], a[160:163], a[96:99]
    ds_read_b64_tr_b16 a[200:201], v201 offset:8288
    s_waitcnt lgkmcnt(11)
    v_mfma_f32_16x16x32_bf16 v[64:67], a[176:179], a[144:147], v[64:67]
    v_mfma_f32_16x16x32_bf16 v[68:71], a[176:179], a[148:151], v[68:71]
    ds_read_b64_tr_b16 a[202:203], v201 offset:10080
    buffer_load_dwordx4 v189, s[8:11], s32 offen offset:1024 lds
    v_mfma_f32_16x16x32_bf16 v[72:75], a[176:179], a[152:155], v[72:75]
    v_mfma_f32_16x16x32_bf16 v[76:79], a[176:179], a[156:159], v[76:79]
    ds_read_b64_tr_b16 a[204:205], v201 offset:22624
    s_waitcnt lgkmcnt(11)
    v_mfma_f32_16x16x32_bf16 a[12:15], a[180:183], a[156:159], a[12:15]
    buffer_load_dwordx4 v190, s[8:11], s32 offen offset:2048 lds
    v_mfma_f32_16x16x32_bf16 a[8:11], a[180:183], a[152:155], a[8:11]
    ds_read_b64_tr_b16 a[206:207], v201 offset:24416
    v_mfma_f32_16x16x32_bf16 a[4:7], a[180:183], a[148:151], a[4:7]
    v_mfma_f32_16x16x32_bf16 a[0:3], a[180:183], a[144:147], a[0:3]
    ds_read_b128 a[176:179], v193 offset:0
    s_mov_b32 m0, s79
    s_waitcnt lgkmcnt(11)
    v_mfma_f32_16x16x32_bf16 v[80:83], a[184:187], a[144:147], v[80:83]
    ds_read_b128 a[160:163], v199 offset:0
    buffer_load_dwordx4 v191, s[12:15], s31 offen offset:0 lds
    v_mfma_f32_16x16x32_bf16 v[84:87], a[184:187], a[148:151], v[84:87]
    v_mfma_f32_16x16x32_bf16 v[88:91], a[184:187], a[152:155], v[88:91]
    v_mfma_f32_16x16x32_bf16 v[92:95], a[184:187], a[156:159], v[92:95]
    ds_read_b128 a[180:183], v193 offset:4096
    buffer_load_dwordx4 v192, s[12:15], s31 offen offset:1024 lds
    s_waitcnt lgkmcnt(11)
    v_mfma_f32_16x16x32_bf16 a[28:31], a[188:191], a[156:159], a[28:31]
    v_mfma_f32_16x16x32_bf16 a[24:27], a[188:191], a[152:155], a[24:27]
    v_mfma_f32_16x16x32_bf16 a[20:23], a[188:191], a[148:151], a[20:23]
    s_mov_b32 m0, s71
    v_mfma_f32_16x16x32_bf16 a[16:19], a[188:191], a[144:147], a[16:19]
    ds_read_b128 a[184:187], v193 offset:2048
    buffer_load_dwordx4 v176, s[4:7], s31 offen offset:0 lds
    s_waitcnt lgkmcnt(10)
    v_mfma_f32_16x16x32_bf16 v[96:99], a[192:195], a[144:147], v[96:99]
    ds_read_b128 a[164:167], v199 offset:2048
    v_mfma_f32_16x16x32_bf16 v[100:103], a[192:195], a[148:151], v[100:103]
    v_mfma_f32_16x16x32_bf16 v[104:107], a[192:195], a[152:155], v[104:107]
    buffer_load_dwordx4 v177, s[4:7], s31 offen offset:1024 lds
    v_mfma_f32_16x16x32_bf16 v[108:111], a[192:195], a[156:159], v[108:111]
    ds_read_b128 a[188:191], v193 offset:6144
    s_waitcnt lgkmcnt(10)
    v_mfma_f32_16x16x32_bf16 a[44:47], a[196:199], a[156:159], a[44:47]
    v_mfma_f32_16x16x32_bf16 a[40:43], a[196:199], a[152:155], a[40:43]
    buffer_load_dwordx4 v178, s[4:7], s31 offen offset:2048 lds
    v_mfma_f32_16x16x32_bf16 a[36:39], a[196:199], a[148:151], a[36:39]
    v_mfma_f32_16x16x32_bf16 a[32:35], a[196:199], a[144:147], a[32:35]
    ds_read_b64_tr_b16 a[192:193], v201 offset:15360
    s_waitcnt lgkmcnt(9)
    v_mfma_f32_16x16x32_bf16 v[112:115], a[200:203], a[144:147], v[112:115]
    ds_read_b128 a[168:171], v199 offset:4096
    buffer_load_dwordx4 v179, s[4:7], s31 offen offset:3072 lds
    v_mfma_f32_16x16x32_bf16 v[116:119], a[200:203], a[148:151], v[116:119]
    ds_read_b64_tr_b16 a[194:195], v201 offset:17152
    v_mfma_f32_16x16x32_bf16 v[120:123], a[200:203], a[152:155], v[120:123]
    v_mfma_f32_16x16x32_bf16 v[124:127], a[200:203], a[156:159], v[124:127]
    ds_read_b64_tr_b16 a[196:197], v201 offset:29696
    s_mov_b32 m0, s73
    s_waitcnt lgkmcnt(10)
    v_mfma_f32_16x16x32_bf16 a[60:63], a[204:207], a[156:159], a[60:63]
    buffer_load_dwordx4 v180, s[4:7], s31 offen offset:0 lds
    v_mfma_f32_16x16x32_bf16 a[56:59], a[204:207], a[152:155], a[56:59]
    ds_read_b64_tr_b16 a[198:199], v201 offset:31488
    v_mfma_f32_16x16x32_bf16 a[52:55], a[204:207], a[148:151], a[52:55]
    v_mfma_f32_16x16x32_bf16 a[48:51], a[204:207], a[144:147], a[48:51]
    ds_read_b64_tr_b16 a[200:201], v201 offset:15392
    buffer_load_dwordx4 v181, s[4:7], s31 offen offset:1024 lds
    s_waitcnt lgkmcnt(11)
    v_mfma_f32_16x16x32_bf16 v[0:3], a[144:147], a[176:179], v[0:3]
    ds_read_b128 a[172:175], v199 offset:6144
    v_mfma_f32_16x16x32_bf16 v[4:7], a[148:151], a[176:179], v[4:7]
    ds_read_b64_tr_b16 a[202:203], v201 offset:17184
    v_mfma_f32_16x16x32_bf16 v[8:11], a[152:155], a[176:179], v[8:11]
    buffer_load_dwordx4 v182, s[4:7], s31 offen offset:2048 lds
    v_mfma_f32_16x16x32_bf16 v[12:15], a[156:159], a[176:179], v[12:15]
    ds_read_b64_tr_b16 a[204:205], v201 offset:29728
    s_waitcnt lgkmcnt(12)
    v_mfma_f32_16x16x32_bf16 v[28:31], a[156:159], a[180:183], v[28:31]
    v_mfma_f32_16x16x32_bf16 v[24:27], a[152:155], a[180:183], v[24:27]
    ds_read_b64_tr_b16 a[206:207], v201 offset:31520
    buffer_load_dwordx4 v183, s[4:7], s31 offen offset:3072 lds
    v_mfma_f32_16x16x32_bf16 v[20:23], a[148:151], a[180:183], v[20:23]
    v_mfma_f32_16x16x32_bf16 v[16:19], a[144:147], a[180:183], v[16:19]
    ds_read_b64_tr_b16 a[176:177], v201 offset:15424
    s_waitcnt lgkmcnt(13)
    v_mfma_f32_16x16x32_bf16 v[32:35], a[144:147], a[184:187], v[32:35]
    buffer_load_dword a255, v230, s[24:27], 0 offen
    v_mfma_f32_16x16x32_bf16 v[36:39], a[148:151], a[184:187], v[36:39]
    ds_read_b64_tr_b16 a[178:179], v201 offset:17216
    v_mov_b32 v167, 0
    s_mov_b32 s84, 0
    buffer_load_dword v166, v167, s[20:23], s84 offen sc1
    v_mfma_f32_16x16x32_bf16 v[40:43], a[152:155], a[184:187], v[40:43]
    s_lshr_b32 s80, s2, 3
    s_lshl_b32 s80, s80, 2
    s_add_u32 s80, s80, s28
    s_mul_i32 s80, s80, 384
    v_min_u32 v232, 2, v224
    v_lshl_add_u32 v232, v232, 7, s80
    v_min_u32 v232, 0x9a88, v232
    s_getpc_b64 s[94:95]
k_cp1:
    global_load_dword v232, v232, s[94:95]
    v_mfma_f32_16x16x32_bf16 v[44:47], a[156:159], a[184:187], v[44:47]
    ds_read_b64_tr_b16 a[180:181], v201 offset:29760
    v_lshlrev_b32 v250, 16, v250
    v_lshlrev_b32 v251, 16, v251
    s_waitcnt lgkmcnt(13)
    v_mfma_f32_16x16x32_bf16 v[60:63], a[156:159], a[188:191], v[60:63]
    v_lshlrev_b32 v252, 16, v252
    v_lshlrev_b32 v253, 16, v253
    v_lshlrev_b32 v254, 16, v254
    v_mfma_f32_16x16x32_bf16 v[56:59], a[152:155], a[188:191], v[56:59]
    ds_read_b64_tr_b16 a[182:183], v201 offset:31552
    v_lshlrev_b32 v255, 16, v255
    v_mul_f32 v144, 0x3fb8aa3b, v254
    v_mfma_f32_16x16x32_bf16 v[52:55], a[148:151], a[188:191], v[52:55]
    v_exp_f32 v144, v144
    s_nop 0
    v_mfma_f32_16x16x32_bf16 v[48:51], a[144:147], a[188:191], v[48:51]
    ds_read_b64_tr_b16 a[184:185], v201 offset:15456
    v_cvt_pk_bf16_f32 v144, v144, v144
    v_lshlrev_b32 v144, 16, v144
    s_waitcnt lgkmcnt(12)
    v_mfma_f32_16x16x32_bf16 v[64:67], a[192:195], a[160:163], v[64:67]
    v_mul_f32 v145, v144, v250
    v_mul_f32 v146, v144, v252
    v_mul_f32 v145, 0x3fb8aa3b, v145
    v_mfma_f32_16x16x32_bf16 v[68:71], a[192:195], a[164:167], v[68:71]
    ds_read_b64_tr_b16 a[186:187], v201 offset:17248
    v_exp_f32 v145, v145
    v_mul_f32 v146, 0.15915494, v146
    v_mfma_f32_16x16x32_bf16 v[72:75], a[192:195], a[168:171], v[72:75]
    v_fract_f32 v146, v146
    v_cos_f32 v147, v146
    v_sin_f32 v146, v146
    s_nop 0
    s_waitcnt lgkmcnt(9)
    v_mfma_f32_16x16x32_bf16 v[76:79], a[192:195], a[172:175], v[76:79]
    ds_read_b64_tr_b16 a[188:189], v201 offset:29792
    v_mul_f32 v204, v145, v147
    v_mul_f32 v205, v145, v146
    v_mfma_f32_16x16x32_bf16 a[12:15], a[196:199], a[172:175], a[12:15]
    v_add_f32 v144, -1.0, v204
    v_mul_f32 v145, v250, v250
    v_fmac_f32 v145, v252, v252
    v_mfma_f32_16x16x32_bf16 a[8:11], a[196:199], a[168:171], a[8:11]
    ds_read_b64_tr_b16 a[190:191], v201 offset:31584
    v_rcp_f32 v145, v145
    v_mul_f32 v146, v144, v250
    v_mfma_f32_16x16x32_bf16 a[4:7], a[196:199], a[164:167], a[4:7]
    v_fmac_f32 v146, v205, v252
    v_mul_f32 v147, v205, v250
    v_fma_f32 v147, -v144, v252, v147
    v_mfma_f32_16x16x32_bf16 a[0:3], a[196:199], a[160:163], a[0:3]
    ds_read_b128 a[192:195], v195 offset:0
    v_mul_f32 v208, v146, v145
    v_mul_f32 v209, v147, v145
    s_waitcnt lgkmcnt(11)
    v_mfma_f32_16x16x32_bf16 v[80:83], a[200:203], a[160:163], v[80:83]
    v_mul_f32 v144, v205, v205
    v_mul_f32 v145, v204, v205
    v_fma_f32 v148, v204, v204, -v144
    v_mfma_f32_16x16x32_bf16 v[84:87], a[200:203], a[164:167], v[84:87]
    v_add_f32 v149, v145, v145
    v_mul_f32 v144, v149, v149
    v_mul_f32 v145, v148, v149
    v_mfma_f32_16x16x32_bf16 v[88:91], a[200:203], a[168:171], v[88:91]
    v_fma_f32 v148, v148, v148, -v144
    v_add_f32 v149, v145, v145
    v_mul_f32 v144, v149, v149
    v_mfma_f32_16x16x32_bf16 v[92:95], a[200:203], a[172:175], v[92:95]
    ds_read_b128 a[196:199], v195 offset:4096
    v_mul_f32 v145, v148, v149
    v_fma_f32 v244, v148, v148, -v144
    s_waitcnt lgkmcnt(10)
    v_mfma_f32_16x16x32_bf16 a[28:31], a[204:207], a[172:175], a[28:31]
    v_add_f32 v246, v145, v145
    v_mul_f32 v144, v246, v246
    v_mul_f32 v145, v244, v246
    v_mfma_f32_16x16x32_bf16 a[24:27], a[204:207], a[168:171], a[24:27]
    v_fma_f32 v212, v244, v244, -v144
    v_add_f32 v214, v145, v145
    v_mov_b32 v220, 1.0
    v_mfma_f32_16x16x32_bf16 a[20:23], a[204:207], a[164:167], a[20:23]
    v_mov_b32 v222, 0
    v_and_b32 v146, 1, v225
    v_cmp_ne_u32 vcc, 0, v146
    v_mfma_f32_16x16x32_bf16 a[16:19], a[204:207], a[160:163], a[16:19]
    ds_read_b128 a[200:203], v195 offset:2048
    v_mul_f32 v146, v220, v212
    v_fma_f32 v146, -v222, v214, v146
    s_waitcnt lgkmcnt(9)
    v_mfma_f32_16x16x32_bf16 v[96:99], a[176:179], a[160:163], v[96:99]
    v_mul_f32 v147, v220, v214
    v_fmac_f32 v147, v222, v212
    v_cndmask_b32 v220, v220, v146, vcc
    v_mfma_f32_16x16x32_bf16 v[100:103], a[176:179], a[164:167], v[100:103]
    v_cndmask_b32 v222, v222, v147, vcc
    v_mul_f32 v144, v214, v214
    v_mul_f32 v145, v212, v214
    v_mfma_f32_16x16x32_bf16 v[104:107], a[176:179], a[168:171], v[104:107]
    v_fma_f32 v148, v212, v212, -v144
    v_add_f32 v149, v145, v145
    v_and_b32 v146, 2, v225
    v_mfma_f32_16x16x32_bf16 v[108:111], a[176:179], a[172:175], v[108:111]
    ds_read_b128 a[204:207], v195 offset:6144
    v_cmp_ne_u32 vcc, 0, v146
    v_mul_f32 v146, v220, v148
    s_waitcnt lgkmcnt(8)
    v_mfma_f32_16x16x32_bf16 a[44:47], a[180:183], a[172:175], a[44:47]
    v_fma_f32 v146, -v222, v149, v146
    v_mul_f32 v147, v220, v149
    v_fmac_f32 v147, v222, v148
    v_mfma_f32_16x16x32_bf16 a[40:43], a[180:183], a[168:171], a[40:43]
    v_cndmask_b32 v220, v220, v146, vcc
    v_cndmask_b32 v222, v222, v147, vcc
    v_mul_f32 v144, v149, v149
    v_mfma_f32_16x16x32_bf16 a[36:39], a[180:183], a[164:167], a[36:39]
    v_mul_f32 v145, v148, v149
    v_fma_f32 v148, v148, v148, -v144
    v_add_f32 v149, v145, v145
    v_mfma_f32_16x16x32_bf16 a[32:35], a[180:183], a[160:163], a[32:35]
    s_waitcnt vmcnt(3)
    s_barrier
    ds_read_b64_tr_b16 a[176:177], v202 offset:8192
    v_and_b32 v146, 4, v225
    s_waitcnt lgkmcnt(7)
    v_mfma_f32_16x16x32_bf16 v[112:115], a[184:187], a[160:163], v[112:115]
    ds_read_b128 a[208:211], v198 offset:0
    v_cmp_ne_u32 vcc, 0, v146
    v_mul_f32 v146, v220, v148
    v_mfma_f32_16x16x32_bf16 v[116:119], a[184:187], a[164:167], v[116:119]
    ds_read_b64_tr_b16 a[178:179], v202 offset:9984
    v_fma_f32 v146, -v222, v149, v146
    v_mul_f32 v147, v220, v149
    v_mfma_f32_16x16x32_bf16 v[120:123], a[184:187], a[168:171], v[120:123]
    ds_read_b128 a[212:215], v198 offset:2048
    v_fmac_f32 v147, v222, v148
    v_cndmask_b32 v220, v220, v146, vcc
    v_mfma_f32_16x16x32_bf16 v[124:127], a[184:187], a[172:175], v[124:127]
    ds_read_b64_tr_b16 a[180:181], v202 offset:22528
    v_cndmask_b32 v222, v222, v147, vcc
    v_mul_f32 v144, v149, v149
    s_waitcnt lgkmcnt(9)
    v_mfma_f32_16x16x32_bf16 a[60:63], a[188:191], a[172:175], a[60:63]
    ds_read_b128 a[216:219], v198 offset:4096
    v_mul_f32 v145, v148, v149
    v_fma_f32 v148, v148, v148, -v144
    v_mfma_f32_16x16x32_bf16 a[56:59], a[188:191], a[168:171], a[56:59]
    ds_read_b64_tr_b16 a[182:183], v202 offset:24320
    v_add_f32 v149, v145, v145
    v_and_b32 v146, 8, v225
    v_mfma_f32_16x16x32_bf16 a[52:55], a[188:191], a[164:167], a[52:55]
    ds_read_b128 a[220:223], v198 offset:6144
    v_cmp_ne_u32 vcc, 0, v146
    v_mul_f32 v146, v220, v148
    v_mfma_f32_16x16x32_bf16 a[48:51], a[188:191], a[160:163], a[48:51]
    ds_read_b64_tr_b16 a[184:185], v202 offset:8224
    v_fma_f32 v146, -v222, v149, v146
    v_mul_f32 v147, v220, v149
    s_waitcnt lgkmcnt(12)
    v_mfma_f32_16x16x32_bf16 v[0:3], a[160:163], a[192:195], v[0:3]
    ds_read_b128 a[224:227], v200 offset:0
    v_fmac_f32 v147, v222, v148
    v_cndmask_b32 v220, v220, v146, vcc
    v_mfma_f32_16x16x32_bf16 v[4:7], a[164:167], a[192:195], v[4:7]
    ds_read_b64_tr_b16 a[186:187], v202 offset:10016
    v_cndmask_b32 v222, v222, v147, vcc
    v_mul_f32 v144, v149, v149
    v_mfma_f32_16x16x32_bf16 v[8:11], a[168:171], a[192:195], v[8:11]
    ds_read_b128 a[228:231], v200 offset:2048
    v_mul_f32 v145, v148, v149
    v_fma_f32 v216, v148, v148, -v144
    v_mfma_f32_16x16x32_bf16 v[12:15], a[172:175], a[192:195], v[12:15]
    ds_read_b64_tr_b16 a[188:189], v202 offset:22560
    v_add_f32 v218, v145, v145
    v_mul_f32 v152, 0x3fb8aa3b, v255
    s_waitcnt lgkmcnt(15)
    v_mfma_f32_16x16x32_bf16 v[28:31], a[172:175], a[196:199], v[28:31]
    ds_read_b128 a[232:235], v200 offset:4096
    v_exp_f32 v152, v152
    s_nop 0
    v_mfma_f32_16x16x32_bf16 v[24:27], a[168:171], a[196:199], v[24:27]
    ds_read_b64_tr_b16 a[190:191], v202 offset:24352
    v_cvt_pk_bf16_f32 v152, v152, v152
    v_lshlrev_b32 v152, 16, v152
    v_mfma_f32_16x16x32_bf16 v[20:23], a[164:167], a[196:199], v[20:23]
    ds_read_b128 a[236:239], v200 offset:6144
    v_mul_f32 v153, v152, v251
    v_mul_f32 v154, v152, v253
    v_mfma_f32_16x16x32_bf16 v[16:19], a[160:163], a[196:199], v[16:19]
    ds_read_b64_tr_b16 a[192:193], v202 offset:15360
    v_mul_f32 v153, 0x3fb8aa3b, v153
    v_exp_f32 v153, v153
    s_waitcnt lgkmcnt(15)
    v_mfma_f32_16x16x32_bf16 v[32:35], a[160:163], a[200:203], v[32:35]
    v_mul_f32 v154, 0.15915494, v154
    v_fract_f32 v154, v154
    v_cos_f32 v155, v154
    v_mfma_f32_16x16x32_bf16 v[36:39], a[164:167], a[200:203], v[36:39]
    ds_read_b64_tr_b16 a[194:195], v202 offset:17152
    v_sin_f32 v154, v154
    s_nop 0
    v_mfma_f32_16x16x32_bf16 v[40:43], a[168:171], a[200:203], v[40:43]
    v_mul_f32 v206, v153, v155
    v_mul_f32 v207, v153, v154
    v_add_f32 v152, -1.0, v206
    v_mfma_f32_16x16x32_bf16 v[44:47], a[172:175], a[200:203], v[44:47]
    ds_read_b64_tr_b16 a[196:197], v202 offset:29696
    v_mul_f32 v153, v251, v251
    v_fmac_f32 v153, v253, v253
    v_mfma_f32_16x16x32_bf16 v[60:63], a[172:175], a[204:207], v[60:63]
    v_rcp_f32 v153, v153
    v_mul_f32 v154, v152, v251
    v_fmac_f32 v154, v207, v253
    v_mfma_f32_16x16x32_bf16 v[56:59], a[168:171], a[204:207], v[56:59]
    ds_read_b64_tr_b16 a[198:199], v202 offset:31488
    v_mul_f32 v155, v207, v251
    v_fma_f32 v155, -v152, v253, v155
    v_mfma_f32_16x16x32_bf16 v[52:55], a[164:167], a[204:207], v[52:55]
    v_mul_f32 v210, v154, v153
    v_mul_f32 v211, v155, v153
    v_mul_f32 v152, v207, v207
    v_mfma_f32_16x16x32_bf16 v[48:51], a[160:163], a[204:207], v[48:51]
    ds_read_b64_tr_b16 a[200:201], v202 offset:15392
    v_mul_f32 v153, v206, v207
    v_fma_f32 v156, v206, v206, -v152
    s_waitcnt lgkmcnt(15)
    v_mfma_f32_16x16x32_bf16 v[64:67], a[176:179], a[208:211], v[64:67]
    v_add_f32 v157, v153, v153
    v_mul_f32 v152, v157, v157
    v_mul_f32 v153, v156, v157
    v_mfma_f32_16x16x32_bf16 v[68:71], a[176:179], a[212:215], v[68:71]
    ds_read_b64_tr_b16 a[202:203], v202 offset:17184
    v_fma_f32 v156, v156, v156, -v152
    v_add_f32 v157, v153, v153
    v_mfma_f32_16x16x32_bf16 v[72:75], a[176:179], a[216:219], v[72:75]
    v_mul_f32 v152, v157, v157
    v_mul_f32 v153, v156, v157
    v_fma_f32 v245, v156, v156, -v152
    s_waitcnt lgkmcnt(14)
    v_mfma_f32_16x16x32_bf16 v[76:79], a[176:179], a[220:223], v[76:79]
    ds_read_b64_tr_b16 a[204:205], v202 offset:29728
    v_add_f32 v247, v153, v153
    v_mul_f32 v152, v247, v247
    v_mfma_f32_16x16x32_bf16 a[12:15], a[180:183], a[220:223], a[12:15]
    v_mul_f32 v153, v245, v247
    v_fma_f32 v213, v245, v245, -v152
    v_add_f32 v215, v153, v153
    v_mfma_f32_16x16x32_bf16 a[8:11], a[180:183], a[216:219], a[8:11]
    ds_read_b64_tr_b16 a[206:207], v202 offset:31520
    v_mov_b32 v221, 1.0
    v_mov_b32 v223, 0
    v_mfma_f32_16x16x32_bf16 a[4:7], a[180:183], a[212:215], a[4:7]
    v_and_b32 v154, 1, v225
    v_cmp_ne_u32 vcc, 0, v154
    v_mul_f32 v154, v221, v213
    v_mfma_f32_16x16x32_bf16 a[0:3], a[180:183], a[208:211], a[0:3]
    ds_read_b64_tr_b16 a[176:177], v202 offset:8256
    v_fma_f32 v154, -v223, v215, v154
    v_mul_f32 v155, v221, v215
    s_waitcnt lgkmcnt(14)
    v_mfma_f32_16x16x32_bf16 v[80:83], a[184:187], a[208:211], v[80:83]
    v_fmac_f32 v155, v223, v213
    v_cndmask_b32 v221, v221, v154, vcc
    v_cndmask_b32 v223, v223, v155, vcc
    v_mfma_f32_16x16x32_bf16 v[84:87], a[184:187], a[212:215], v[84:87]
    ds_read_b64_tr_b16 a[178:179], v202 offset:10048
    v_mul_f32 v152, v215, v215
    v_mul_f32 v153, v213, v215
    v_mfma_f32_16x16x32_bf16 v[88:91], a[184:187], a[216:219], v[88:91]
    v_fma_f32 v156, v213, v213, -v152
    v_add_f32 v157, v153, v153
    v_and_b32 v154, 2, v225
    v_mfma_f32_16x16x32_bf16 v[92:95], a[184:187], a[220:223], v[92:95]
    ds_read_b64_tr_b16 a[180:181], v202 offset:22592
    v_cmp_ne_u32 vcc, 0, v154
    v_mul_f32 v154, v221, v156
    s_waitcnt lgkmcnt(12)
    v_mfma_f32_16x16x32_bf16 a[28:31], a[188:191], a[220:223], a[28:31]
    v_fma_f32 v154, -v223, v157, v154
    v_mul_f32 v155, v221, v157
    v_fmac_f32 v155, v223, v156
    v_mfma_f32_16x16x32_bf16 a[24:27], a[188:191], a[216:219], a[24:27]
    ds_read_b64_tr_b16 a[182:183], v202 offset:24384
    v_cndmask_b32 v221, v221, v154, vcc
    v_cndmask_b32 v223, v223, v155, vcc
    v_mfma_f32_16x16x32_bf16 a[20:23], a[188:191], a[212:215], a[20:23]
    v_mul_f32 v152, v157, v157
    v_mul_f32 v153, v156, v157
    v_fma_f32 v156, v156, v156, -v152
    v_mfma_f32_16x16x32_bf16 a[16:19], a[188:191], a[208:211], a[16:19]
    ds_read_b64_tr_b16 a[184:185], v202 offset:8288
    v_add_f32 v157, v153, v153
    v_and_b32 v154, 4, v225
    s_waitcnt lgkmcnt(11)
    v_mfma_f32_16x16x32_bf16 v[64:67], a[192:195], a[224:227], v[64:67]
    v_cmp_ne_u32 vcc, 0, v154
    v_mul_f32 v154, v221, v156
    v_fma_f32 v154, -v223, v157, v154
    v_mfma_f32_16x16x32_bf16 v[68:71], a[192:195], a[228:231], v[68:71]
    ds_read_b64_tr_b16 a[186:187], v202 offset:10080
    v_mul_f32 v155, v221, v157
    v_fmac_f32 v155, v223, v156
    v_mfma_f32_16x16x32_bf16 v[72:75], a[192:195], a[232:235], v[72:75]
    v_cndmask_b32 v221, v221, v154, vcc
    v_cndmask_b32 v223, v223, v155, vcc
    v_mul_f32 v152, v157, v157
    v_mfma_f32_16x16x32_bf16 v[76:79], a[192:195], a[236:239], v[76:79]
    ds_read_b64_tr_b16 a[188:189], v202 offset:22624
    v_mul_f32 v153, v156, v157
    v_fma_f32 v156, v156, v156, -v152
    s_waitcnt lgkmcnt(11)
    v_mfma_f32_16x16x32_bf16 a[12:15], a[196:199], a[236:239], a[12:15]
    v_add_f32 v157, v153, v153
    v_and_b32 v154, 8, v225
    v_cmp_ne_u32 vcc, 0, v154
    v_mfma_f32_16x16x32_bf16 a[8:11], a[196:199], a[232:235], a[8:11]
    ds_read_b64_tr_b16 a[190:191], v202 offset:24416
    v_mul_f32 v154, v221, v156
    v_fma_f32 v154, -v223, v157, v154
    v_mfma_f32_16x16x32_bf16 a[4:7], a[196:199], a[228:231], a[4:7]
    v_mul_f32 v155, v221, v157
    v_fmac_f32 v155, v223, v156
    v_cndmask_b32 v221, v221, v154, vcc
    v_mfma_f32_16x16x32_bf16 a[0:3], a[196:199], a[224:227], a[0:3]
    ds_read_b64_tr_b16 a[192:193], v202 offset:15424
    v_cndmask_b32 v223, v223, v155, vcc
    v_mul_f32 v152, v157, v157
    s_waitcnt lgkmcnt(11)
    v_mfma_f32_16x16x32_bf16 v[80:83], a[200:203], a[224:227], v[80:83]
    v_mul_f32 v153, v156, v157
    v_fma_f32 v217, v156, v156, -v152
    v_add_f32 v219, v153, v153
    v_mfma_f32_16x16x32_bf16 v[84:87], a[200:203], a[228:231], v[84:87]
    ds_read_b64_tr_b16 a[194:195], v202 offset:17216
    s_lshl_b32 s80, s29, 2
    s_add_u32 s80, s80, s28
    v_mfma_f32_16x16x32_bf16 v[88:91], a[200:203], a[232:235], v[88:91]
    s_mul_i32 s88, s80, 176
    s_and_b32 s81, s30, 1
    s_mul_i32 s82, s30, 7
    v_mfma_f32_16x16x32_bf16 v[92:95], a[200:203], a[236:239], v[92:95]
    ds_read_b64_tr_b16 a[196:197], v202 offset:29760
    s_add_u32 s83, s82, s81
    s_lshr_b32 s83, s83, 1
    s_waitcnt lgkmcnt(11)
    v_mfma_f32_16x16x32_bf16 a[28:31], a[204:207], a[236:239], a[28:31]
    s_add_u32 s83, s83, s88
    s_lshl_b32 s83, s83, 12
    s_mul_i32 s85, s81, 7
    v_mfma_f32_16x16x32_bf16 a[24:27], a[204:207], a[232:235], a[24:27]
    ds_read_b64_tr_b16 a[198:199], v202 offset:31552
    s_add_u32 s82, s82, 6
    s_sub_u32 s82, s82, s85
    v_mfma_f32_16x16x32_bf16 a[20:23], a[204:207], a[228:231], a[20:23]
    s_lshr_b32 s82, s82, 1
    s_add_u32 s82, s82, s88
    s_lshl_b32 s82, s82, 12
    v_mfma_f32_16x16x32_bf16 a[16:19], a[204:207], a[224:227], a[16:19]
    ds_read_b64_tr_b16 a[200:201], v202 offset:15456
    s_lshl_b32 s81, s81, 9
    s_add_u32 s82, s82, s81
    s_waitcnt lgkmcnt(11)
    v_mfma_f32_16x16x32_bf16 v[96:99], a[176:179], a[208:211], v[96:99]
    s_lshr_b32 s71, s30, 1
    s_lshl_b32 s71, s71, 2
    s_and_b32 s81, s30, 1
    v_mfma_f32_16x16x32_bf16 v[100:103], a[176:179], a[212:215], v[100:103]
    ds_read_b64_tr_b16 a[202:203], v202 offset:17248
    s_add_u32 s71, s71, s81
    s_add_u32 s71, s71, 112
    v_mfma_f32_16x16x32_bf16 v[104:107], a[176:179], a[216:219], v[104:107]
    s_add_u32 s71, s71, s88
    s_lshl_b32 s71, s71, 12
    v_lshlrev_b32 v179, 4, v224
    v_mfma_f32_16x16x32_bf16 v[108:111], a[176:179], a[220:223], v[108:111]
    ds_read_b64_tr_b16 a[204:205], v202 offset:29792
    v_mov_b32 v203, 1
    s_mov_b32 s8, s60
    s_waitcnt lgkmcnt(11)
    v_mfma_f32_16x16x32_bf16 a[44:47], a[180:183], a[220:223], a[44:47]
    s_mov_b32 s9, s61
    s_mov_b32 s10, 0x700000
    s_mov_b32 s11, 0x20000
    v_mfma_f32_16x16x32_bf16 a[40:43], a[180:183], a[216:219], a[40:43]
    ds_read_b64_tr_b16 a[206:207], v202 offset:31584
    s_lshr_b32 s31, s101, 3
    s_and_b32 s32, s101, 7
    v_mfma_f32_16x16x32_bf16 a[36:39], a[180:183], a[212:215], a[36:39]
    s_lshl_b32 s3, s28, 12
    s_add_u32 s3, s3, 0x9000
    s_mul_i32 s34, s100, 0x1c0000
    v_mfma_f32_16x16x32_bf16 a[32:35], a[180:183], a[208:211], a[32:35]
    ds_read_b128 a[176:179], v194 offset:0
    s_lshr_b32 s76, s28, 1
    s_mul_i32 s77, s76, 0x70000
    s_waitcnt lgkmcnt(11)
    v_mfma_f32_16x16x32_bf16 v[112:115], a[184:187], a[208:211], v[112:115]
    s_add_u32 s35, s34, s77
    s_and_b32 s77, s28, 1
    s_mul_i32 s77, s77, 0x6000
    v_mfma_f32_16x16x32_bf16 v[116:119], a[184:187], a[212:215], v[116:119]
    s_sub_u32 s35, s35, s77
    s_lshl_b32 s77, s76, 18
    s_add_u32 s34, s34, s77
    v_mfma_f32_16x16x32_bf16 v[120:123], a[184:187], a[216:219], v[120:123]
    s_lshl_b32 s76, s31, 2
    s_add_u32 s76, s76, s28
    s_mul_i32 s78, s76, 640
    v_mfma_f32_16x16x32_bf16 v[124:127], a[184:187], a[220:223], v[124:127]
    ds_read_b128 a[180:183], v194 offset:4096
    s_mul_i32 s76, s76, 176
    s_mul_i32 s77, s100, 28
    s_waitcnt lgkmcnt(10)
    v_mfma_f32_16x16x32_bf16 a[60:63], a[188:191], a[220:223], a[60:63]
    s_add_u32 s33, s76, s77
    s_lshl_b32 s33, s33, 12
    s_lshl_b32 s77, s100, 5
    v_mfma_f32_16x16x32_bf16 a[56:59], a[188:191], a[216:219], a[56:59]
    s_add_u32 s78, s78, s77
    s_add_u32 s78, s78, 0x1a00000
    v_and_b32 v254, 7, v224
    v_mfma_f32_16x16x32_bf16 a[52:55], a[188:191], a[212:215], a[52:55]
    v_lshlrev_b32 v254, 2, v254
    s_lshl_b32 s76, s100, 1
    s_and_b32 s77, s28, 1
    v_mfma_f32_16x16x32_bf16 a[48:51], a[188:191], a[208:211], a[48:51]
    ds_read_b128 a[184:187], v194 offset:2048
    s_lshl_b32 s77, s77, 15
    s_lshl_b32 s79, s32, 8
    s_waitcnt lgkmcnt(9)
    v_mfma_f32_16x16x32_bf16 v[96:99], a[192:195], a[224:227], v[96:99]
    s_add_u32 s77, s77, s79
    v_lshrrev_b32 v172, 1, v226
    v_xor_b32 v172, v172, v227
    v_mfma_f32_16x16x32_bf16 v[100:103], a[192:195], a[228:231], v[100:103]
    v_add_u32 v172, s76, v172
    v_and_b32 v172, 7, v172
    v_and_b32 v173, 1, v226
    v_mfma_f32_16x16x32_bf16 v[104:107], a[192:195], a[232:235], v[104:107]
    v_lshl_add_u32 v172, v172, 1, v173
    v_lshlrev_b32 v173, 11, v227
    v_lshl_add_u32 v172, v172, 4, v173
    v_mfma_f32_16x16x32_bf16 v[108:111], a[192:195], a[236:239], v[108:111]
    ds_read_b128 a[188:191], v194 offset:6144
    v_add_u32 v172, s77, v172
    v_add_u32 v188, 0x0, v172
    s_waitcnt lgkmcnt(8)
    v_mfma_f32_16x16x32_bf16 a[44:47], a[196:199], a[236:239], a[44:47]
    v_lshrrev_b32 v172, 1, v226
    v_xor_b32 v172, v172, v227
    v_xor_b32 v172, 4, v172
    v_mfma_f32_16x16x32_bf16 a[40:43], a[196:199], a[232:235], a[40:43]
    v_add_u32 v172, s76, v172
    v_and_b32 v172, 7, v172
    v_and_b32 v173, 1, v226
    v_mfma_f32_16x16x32_bf16 a[36:39], a[196:199], a[228:231], a[36:39]
    v_lshl_add_u32 v172, v172, 1, v173
    v_lshlrev_b32 v173, 11, v227
    v_lshl_add_u32 v172, v172, 4, v173
    v_mfma_f32_16x16x32_bf16 a[32:35], a[196:199], a[224:227], a[32:35]
    ds_read_b128 a[192:195], v196 offset:0
    v_add_u32 v172, s77, v172
    v_add_u32 v189, 0x1c00, v172
    s_waitcnt lgkmcnt(7)
    v_mfma_f32_16x16x32_bf16 v[112:115], a[200:203], a[224:227], v[112:115]
    v_lshrrev_b32 v172, 1, v226
    v_xor_b32 v172, v172, v227
    v_add_u32 v172, s76, v172
    v_mfma_f32_16x16x32_bf16 v[116:119], a[200:203], a[228:231], v[116:119]
    v_and_b32 v172, 7, v172
    v_and_b32 v173, 1, v226
    v_lshl_add_u32 v172, v172, 1, v173
    v_mfma_f32_16x16x32_bf16 v[120:123], a[200:203], a[232:235], v[120:123]
    v_lshlrev_b32 v173, 11, v227
    v_lshl_add_u32 v172, v172, 4, v173
    v_add_u32 v172, s77, v172
    v_mfma_f32_16x16x32_bf16 v[124:127], a[200:203], a[236:239], v[124:127]
    ds_read_b128 a[196:199], v196 offset:4096
    v_add_u32 v190, 0x3800, v172
    v_lshrrev_b32 v172, 1, v226
    s_waitcnt lgkmcnt(6)
    v_mfma_f32_16x16x32_bf16 a[60:63], a[204:207], a[236:239], a[60:63]
    v_xor_b32 v172, v172, v227
    v_xor_b32 v172, 4, v172
    v_add_u32 v172, s76, v172
    v_mfma_f32_16x16x32_bf16 a[56:59], a[204:207], a[232:235], a[56:59]
    v_and_b32 v172, 7, v172
    v_and_b32 v173, 1, v226
    v_lshl_add_u32 v172, v172, 1, v173
    v_mfma_f32_16x16x32_bf16 a[52:55], a[204:207], a[228:231], a[52:55]
    v_lshlrev_b32 v173, 11, v227
    v_lshl_add_u32 v172, v172, 4, v173
    v_add_u32 v172, s77, v172
    v_mfma_f32_16x16x32_bf16 a[48:51], a[204:207], a[224:227], a[48:51]
    ds_read_b128 a[200:203], v196 offset:2048
    v_add_u32 v192, 0x5400, v172
    s_movk_i32 s85, 255
    s_waitcnt vmcnt(1)
    v_cmp_lt_u32 vcc, s85, v166
    s_cmp_eq_u64 vcc, -1
    s_cbranch_scc0 chk_1_slow
chk_1_ok:
    s_waitcnt lgkmcnt(6)
    v_mfma_f32_16x16x32_bf16 v[0:3], a[208:211], a[176:179], v[0:3]
    s_add_u32 s84, s83, 4096
    s_add_u32 s86, s83, 8192
    v_accvgpr_read_b32 v168, a0
    v_accvgpr_read_b32 v169, a1
    v_accvgpr_read_b32 v170, a2
    v_accvgpr_read_b32 v171, a3
    v_max_f32 v64, 0, v64
    v_max_f32 v65, 0, v65
    v_mfma_f32_16x16x32_bf16 v[4:7], a[212:215], a[176:179], v[4:7]
    v_max_f32 v66, 0, v66
    v_max_f32 v67, 0, v67
    v_mul_f32 v64, v64, v168
    v_mul_f32 v65, v65, v169
    v_mul_f32 v66, v66, v170
    v_mul_f32 v67, v67, v171
    v_cvt_pk_bf16_f32 v64, v64, v65
    v_cvt_pk_bf16_f32 v65, v66, v67
    v_mfma_f32_16x16x32_bf16 v[8:11], a[216:219], a[176:179], v[8:11]
    v_accvgpr_read_b32 v172, a16
    v_accvgpr_read_b32 v173, a17
    v_accvgpr_read_b32 v174, a18
    v_accvgpr_read_b32 v175, a19
    v_max_f32 v80, 0, v80
    v_max_f32 v81, 0, v81
    v_max_f32 v82, 0, v82
    v_max_f32 v83, 0, v83
    v_mfma_f32_16x16x32_bf16 v[12:15], a[220:223], a[176:179], v[12:15]
    ds_read_b128 a[204:207], v196 offset:6144
    v_mul_f32 v80, v80, v172
    v_mul_f32 v81, v81, v173
    v_mul_f32 v82, v82, v174
    v_mul_f32 v83, v83, v175
    v_cvt_pk_bf16_f32 v66, v80, v81
    v_cvt_pk_bf16_f32 v67, v82, v83
    buffer_store_dwordx4 v[64:67], v179, s[16:19], s83 offen offset:0 sc1
    s_waitcnt lgkmcnt(6)
    v_mfma_f32_16x16x32_bf16 v[28:31], a[220:223], a[180:183], v[28:31]
    v_accvgpr_read_b32 v168, a4
    v_accvgpr_read_b32 v169, a5
    v_accvgpr_read_b32 v170, a6
    v_accvgpr_read_b32 v171, a7
    v_max_f32 v68, 0, v68
    v_max_f32 v69, 0, v69
    v_max_f32 v70, 0, v70
    v_max_f32 v71, 0, v71
    v_mfma_f32_16x16x32_bf16 v[24:27], a[216:219], a[180:183], v[24:27]
    v_mul_f32 v68, v68, v168
    v_mul_f32 v69, v69, v169
    v_mul_f32 v70, v70, v170
    v_mul_f32 v71, v71, v171
    v_cvt_pk_bf16_f32 v68, v68, v69
    v_cvt_pk_bf16_f32 v69, v70, v71
    v_accvgpr_read_b32 v172, a20
    v_accvgpr_read_b32 v173, a21
    v_mfma_f32_16x16x32_bf16 v[20:23], a[212:215], a[180:183], v[20:23]
    v_accvgpr_read_b32 v174, a22
    v_accvgpr_read_b32 v175, a23
    v_max_f32 v84, 0, v84
    v_max_f32 v85, 0, v85
    v_max_f32 v86, 0, v86
    v_max_f32 v87, 0, v87
    v_mul_f32 v84, v84, v172
    v_mul_f32 v85, v85, v173
    v_mfma_f32_16x16x32_bf16 v[16:19], a[208:211], a[180:183], v[16:19]
    ds_read_b64_tr_b16 a[176:177], v201 offset:8320
    v_mul_f32 v86, v86, v174
    v_mul_f32 v87, v87, v175
    v_cvt_pk_bf16_f32 v70, v84, v85
    v_cvt_pk_bf16_f32 v71, v86, v87
    buffer_store_dwordx4 v[68:71], v179, s[16:19], s83 offen offset:1024 sc1
    v_accvgpr_read_b32 v168, a8
    v_accvgpr_read_b32 v169, a9
    s_waitcnt lgkmcnt(6)
    v_mfma_f32_16x16x32_bf16 v[32:35], a[208:211], a[184:187], v[32:35]
    v_accvgpr_read_b32 v170, a10
    v_accvgpr_read_b32 v171, a11
    v_max_f32 v72, 0, v72
    v_max_f32 v73, 0, v73
    v_max_f32 v74, 0, v74
    v_max_f32 v75, 0, v75
    v_mul_f32 v72, v72, v168
    v_mul_f32 v73, v73, v169
    v_mfma_f32_16x16x32_bf16 v[36:39], a[212:215], a[184:187], v[36:39]
    ds_read_b64_tr_b16 a[178:179], v201 offset:10112
    v_mul_f32 v74, v74, v170
    v_mul_f32 v75, v75, v171
    v_cvt_pk_bf16_f32 v72, v72, v73
    v_cvt_pk_bf16_f32 v73, v74, v75
    v_accvgpr_read_b32 v172, a24
    v_accvgpr_read_b32 v173, a25
    v_accvgpr_read_b32 v174, a26
    v_mfma_f32_16x16x32_bf16 v[40:43], a[216:219], a[184:187], v[40:43]
    v_accvgpr_read_b32 v175, a27
    v_max_f32 v88, 0, v88
    v_max_f32 v89, 0, v89
    v_max_f32 v90, 0, v90
    v_max_f32 v91, 0, v91
    v_mul_f32 v88, v88, v172
    v_mul_f32 v89, v89, v173
    v_mul_f32 v90, v90, v174
    v_mfma_f32_16x16x32_bf16 v[44:47], a[220:223], a[184:187], v[44:47]
    ds_read_b64_tr_b16 a[180:181], v201 offset:22656
    v_mul_f32 v91, v91, v175
    v_cvt_pk_bf16_f32 v74, v88, v89
    v_cvt_pk_bf16_f32 v75, v90, v91
    buffer_store_dwordx4 v[72:75], v179, s[16:19], s83 offen offset:2048 sc1
    v_accvgpr_read_b32 v168, a12
    v_accvgpr_read_b32 v169, a13
    v_accvgpr_read_b32 v170, a14
    s_waitcnt lgkmcnt(7)
    v_mfma_f32_16x16x32_bf16 v[60:63], a[220:223], a[188:191], v[60:63]
    v_accvgpr_read_b32 v171, a15
    v_max_f32 v76, 0, v76
    v_max_f32 v77, 0, v77
    v_max_f32 v78, 0, v78
    v_max_f32 v79, 0, v79
    v_mul_f32 v76, v76, v168
    v_mul_f32 v77, v77, v169
    v_mul_f32 v78, v78, v170
    v_mfma_f32_16x16x32_bf16 v[56:59], a[216:219], a[188:191], v[56:59]
    ds_read_b64_tr_b16 a[182:183], v201 offset:24448
    v_mul_f32 v79, v79, v171
    v_cvt_pk_bf16_f32 v76, v76, v77
    v_cvt_pk_bf16_f32 v77, v78, v79
    v_accvgpr_read_b32 v172, a28
    v_accvgpr_read_b32 v173, a29
    v_accvgpr_read_b32 v174, a30
    v_accvgpr_read_b32 v175, a31
    v_mfma_f32_16x16x32_bf16 v[52:55], a[212:215], a[188:191], v[52:55]
    v_max_f32 v92, 0, v92
    v_max_f32 v93, 0, v93
    v_max_f32 v94, 0, v94
    v_max_f32 v95, 0, v95
    v_mul_f32 v92, v92, v172
    v_mul_f32 v93, v93, v173
    v_mul_f32 v94, v94, v174
    v_mul_f32 v95, v95, v175
    v_mfma_f32_16x16x32_bf16 v[48:51], a[208:211], a[188:191], v[48:51]
    ds_read_b64_tr_b16 a[184:185], v201 offset:8352
    v_cvt_pk_bf16_f32 v78, v92, v93
    v_cvt_pk_bf16_f32 v79, v94, v95
    buffer_store_dwordx4 v[76:79], v179, s[16:19], s83 offen offset:3072 sc1
    v_accvgpr_read_b32 v168, a32
    v_accvgpr_read_b32 v169, a33
    v_accvgpr_read_b32 v170, a34
    v_accvgpr_read_b32 v171, a35
    s_waitcnt lgkmcnt(8)
    v_mfma_f32_16x16x32_bf16 v[0:3], a[224:227], a[192:195], v[0:3]
    v_max_f32 v96, 0, v96
    v_max_f32 v97, 0, v97
    v_max_f32 v98, 0, v98
    v_max_f32 v99, 0, v99
    v_mul_f32 v96, v96, v168
    v_mul_f32 v97, v97, v169
    v_mul_f32 v98, v98, v170
    v_mul_f32 v99, v99, v171
    v_mfma_f32_16x16x32_bf16 v[4:7], a[228:231], a[192:195], v[4:7]
    ds_read_b64_tr_b16 a[186:187], v201 offset:10144
    v_cvt_pk_bf16_f32 v96, v96, v97
    v_cvt_pk_bf16_f32 v97, v98, v99
    v_accvgpr_read_b32 v172, a48
    v_accvgpr_read_b32 v173, a49
    v_accvgpr_read_b32 v174, a50
    v_accvgpr_read_b32 v175, a51
    v_max_f32 v112, 0, v112
    v_mfma_f32_16x16x32_bf16 v[8:11], a[232:235], a[192:195], v[8:11]
    v_max_f32 v113, 0, v113
    v_max_f32 v114, 0, v114
    v_max_f32 v115, 0, v115
    v_mul_f32 v112, v112, v172
    v_mul_f32 v113, v113, v173
    v_mul_f32 v114, v114, v174
    v_mul_f32 v115, v115, v175
    v_cvt_pk_bf16_f32 v98, v112, v113
    v_mfma_f32_16x16x32_bf16 v[12:15], a[236:239], a[192:195], v[12:15]
    ds_read_b64_tr_b16 a[188:189], v201 offset:22688
    v_cvt_pk_bf16_f32 v99, v114, v115
    buffer_store_dwordx4 v[96:99], v179, s[16:19], s84 offen offset:0 sc1
    v_accvgpr_read_b32 v168, a36
    v_accvgpr_read_b32 v169, a37
    v_accvgpr_read_b32 v170, a38
    v_accvgpr_read_b32 v171, a39
    v_max_f32 v100, 0, v100
    s_waitcnt lgkmcnt(9)
    v_mfma_f32_16x16x32_bf16 v[28:31], a[236:239], a[196:199], v[28:31]
    v_max_f32 v101, 0, v101
    v_max_f32 v102, 0, v102
    v_max_f32 v103, 0, v103
    v_mul_f32 v100, v100, v168
    v_mul_f32 v101, v101, v169
    v_mul_f32 v102, v102, v170
    v_mul_f32 v103, v103, v171
    v_cvt_pk_bf16_f32 v100, v100, v101
    v_mfma_f32_16x16x32_bf16 v[24:27], a[232:235], a[196:199], v[24:27]
    ds_read_b64_tr_b16 a[190:191], v201 offset:24480
    v_cvt_pk_bf16_f32 v101, v102, v103
    v_accvgpr_read_b32 v172, a52
    v_accvgpr_read_b32 v173, a53
    v_accvgpr_read_b32 v174, a54
    v_accvgpr_read_b32 v175, a55
    v_max_f32 v116, 0, v116
    v_max_f32 v117, 0, v117
    v_mfma_f32_16x16x32_bf16 v[20:23], a[228:231], a[196:199], v[20:23]
    v_max_f32 v118, 0, v118
    v_max_f32 v119, 0, v119
    v_mul_f32 v116, v116, v172
    v_mul_f32 v117, v117, v173
    v_mul_f32 v118, v118, v174
    v_mul_f32 v119, v119, v175
    v_cvt_pk_bf16_f32 v102, v116, v117
    v_cvt_pk_bf16_f32 v103, v118, v119
    v_mfma_f32_16x16x32_bf16 v[16:19], a[224:227], a[196:199], v[16:19]
    ds_read_b64_tr_b16 a[192:193], v201 offset:15488
    buffer_store_dwordx4 v[100:103], v179, s[16:19], s84 offen offset:1024 sc1
    v_accvgpr_read_b32 v168, a40
    v_accvgpr_read_b32 v169, a41
    v_accvgpr_read_b32 v170, a42
    v_accvgpr_read_b32 v171, a43
    v_max_f32 v104, 0, v104
    v_max_f32 v105, 0, v105
    s_waitcnt lgkmcnt(10)
    v_mfma_f32_16x16x32_bf16 v[32:35], a[224:227], a[200:203], v[32:35]
    v_max_f32 v106, 0, v106
    v_max_f32 v107, 0, v107
    v_mul_f32 v104, v104, v168
    v_mul_f32 v105, v105, v169
    v_mul_f32 v106, v106, v170
    v_mul_f32 v107, v107, v171
    v_cvt_pk_bf16_f32 v104, v104, v105
    v_cvt_pk_bf16_f32 v105, v106, v107
    v_mfma_f32_16x16x32_bf16 v[36:39], a[228:231], a[200:203], v[36:39]
    ds_read_b64_tr_b16 a[194:195], v201 offset:17280
    v_accvgpr_read_b32 v172, a56
    v_accvgpr_read_b32 v173, a57
    v_accvgpr_read_b32 v174, a58
    v_accvgpr_read_b32 v175, a59
    v_max_f32 v120, 0, v120
    v_max_f32 v121, 0, v121
    v_max_f32 v122, 0, v122
    v_mfma_f32_16x16x32_bf16 v[40:43], a[232:235], a[200:203], v[40:43]
    v_max_f32 v123, 0, v123
    v_mul_f32 v120, v120, v172
    v_mul_f32 v121, v121, v173
    v_mul_f32 v122, v122, v174
    v_mul_f32 v123, v123, v175
    v_cvt_pk_bf16_f32 v106, v120, v121
    v_cvt_pk_bf16_f32 v107, v122, v123
    buffer_store_dwordx4 v[104:107], v179, s[16:19], s84 offen offset:2048 sc1
    v_mfma_f32_16x16x32_bf16 v[44:47], a[236:239], a[200:203], v[44:47]
    ds_read_b64_tr_b16 a[196:197], v201 offset:29824
    v_accvgpr_read_b32 v168, a44
    v_accvgpr_read_b32 v169, a45
    v_accvgpr_read_b32 v170, a46
    v_accvgpr_read_b32 v171, a47
    v_max_f32 v108, 0, v108
    v_max_f32 v109, 0, v109
    v_max_f32 v110, 0, v110
    s_waitcnt lgkmcnt(11)
    v_mfma_f32_16x16x32_bf16 v[60:63], a[236:239], a[204:207], v[60:63]
    v_max_f32 v111, 0, v111
    v_mul_f32 v108, v108, v168
    v_mul_f32 v109, v109, v169
    v_mul_f32 v110, v110, v170
    v_mul_f32 v111, v111, v171
    v_cvt_pk_bf16_f32 v108, v108, v109
    v_cvt_pk_bf16_f32 v109, v110, v111
    v_accvgpr_read_b32 v172, a60
    v_mfma_f32_16x16x32_bf16 v[56:59], a[232:235], a[204:207], v[56:59]
    ds_read_b64_tr_b16 a[198:199], v201 offset:31616
    v_accvgpr_read_b32 v173, a61
    v_accvgpr_read_b32 v174, a62
    v_accvgpr_read_b32 v175, a63
    v_max_f32 v124, 0, v124
    v_max_f32 v125, 0, v125
    v_max_f32 v126, 0, v126
    v_max_f32 v127, 0, v127
    v_mfma_f32_16x16x32_bf16 v[52:55], a[228:231], a[204:207], v[52:55]
    v_mul_f32 v124, v124, v172
    v_mul_f32 v125, v125, v173
    v_mul_f32 v126, v126, v174
    v_mul_f32 v127, v127, v175
    v_cvt_pk_bf16_f32 v110, v124, v125
    v_cvt_pk_bf16_f32 v111, v126, v127
    buffer_store_dwordx4 v[108:111], v179, s[16:19], s84 offen offset:3072 sc1
    v_mfma_f32_16x16x32_bf16 v[48:51], a[224:227], a[204:207], v[48:51]
    ds_read_b64_tr_b16 a[200:201], v201 offset:15520
    s_waitcnt lgkmcnt(11)
    v_mfma_f32_16x16x32_bf16 v[128:131], a[176:179], a[144:147], v[128:131]
    v_mfma_f32_16x16x32_bf16 v[132:135], a[176:179], a[148:151], v[132:135]
    ds_read_b64_tr_b16 a[202:203], v201 offset:17312
    v_mfma_f32_16x16x32_bf16 v[136:139], a[176:179], a[152:155], v[136:139]
    v_mfma_f32_16x16x32_bf16 v[140:143], a[176:179], a[156:159], v[140:143]
    ds_read_b64_tr_b16 a[204:205], v201 offset:29856
    s_waitcnt lgkmcnt(11)
    v_mfma_f32_16x16x32_bf16 a[76:79], a[180:183], a[156:159], a[76:79]
    v_mfma_f32_16x16x32_bf16 a[72:75], a[180:183], a[152:155], a[72:75]
    ds_read_b64_tr_b16 a[206:207], v201 offset:31648
    v_mfma_f32_16x16x32_bf16 a[68:71], a[180:183], a[148:151], a[68:71]
    v_mfma_f32_16x16x32_bf16 a[64:67], a[180:183], a[144:147], a[64:67]
    ds_read_b64_tr_b16 a[176:177], v202 offset:8320
    s_waitcnt vmcnt(4)
    s_mov_b64 exec, 0x1
    buffer_store_dword v203, v248, s[16:19], 0 offen sc1
    s_mov_b64 exec, -1
    s_waitcnt lgkmcnt(11)
    v_mfma_f32_16x16x32_bf16 a[112:115], a[184:187], a[144:147], a[112:115]
    v_fma_f32 v64, v204, v0, v2
    v_fma_f32 v65, v204, v1, v3
    v_fma_f32 v66, v204, v16, v18
    v_fma_f32 v67, v204, v17, v19
    v_fma_f32 v72, v206, v32, v34
    v_fma_f32 v73, v206, v33, v35
    v_fma_f32 v74, v206, v48, v50
    v_fma_f32 v75, v206, v49, v51
    v_mfma_f32_16x16x32_bf16 a[116:119], a[184:187], a[148:151], a[116:119]
    ds_read_b64_tr_b16 a[178:179], v202 offset:10112
    v_fma_f32 v64, -v205, v16, v64
    v_fma_f32 v65, -v205, v17, v65
    v_fma_f32 v66, v205, v0, v66
    v_fma_f32 v67, v205, v1, v67
    v_fma_f32 v72, -v207, v48, v72
    v_fma_f32 v73, -v207, v49, v73
    v_fma_f32 v74, v207, v32, v74
    v_mfma_f32_16x16x32_bf16 a[120:123], a[184:187], a[152:155], a[120:123]
    v_fma_f32 v75, v207, v33, v75
    v_fma_f32 v68, v204, v64, v4
    v_fma_f32 v69, v204, v65, v5
    v_fma_f32 v70, v204, v66, v20
    v_fma_f32 v71, v204, v67, v21
    v_fma_f32 v76, v206, v72, v36
    v_fma_f32 v77, v206, v73, v37
    v_fma_f32 v78, v206, v74, v52
    v_mfma_f32_16x16x32_bf16 a[124:127], a[184:187], a[156:159], a[124:127]
    ds_read_b64_tr_b16 a[180:181], v202 offset:22656
    v_fma_f32 v79, v206, v75, v53
    v_fma_f32 v68, -v205, v66, v68
    v_fma_f32 v69, -v205, v67, v69
    v_fma_f32 v70, v205, v64, v70
    v_fma_f32 v71, v205, v65, v71
    v_fma_f32 v76, -v207, v74, v76
    v_fma_f32 v77, -v207, v75, v77
    s_waitcnt lgkmcnt(11)
    v_mfma_f32_16x16x32_bf16 a[92:95], a[188:191], a[156:159], a[92:95]
    v_fma_f32 v78, v207, v72, v78
    v_fma_f32 v79, v207, v73, v79
    v_fma_f32 v64, v204, v68, v6
    v_fma_f32 v65, v204, v69, v7
    v_fma_f32 v66, v204, v70, v22
    v_fma_f32 v67, v204, v71, v23
    v_fma_f32 v72, v206, v76, v38
    v_fma_f32 v73, v206, v77, v39
    v_mfma_f32_16x16x32_bf16 a[88:91], a[188:191], a[152:155], a[88:91]
    ds_read_b64_tr_b16 a[182:183], v202 offset:24448
    v_fma_f32 v74, v206, v78, v54
    v_fma_f32 v75, v206, v79, v55
    v_fma_f32 v64, -v205, v70, v64
    v_fma_f32 v65, -v205, v71, v65
    v_fma_f32 v66, v205, v68, v66
    v_fma_f32 v67, v205, v69, v67
    v_fma_f32 v72, -v207, v78, v72
    v_mfma_f32_16x16x32_bf16 a[84:87], a[188:191], a[148:151], a[84:87]
    v_fma_f32 v73, -v207, v79, v73
    v_fma_f32 v74, v207, v76, v74
    v_fma_f32 v75, v207, v77, v75
    v_fma_f32 v68, v204, v64, v8
    v_fma_f32 v69, v204, v65, v9
    v_fma_f32 v70, v204, v66, v24
    v_fma_f32 v71, v204, v67, v25
    v_fma_f32 v76, v206, v72, v40
    v_mfma_f32_16x16x32_bf16 a[80:83], a[188:191], a[144:147], a[80:83]
    ds_read_b64_tr_b16 a[184:185], v202 offset:8352
    v_fma_f32 v77, v206, v73, v41
    v_fma_f32 v78, v206, v74, v56
    v_fma_f32 v79, v206, v75, v57
    v_fma_f32 v68, -v205, v66, v68
    v_fma_f32 v69, -v205, v67, v69
    v_fma_f32 v70, v205, v64, v70
    v_fma_f32 v71, v205, v65, v71
    s_waitcnt lgkmcnt(11)
    v_mfma_f32_16x16x32_bf16 v[128:131], a[192:195], a[160:163], v[128:131]
    v_fma_f32 v76, -v207, v74, v76
    v_fma_f32 v77, -v207, v75, v77
    v_fma_f32 v78, v207, v72, v78
    v_fma_f32 v79, v207, v73, v79
    v_fma_f32 v64, v204, v68, v10
    v_fma_f32 v65, v204, v69, v11
    v_fma_f32 v66, v204, v70, v26
    v_fma_f32 v67, v204, v71, v27
    v_mfma_f32_16x16x32_bf16 v[132:135], a[192:195], a[164:167], v[132:135]
    ds_read_b64_tr_b16 a[186:187], v202 offset:10144
    v_fma_f32 v72, v206, v76, v42
    v_fma_f32 v73, v206, v77, v43
    v_fma_f32 v74, v206, v78, v58
    v_fma_f32 v75, v206, v79, v59
    v_fma_f32 v64, -v205, v70, v64
    v_fma_f32 v65, -v205, v71, v65
    v_fma_f32 v66, v205, v68, v66
    v_mfma_f32_16x16x32_bf16 v[136:139], a[192:195], a[168:171], v[136:139]
    v_fma_f32 v67, v205, v69, v67
    v_fma_f32 v72, -v207, v78, v72
    v_fma_f32 v73, -v207, v79, v73
    v_fma_f32 v74, v207, v76, v74
    v_fma_f32 v75, v207, v77, v75
    v_fma_f32 v68, v204, v64, v12
    v_fma_f32 v69, v204, v65, v13
    v_fma_f32 v70, v204, v66, v28
    v_mfma_f32_16x16x32_bf16 v[140:143], a[192:195], a[172:175], v[140:143]
    ds_read_b64_tr_b16 a[188:189], v202 offset:22688
    v_fma_f32 v71, v204, v67, v29
    v_fma_f32 v76, v206, v72, v44
    v_fma_f32 v77, v206, v73, v45
    v_fma_f32 v78, v206, v74, v60
    v_fma_f32 v79, v206, v75, v61
    v_fma_f32 v68, -v205, v66, v68
    v_fma_f32 v69, -v205, v67, v69
    s_waitcnt lgkmcnt(11)
    v_mfma_f32_16x16x32_bf16 a[76:79], a[196:199], a[172:175], a[76:79]
    v_fma_f32 v70, v205, v64, v70
    v_fma_f32 v71, v205, v65, v71
    v_fma_f32 v76, -v207, v74, v76
    v_fma_f32 v77, -v207, v75, v77
    v_fma_f32 v78, v207, v72, v78
    v_fma_f32 v79, v207, v73, v79
    v_fma_f32 v64, v204, v68, v14
    v_fma_f32 v65, v204, v69, v15
    v_mfma_f32_16x16x32_bf16 a[72:75], a[196:199], a[168:171], a[72:75]
    ds_read_b64_tr_b16 a[190:191], v202 offset:24480
    v_fma_f32 v66, v204, v70, v30
    v_fma_f32 v67, v204, v71, v31
    v_fma_f32 v72, v206, v76, v46
    v_fma_f32 v73, v206, v77, v47
    v_fma_f32 v74, v206, v78, v62
    v_fma_f32 v75, v206, v79, v63
    v_fma_f32 v64, -v205, v70, v64
    v_mfma_f32_16x16x32_bf16 a[68:71], a[196:199], a[164:167], a[68:71]
    v_fma_f32 v65, -v205, v71, v65
    v_fma_f32 v66, v205, v68, v66
    v_fma_f32 v67, v205, v69, v67
    v_fma_f32 v72, -v207, v78, v72
    v_fma_f32 v73, -v207, v79, v73
    v_fma_f32 v74, v207, v76, v74
    v_fma_f32 v75, v207, v77, v75
    v_mov_b32 v228, v64
    v_mfma_f32_16x16x32_bf16 a[64:67], a[196:199], a[160:163], a[64:67]
    ds_read_b64_tr_b16 a[192:193], v202 offset:15488
    v_mov_b32 v230, v66
    v_mov_b32 v80, v65
    v_mov_b32 v82, v67
    v_mov_b32 v229, v72
    v_mov_b32 v231, v74
    v_mov_b32 v81, v73
    v_mov_b32 v83, v75
    s_waitcnt lgkmcnt(11)
    v_mfma_f32_16x16x32_bf16 a[112:115], a[200:203], a[160:163], a[112:115]
    v_fma_f32 v84, v244, v228, v80
    v_fma_f32 v85, v245, v229, v81
    v_fma_f32 v86, v244, v230, v82
    v_fma_f32 v87, v245, v231, v83
    v_fma_f32 v232, -v246, v230, v84
    v_fma_f32 v233, -v247, v231, v85
    v_fma_f32 v234, v246, v228, v86
    v_fma_f32 v235, v247, v229, v87
    v_mfma_f32_16x16x32_bf16 a[116:119], a[200:203], a[164:167], a[116:119]
    ds_read_b64_tr_b16 a[194:195], v202 offset:17280
    v_lshlrev_b32 v178, 4, v226
    v_lshl_add_u32 v176, v225, 8, v178
    v_add_u32 v176, 0x22000, v176
    ds_write_b128 v176, v[232:235] offset:3840
    v_mfma_f32_16x16x32_bf16 a[120:123], a[200:203], a[168:171], a[120:123]
    v_mfma_f32_16x16x32_bf16 a[124:127], a[200:203], a[172:175], a[124:127]
    ds_read_b64_tr_b16 a[196:197], v202 offset:29824
    s_waitcnt lgkmcnt(1)
    s_barrier
    v_mfma_f32_16x16x32_bf16 a[92:95], a[204:207], a[172:175], a[92:95]
    s_add_u32 m0, s3, 0x0
    s_add_u32 s76, s34, 0x0
    v_mfma_f32_16x16x32_bf16 a[88:91], a[204:207], a[168:171], a[88:91]
    ds_read_b64_tr_b16 a[198:199], v202 offset:31616
    v_mfma_f32_16x16x32_bf16 a[84:87], a[204:207], a[164:167], a[84:87]
    buffer_load_dwordx4 v188, s[8:11], s76 offen offset:0 lds
    v_mfma_f32_16x16x32_bf16 a[80:83], a[204:207], a[160:163], a[80:83]
    ds_read_b64_tr_b16 a[200:201], v202 offset:15520
    buffer_load_dwordx4 v189, s[8:11], s76 offen offset:1024 lds
    v_mfma_f32_16x16x32_bf16 v[128:131], a[176:179], a[208:211], v[128:131]
    buffer_load_dwordx4 v190, s[8:11], s76 offen offset:2048 lds
    v_mfma_f32_16x16x32_bf16 v[132:135], a[176:179], a[212:215], v[132:135]
    ds_read_b64_tr_b16 a[202:203], v202 offset:17312
    buffer_load_dwordx4 v192, s[8:11], s76 offen offset:3072 lds
    v_mfma_f32_16x16x32_bf16 v[136:139], a[176:179], a[216:219], v[136:139]
    s_add_u32 m0, s3, 0x4000
    s_add_u32 s76, s34, 0x70000
    v_mfma_f32_16x16x32_bf16 v[140:143], a[176:179], a[220:223], v[140:143]
    ds_read_b64_tr_b16 a[204:205], v202 offset:29856
    v_mfma_f32_16x16x32_bf16 a[76:79], a[180:183], a[220:223], a[76:79]
    buffer_load_dwordx4 v188, s[8:11], s76 offen offset:0 lds
    v_mfma_f32_16x16x32_bf16 a[72:75], a[180:183], a[216:219], a[72:75]
    ds_read_b64_tr_b16 a[206:207], v202 offset:31648
    buffer_load_dwordx4 v189, s[8:11], s76 offen offset:1024 lds
    v_mfma_f32_16x16x32_bf16 a[68:71], a[180:183], a[212:215], a[68:71]
    buffer_load_dwordx4 v190, s[8:11], s76 offen offset:2048 lds
    v_mfma_f32_16x16x32_bf16 a[64:67], a[180:183], a[208:211], a[64:67]
    ds_read_b64_tr_b16 a[176:177], v201 offset:8384
    buffer_load_dwordx4 v192, s[8:11], s76 offen offset:3072 lds
    v_mfma_f32_16x16x32_bf16 a[112:115], a[184:187], a[208:211], a[112:115]
    s_add_u32 m0, s3, 0x8000
    s_add_u32 s76, s34, 0xe0000
    v_mfma_f32_16x16x32_bf16 a[116:119], a[184:187], a[212:215], a[116:119]
    ds_read_b64_tr_b16 a[178:179], v201 offset:10176
    v_mfma_f32_16x16x32_bf16 a[120:123], a[184:187], a[216:219], a[120:123]
    buffer_load_dwordx4 v188, s[8:11], s76 offen offset:0 lds
    v_mfma_f32_16x16x32_bf16 a[124:127], a[184:187], a[220:223], a[124:127]
    ds_read_b64_tr_b16 a[180:181], v201 offset:22720
    buffer_load_dwordx4 v189, s[8:11], s76 offen offset:1024 lds
    v_mfma_f32_16x16x32_bf16 a[92:95], a[188:191], a[220:223], a[92:95]
    buffer_load_dwordx4 v190, s[8:11], s76 offen offset:2048 lds
    v_mfma_f32_16x16x32_bf16 a[88:91], a[188:191], a[216:219], a[88:91]
    ds_read_b64_tr_b16 a[182:183], v201 offset:24512
    buffer_load_dwordx4 v192, s[8:11], s76 offen offset:3072 lds
    v_mfma_f32_16x16x32_bf16 a[84:87], a[188:191], a[212:215], a[84:87]
    s_waitcnt vmcnt(13)
    s_mov_b64 exec, 0x2
    buffer_store_dword v203, v248, s[16:19], 0 offen sc1
    s_mov_b64 exec, -1
    v_mfma_f32_16x16x32_bf16 a[80:83], a[188:191], a[208:211], a[80:83]
    ds_read_b64_tr_b16 a[184:185], v201 offset:15552
    ds_read_b128 v[64:67], v176 offset:0
    ds_read_b128 v[68:71], v176 offset:256
    ds_read_b128 v[72:75], v176 offset:512
    ds_read_b128 v[156:159], v176 offset:768
    ds_read_b128 v[160:163], v176 offset:1024
    ds_read_b128 v[164:167], v176 offset:1280
    v_mfma_f32_16x16x32_bf16 v[128:131], a[192:195], a[224:227], v[128:131]
    v_mfma_f32_16x16x32_bf16 v[132:135], a[192:195], a[228:231], v[132:135]
    ds_read_b64_tr_b16 a[186:187], v201 offset:17344
    v_mfma_f32_16x16x32_bf16 v[136:139], a[192:195], a[232:235], v[136:139]
    v_mfma_f32_16x16x32_bf16 v[140:143], a[192:195], a[236:239], v[140:143]
    ds_read_b64_tr_b16 a[188:189], v201 offset:29888
    s_waitcnt lgkmcnt(7)
    s_waitcnt lgkmcnt(6)
    v_fma_f32 v84, v212, v64, v68
    v_fma_f32 v85, v213, v65, v69
    v_fma_f32 v86, v212, v66, v70
    v_fma_f32 v87, v213, v67, v71
    v_fma_f32 v240, -v214, v66, v84
    v_mfma_f32_16x16x32_bf16 a[76:79], a[196:199], a[236:239], a[76:79]
    v_fma_f32 v241, -v215, v67, v85
    v_fma_f32 v242, v214, v64, v86
    v_fma_f32 v243, v215, v65, v87
    s_waitcnt lgkmcnt(5)
    v_fma_f32 v84, v212, v240, v72
    v_fma_f32 v85, v213, v241, v73
    v_fma_f32 v86, v212, v242, v74
    v_fma_f32 v87, v213, v243, v75
    v_mfma_f32_16x16x32_bf16 a[72:75], a[196:199], a[232:235], a[72:75]
    ds_read_b64_tr_b16 a[190:191], v201 offset:31680
    v_fma_f32 v236, -v214, v242, v84
    v_fma_f32 v237, -v215, v243, v85
    v_fma_f32 v238, v214, v240, v86
    v_fma_f32 v239, v215, v241, v87
    ds_read_b128 v[64:67], v176 offset:1536
    ds_read_b128 v[68:71], v176 offset:1792
    ds_read_b128 v[72:75], v176 offset:2048
    v_mfma_f32_16x16x32_bf16 a[68:71], a[196:199], a[228:231], a[68:71]
    s_waitcnt lgkmcnt(8)
    v_fma_f32 v84, v212, v236, v156
    v_fma_f32 v85, v213, v237, v157
    v_fma_f32 v86, v212, v238, v158
    v_fma_f32 v87, v213, v239, v159
    v_fma_f32 v240, -v214, v238, v84
    v_fma_f32 v241, -v215, v239, v85
    v_fma_f32 v242, v214, v236, v86
    v_mfma_f32_16x16x32_bf16 a[64:67], a[196:199], a[224:227], a[64:67]
    ds_read_b64_tr_b16 a[192:193], v202 offset:8384
    v_fma_f32 v243, v215, v237, v87
    s_waitcnt lgkmcnt(8)
    v_fma_f32 v84, v212, v240, v160
    v_fma_f32 v85, v213, v241, v161
    v_fma_f32 v86, v212, v242, v162
    v_fma_f32 v87, v213, v243, v163
    v_fma_f32 v236, -v214, v242, v84
    v_mfma_f32_16x16x32_bf16 a[112:115], a[200:203], a[224:227], a[112:115]
    v_fma_f32 v237, -v215, v243, v85
    v_fma_f32 v238, v214, v240, v86
    v_fma_f32 v239, v215, v241, v87
    s_waitcnt lgkmcnt(7)
    v_fma_f32 v84, v212, v236, v164
    v_fma_f32 v85, v213, v237, v165
    v_fma_f32 v86, v212, v238, v166
    v_fma_f32 v87, v213, v239, v167
    v_mfma_f32_16x16x32_bf16 a[116:119], a[200:203], a[228:231], a[116:119]
    ds_read_b64_tr_b16 a[194:195], v202 offset:10176
    v_fma_f32 v240, -v214, v238, v84
    v_fma_f32 v241, -v215, v239, v85
    v_fma_f32 v242, v214, v236, v86
    v_fma_f32 v243, v215, v237, v87
    ds_read_b128 v[156:159], v176 offset:2304
    ds_read_b128 v[160:163], v176 offset:2560
    ds_read_b128 v[164:167], v176 offset:2816
    v_mfma_f32_16x16x32_bf16 a[120:123], a[200:203], a[232:235], a[120:123]
    s_waitcnt lgkmcnt(7)
    v_fma_f32 v84, v212, v240, v64
    v_fma_f32 v85, v213, v241, v65
    v_fma_f32 v86, v212, v242, v66
    v_fma_f32 v87, v213, v243, v67
    v_fma_f32 v236, -v214, v242, v84
    v_fma_f32 v237, -v215, v243, v85
    v_fma_f32 v238, v214, v240, v86
    v_mfma_f32_16x16x32_bf16 a[124:127], a[200:203], a[236:239], a[124:127]
    ds_read_b64_tr_b16 a[196:197], v202 offset:22720
    v_fma_f32 v239, v215, v241, v87
    s_waitcnt lgkmcnt(7)
    v_fma_f32 v84, v212, v236, v68
    v_fma_f32 v85, v213, v237, v69
    v_fma_f32 v86, v212, v238, v70
    v_fma_f32 v87, v213, v239, v71
    v_fma_f32 v240, -v214, v238, v84
    v_mfma_f32_16x16x32_bf16 a[92:95], a[204:207], a[236:239], a[92:95]
    v_fma_f32 v241, -v215, v239, v85
    v_fma_f32 v242, v214, v236, v86
    v_fma_f32 v243, v215, v237, v87
    s_waitcnt lgkmcnt(6)
    v_fma_f32 v84, v212, v240, v72
    v_fma_f32 v85, v213, v241, v73
    v_fma_f32 v86, v212, v242, v74
    v_fma_f32 v87, v213, v243, v75
    v_mfma_f32_16x16x32_bf16 a[88:91], a[204:207], a[232:235], a[88:91]
    ds_read_b64_tr_b16 a[198:199], v202 offset:24512
    v_fma_f32 v236, -v214, v242, v84
    v_fma_f32 v237, -v215, v243, v85
    v_fma_f32 v238, v214, v240, v86
    v_fma_f32 v239, v215, v241, v87
    ds_read_b128 v[64:67], v176 offset:3072
    ds_read_b128 v[68:71], v176 offset:3328
    ds_read_b128 v[72:75], v176 offset:3584
    v_mfma_f32_16x16x32_bf16 a[84:87], a[204:207], a[228:231], a[84:87]
    s_waitcnt lgkmcnt(7)
    v_fma_f32 v84, v212, v236, v156
    v_fma_f32 v85, v213, v237, v157
    v_fma_f32 v86, v212, v238, v158
    v_fma_f32 v87, v213, v239, v159
    v_fma_f32 v240, -v214, v238, v84
    v_fma_f32 v241, -v215, v239, v85
    v_fma_f32 v242, v214, v236, v86
    v_mfma_f32_16x16x32_bf16 a[80:83], a[204:207], a[224:227], a[80:83]
    ds_read_b64_tr_b16 a[200:201], v202 offset:15552
    v_fma_f32 v243, v215, v237, v87
    s_waitcnt lgkmcnt(7)
    v_fma_f32 v84, v212, v240, v160
    v_fma_f32 v85, v213, v241, v161
    v_fma_f32 v86, v212, v242, v162
    v_fma_f32 v87, v213, v243, v163
    v_fma_f32 v236, -v214, v242, v84
    v_mfma_f32_16x16x32_bf16 a[128:131], a[176:179], a[144:147], a[128:131]
    v_fma_f32 v237, -v215, v243, v85
    v_fma_f32 v238, v214, v240, v86
    v_fma_f32 v239, v215, v241, v87
    s_waitcnt lgkmcnt(6)
    v_fma_f32 v84, v212, v236, v164
    v_fma_f32 v85, v213, v237, v165
    v_fma_f32 v86, v212, v238, v166
    v_fma_f32 v87, v213, v239, v167
    v_mfma_f32_16x16x32_bf16 a[132:135], a[176:179], a[148:151], a[132:135]
    ds_read_b64_tr_b16 a[202:203], v202 offset:17344
    v_fma_f32 v240, -v214, v238, v84
    v_fma_f32 v241, -v215, v239, v85
    v_fma_f32 v242, v214, v236, v86
    v_fma_f32 v243, v215, v237, v87
    s_waitcnt lgkmcnt(4)
    v_fma_f32 v84, v212, v240, v64
    v_fma_f32 v85, v213, v241, v65
    v_mfma_f32_16x16x32_bf16 a[136:139], a[176:179], a[152:155], a[136:139]
    v_fma_f32 v86, v212, v242, v66
    v_fma_f32 v87, v213, v243, v67
    v_fma_f32 v236, -v214, v242, v84
    v_fma_f32 v237, -v215, v243, v85
    v_fma_f32 v238, v214, v240, v86
    v_fma_f32 v239, v215, v241, v87
    s_waitcnt lgkmcnt(3)
    v_fma_f32 v84, v212, v236, v68
    v_mfma_f32_16x16x32_bf16 a[140:143], a[176:179], a[156:159], a[140:143]
    ds_read_b64_tr_b16 a[204:205], v202 offset:29888
    v_fma_f32 v85, v213, v237, v69
    v_fma_f32 v86, v212, v238, v70
    v_fma_f32 v87, v213, v239, v71
    v_fma_f32 v240, -v214, v238, v84
    v_fma_f32 v241, -v215, v239, v85
    v_fma_f32 v242, v214, v236, v86
    v_fma_f32 v243, v215, v237, v87
    v_mfma_f32_16x16x32_bf16 a[108:111], a[180:183], a[156:159], a[108:111]
    s_waitcnt lgkmcnt(3)
    v_fma_f32 v84, v212, v240, v72
    v_fma_f32 v85, v213, v241, v73
    v_fma_f32 v86, v212, v242, v74
    v_fma_f32 v87, v213, v243, v75
    v_fma_f32 v236, -v214, v242, v84
    v_fma_f32 v237, -v215, v243, v85
    v_fma_f32 v238, v214, v240, v86
    v_mfma_f32_16x16x32_bf16 a[104:107], a[180:183], a[152:155], a[104:107]
    ds_read_b64_tr_b16 a[206:207], v202 offset:31680
    v_fma_f32 v239, v215, v241, v87
    v_fma_f32 v84, v212, v236, v232
    v_fma_f32 v85, v213, v237, v233
    v_fma_f32 v86, v212, v238, v234
    v_fma_f32 v87, v213, v239, v235
    v_fma_f32 v240, -v214, v238, v84
    v_fma_f32 v241, -v215, v239, v85
    v_mfma_f32_16x16x32_bf16 a[100:103], a[180:183], a[148:151], a[100:103]
    v_fma_f32 v242, v214, v236, v86
    v_fma_f32 v243, v215, v237, v87
    s_lshl_b32 s70, s30, 11
    s_add_u32 s70, s70, 0x1900000
    s_lshl_b32 s80, s29, 8
    s_mov_b32 s94, s80
    s_add_u32 s80, s80, s70
    v_sub_u32 v177, 15, v225
    v_mfma_f32_16x16x32_bf16 a[96:99], a[180:183], a[144:147], a[96:99]
    v_lshlrev_b32 v177, 26, v177
    v_add_u32 v177, v177, v178
    v_min_u32 v240, -2, v240
    v_min_u32 v241, -2, v241
    v_min_u32 v242, -2, v242
    v_min_u32 v243, -2, v243
    buffer_store_dwordx4 v[240:243], v177, s[16:19], s80 offen sc1
    s_add_u32 s92, s68, s70
    s_addc_u32 s93, s69, 0
    v_mfma_f32_16x16x32_bf16 a[128:131], a[184:187], a[160:163], a[128:131]
    s_mov_b32 s95, 0x20000
    s_lshl_b32 s87, s30, 7
    s_add_u32 s87, s87, 0x1a0c000
    s_lshl_b32 s85, 1, s29
    s_sub_u32 s85, s85, 1
    buffer_load_dword v153, v254, s[16:19], s78 offen offset:0 sc1
    v_accvgpr_read_b32 v168, a64
    v_accvgpr_read_b32 v169, a65
    v_mfma_f32_16x16x32_bf16 a[132:135], a[184:187], a[164:167], a[132:135]
    v_accvgpr_read_b32 v170, a66
    v_accvgpr_read_b32 v171, a67
    v_max_f32 v128, 0, v128
    v_max_f32 v129, 0, v129
    v_max_f32 v130, 0, v130
    v_max_f32 v131, 0, v131
    v_mul_f32 v128, v128, v168
    v_mul_f32 v129, v129, v169
    v_mfma_f32_16x16x32_bf16 a[136:139], a[184:187], a[168:171], a[136:139]
    v_mul_f32 v130, v130, v170
    v_mul_f32 v131, v131, v171
    v_cvt_pk_bf16_f32 v112, v128, v129
    v_cvt_pk_bf16_f32 v113, v130, v131
    v_accvgpr_read_b32 v80, a112
    v_accvgpr_read_b32 v81, a113
    v_accvgpr_read_b32 v82, a114
    v_accvgpr_read_b32 v83, a115
    v_mfma_f32_16x16x32_bf16 a[140:143], a[184:187], a[172:175], a[140:143]
    v_accvgpr_read_b32 v172, a80
    v_accvgpr_read_b32 v173, a81
    v_accvgpr_read_b32 v174, a82
    v_accvgpr_read_b32 v175, a83
    v_max_f32 v80, 0, v80
    v_max_f32 v81, 0, v81
    v_max_f32 v82, 0, v82
    v_max_f32 v83, 0, v83
    v_mfma_f32_16x16x32_bf16 a[108:111], a[188:191], a[172:175], a[108:111]
    v_mul_f32 v80, v80, v172
    v_mul_f32 v81, v81, v173
    v_mul_f32 v82, v82, v174
    v_mul_f32 v83, v83, v175
    v_cvt_pk_bf16_f32 v114, v80, v81
    v_cvt_pk_bf16_f32 v115, v82, v83
    v_accvgpr_read_b32 v168, a68
    v_accvgpr_read_b32 v169, a69
    v_mfma_f32_16x16x32_bf16 a[104:107], a[188:191], a[168:171], a[104:107]
    v_accvgpr_read_b32 v170, a70
    v_accvgpr_read_b32 v171, a71
    v_max_f32 v132, 0, v132
    v_max_f32 v133, 0, v133
    v_max_f32 v134, 0, v134
    v_max_f32 v135, 0, v135
    v_mul_f32 v132, v132, v168
    v_mul_f32 v133, v133, v169
    v_mfma_f32_16x16x32_bf16 a[100:103], a[188:191], a[164:167], a[100:103]
    v_mul_f32 v134, v134, v170
    v_mul_f32 v135, v135, v171
    v_cvt_pk_bf16_f32 v116, v132, v133
    v_cvt_pk_bf16_f32 v117, v134, v135
    v_accvgpr_read_b32 v84, a116
    v_accvgpr_read_b32 v85, a117
    v_accvgpr_read_b32 v86, a118
    v_accvgpr_read_b32 v87, a119
    v_mfma_f32_16x16x32_bf16 a[96:99], a[188:191], a[160:163], a[96:99]
    v_accvgpr_read_b32 v172, a84
    v_accvgpr_read_b32 v173, a85
    v_accvgpr_read_b32 v174, a86
    v_accvgpr_read_b32 v175, a87
    v_max_f32 v84, 0, v84
    v_max_f32 v85, 0, v85
    v_max_f32 v86, 0, v86
    v_max_f32 v87, 0, v87
    v_mfma_f32_16x16x32_bf16 a[128:131], a[192:195], a[208:211], a[128:131]
    v_mul_f32 v84, v84, v172
    v_mul_f32 v85, v85, v173
    v_mul_f32 v86, v86, v174
    v_mul_f32 v87, v87, v175
    v_cvt_pk_bf16_f32 v118, v84, v85
    v_cvt_pk_bf16_f32 v119, v86, v87
    v_accvgpr_read_b32 v168, a72
    v_accvgpr_read_b32 v169, a73
    v_mfma_f32_16x16x32_bf16 a[132:135], a[192:195], a[212:215], a[132:135]
    v_accvgpr_read_b32 v170, a74
    v_accvgpr_read_b32 v171, a75
    v_max_f32 v136, 0, v136
    v_max_f32 v137, 0, v137
    v_max_f32 v138, 0, v138
    v_max_f32 v139, 0, v139
    v_mul_f32 v136, v136, v168
    v_mul_f32 v137, v137, v169
    v_mfma_f32_16x16x32_bf16 a[136:139], a[192:195], a[216:219], a[136:139]
    v_mul_f32 v138, v138, v170
    v_mul_f32 v139, v139, v171
    v_cvt_pk_bf16_f32 v120, v136, v137
    v_cvt_pk_bf16_f32 v121, v138, v139
    v_accvgpr_read_b32 v88, a120
    v_accvgpr_read_b32 v89, a121
    v_accvgpr_read_b32 v90, a122
    v_accvgpr_read_b32 v91, a123
    v_mfma_f32_16x16x32_bf16 a[140:143], a[192:195], a[220:223], a[140:143]
    v_accvgpr_read_b32 v172, a88
    v_accvgpr_read_b32 v173, a89
    v_accvgpr_read_b32 v174, a90
    v_accvgpr_read_b32 v175, a91
    v_max_f32 v88, 0, v88
    v_max_f32 v89, 0, v89
    v_max_f32 v90, 0, v90
    v_max_f32 v91, 0, v91
    v_mfma_f32_16x16x32_bf16 a[108:111], a[196:199], a[220:223], a[108:111]
    v_mul_f32 v88, v88, v172
    v_mul_f32 v89, v89, v173
    v_mul_f32 v90, v90, v174
    v_mul_f32 v91, v91, v175
    v_cvt_pk_bf16_f32 v122, v88, v89
    v_cvt_pk_bf16_f32 v123, v90, v91
    v_accvgpr_read_b32 v168, a76
    v_accvgpr_read_b32 v169, a77
    v_mfma_f32_16x16x32_bf16 a[104:107], a[196:199], a[216:219], a[104:107]
    v_accvgpr_read_b32 v170, a78
    v_accvgpr_read_b32 v171, a79
    v_max_f32 v140, 0, v140
    v_max_f32 v141, 0, v141
    v_max_f32 v142, 0, v142
    v_max_f32 v143, 0, v143
    v_mul_f32 v140, v140, v168
    v_mul_f32 v141, v141, v169
    v_mfma_f32_16x16x32_bf16 a[100:103], a[196:199], a[212:215], a[100:103]
    v_mul_f32 v142, v142, v170
    v_mul_f32 v143, v143, v171
    v_cvt_pk_bf16_f32 v124, v140, v141
    v_cvt_pk_bf16_f32 v125, v142, v143
    v_accvgpr_read_b32 v92, a124
    v_accvgpr_read_b32 v93, a125
    v_accvgpr_read_b32 v94, a126
    v_accvgpr_read_b32 v95, a127
    v_mfma_f32_16x16x32_bf16 a[96:99], a[196:199], a[208:211], a[96:99]
    v_accvgpr_read_b32 v172, a92
    v_accvgpr_read_b32 v173, a93
    v_accvgpr_read_b32 v174, a94
    v_accvgpr_read_b32 v175, a95
    v_max_f32 v92, 0, v92
    v_max_f32 v93, 0, v93
    v_max_f32 v94, 0, v94
    v_max_f32 v95, 0, v95
    s_waitcnt lgkmcnt(2)
    v_mfma_f32_16x16x32_bf16 a[128:131], a[200:203], a[224:227], a[128:131]
    v_mul_f32 v92, v92, v172
    v_mul_f32 v93, v93, v173
    v_mul_f32 v94, v94, v174
    v_mul_f32 v95, v95, v175
    v_cvt_pk_bf16_f32 v126, v92, v93
    v_cvt_pk_bf16_f32 v127, v94, v95
    v_mfma_f32_16x16x32_bf16 a[132:135], a[200:203], a[228:231], a[132:135]
    v_mfma_f32_16x16x32_bf16 a[136:139], a[200:203], a[232:235], a[136:139]
    v_mfma_f32_16x16x32_bf16 a[140:143], a[200:203], a[236:239], a[140:143]
    s_waitcnt lgkmcnt(0)
    v_mfma_f32_16x16x32_bf16 a[108:111], a[204:207], a[236:239], a[108:111]
    v_mfma_f32_16x16x32_bf16 a[104:107], a[204:207], a[232:235], a[104:107]
    v_mfma_f32_16x16x32_bf16 a[100:103], a[204:207], a[228:231], a[100:103]
    v_mfma_f32_16x16x32_bf16 a[96:99], a[204:207], a[224:227], a[96:99]
    s_nop 7
    s_and_b32 s80, s30, 7
    s_lshl_b32 s80, 0x01010101, s80
    s_waitcnt vmcnt(0)
    v_cmp_eq_u32 vcc, 1, v153
    s_or_b32 s80, vcc_lo, s80
    s_cmp_eq_u32 s80, -1
    s_cselect_b32 s88, 1, 0
    s_cbranch_scc0 k_noearly
    s_add_u32 s77, s33, 0x0
    buffer_load_dwordx4 a[160:163], v179, s[16:19], s77 offen offset:0 sc1
    buffer_load_dwordx4 a[164:167], v179, s[16:19], s77 offen offset:1024 sc1
    buffer_load_dwordx4 a[168:171], v179, s[16:19], s77 offen offset:2048 sc1
    buffer_load_dwordx4 a[172:175], v179, s[16:19], s77 offen offset:3072 sc1
    s_add_u32 s77, s33, 0x4000
    buffer_load_dwordx4 a[176:179], v179, s[16:19], s77 offen offset:0 sc1
    buffer_load_dwordx4 a[180:183], v179, s[16:19], s77 offen offset:1024 sc1
    buffer_load_dwordx4 a[184:187], v179, s[16:19], s77 offen offset:2048 sc1
    buffer_load_dwordx4 a[188:191], v179, s[16:19], s77 offen offset:3072 sc1
k_early12:
    s_add_u32 s77, s33, 0x7000
    buffer_load_dwordx4 a[192:195], v179, s[16:19], s77 offen offset:0 sc1
    buffer_load_dwordx4 a[196:199], v179, s[16:19], s77 offen offset:1024 sc1
    buffer_load_dwordx4 a[200:203], v179, s[16:19], s77 offen offset:2048 sc1
    buffer_load_dwordx4 a[204:207], v179, s[16:19], s77 offen offset:3072 sc1
    s_add_u32 s77, s33, 0xb000
    buffer_load_dwordx4 a[208:211], v179, s[16:19], s77 offen offset:0 sc1
    buffer_load_dwordx4 a[212:215], v179, s[16:19], s77 offen offset:1024 sc1
    buffer_load_dwordx4 a[216:219], v179, s[16:19], s77 offen offset:2048 sc1
    buffer_load_dwordx4 a[220:223], v179, s[16:19], s77 offen offset:3072 sc1
    s_add_u32 s77, s33, 0xe000
    buffer_load_dwordx4 a[224:227], v179, s[16:19], s77 offen offset:0 sc1
    buffer_load_dwordx4 a[228:231], v179, s[16:19], s77 offen offset:1024 sc1
    buffer_load_dwordx4 a[232:235], v179, s[16:19], s77 offen offset:2048 sc1
    buffer_load_dwordx4 a[236:239], v179, s[16:19], s77 offen offset:3072 sc1
    s_add_u32 s77, s33, 0x12000
    buffer_load_dwordx4 a[240:243], v179, s[16:19], s77 offen offset:0 sc1
    buffer_load_dwordx4 a[244:247], v179, s[16:19], s77 offen offset:1024 sc1
    buffer_load_dwordx4 a[248:251], v179, s[16:19], s77 offen offset:2048 sc1
    buffer_load_dwordx4 a[252:255], v179, s[16:19], s77 offen offset:3072 sc1
k_noearly:
    v_and_b32 v191, 1, v227
    v_lshlrev_b32 v191, 10, v191
    v_lshl_add_u32 v191, v226, 4, v191
    v_lshrrev_b32 v180, 1, v227
    v_lshl_add_u32 v191, v180, 8, v191
    v_accvgpr_read_b32 v80, a128
    v_accvgpr_read_b32 v81, a129
    v_accvgpr_read_b32 v82, a130
    v_accvgpr_read_b32 v83, a131
    v_accvgpr_read_b32 v168, a96
    v_accvgpr_read_b32 v169, a97
    v_accvgpr_read_b32 v170, a98
    v_accvgpr_read_b32 v171, a99
    v_max_f32 v80, 0, v80
    v_max_f32 v81, 0, v81
    v_max_f32 v82, 0, v82
    v_max_f32 v83, 0, v83
    v_mul_f32 v80, v80, v168
    v_mul_f32 v81, v81, v169
    v_mul_f32 v82, v82, v170
    v_mul_f32 v83, v83, v171
    v_cvt_pk_bf16_f32 v180, v80, v81
    v_cvt_pk_bf16_f32 v181, v82, v83
    v_accvgpr_read_b32 v84, a132
    v_accvgpr_read_b32 v85, a133
    v_accvgpr_read_b32 v86, a134
    v_accvgpr_read_b32 v87, a135
    v_accvgpr_read_b32 v172, a100
    v_accvgpr_read_b32 v173, a101
    v_accvgpr_read_b32 v174, a102
    v_accvgpr_read_b32 v175, a103
    v_max_f32 v84, 0, v84
    v_max_f32 v85, 0, v85
    v_max_f32 v86, 0, v86
    v_max_f32 v87, 0, v87
    v_mul_f32 v84, v84, v172
    v_mul_f32 v85, v85, v173
    v_mul_f32 v86, v86, v174
    v_mul_f32 v87, v87, v175
    v_cvt_pk_bf16_f32 v182, v84, v85
    v_cvt_pk_bf16_f32 v183, v86, v87
    s_nop 1
    v_permlane16_swap_b32 v180, v182
    v_permlane16_swap_b32 v181, v183
    v_accvgpr_read_b32 v88, a136
    v_accvgpr_read_b32 v89, a137
    v_accvgpr_read_b32 v90, a138
    v_accvgpr_read_b32 v91, a139
    v_accvgpr_read_b32 v168, a104
    v_accvgpr_read_b32 v169, a105
    v_accvgpr_read_b32 v170, a106
    v_accvgpr_read_b32 v171, a107
    v_max_f32 v88, 0, v88
    v_max_f32 v89, 0, v89
    v_max_f32 v90, 0, v90
    v_max_f32 v91, 0, v91
    v_mul_f32 v88, v88, v168
    v_mul_f32 v89, v89, v169
    v_mul_f32 v90, v90, v170
    v_mul_f32 v91, v91, v171
    v_cvt_pk_bf16_f32 v184, v88, v89
    v_cvt_pk_bf16_f32 v185, v90, v91
    v_accvgpr_read_b32 v92, a140
    v_accvgpr_read_b32 v93, a141
    v_accvgpr_read_b32 v94, a142
    v_accvgpr_read_b32 v95, a143
    v_accvgpr_read_b32 v172, a108
    v_accvgpr_read_b32 v173, a109
    v_accvgpr_read_b32 v174, a110
    v_accvgpr_read_b32 v175, a111
    v_max_f32 v92, 0, v92
    v_max_f32 v93, 0, v93
    v_max_f32 v94, 0, v94
    v_max_f32 v95, 0, v95
    v_mul_f32 v92, v92, v172
    v_mul_f32 v93, v93, v173
    v_mul_f32 v94, v94, v174
    v_mul_f32 v95, v95, v175
    v_cvt_pk_bf16_f32 v186, v92, v93
    v_cvt_pk_bf16_f32 v187, v94, v95
    s_nop 1
    v_permlane16_swap_b32 v184, v186
    v_permlane16_swap_b32 v185, v187
    v_lshrrev_b32 v154, 2, v224
    v_and_b32 v155, 7, v154
    v_lshlrev_b32 v154, 8, v154
    v_and_b32 v156, 3, v224
    v_lshl_add_u32 v154, v156, 3, v154
    v_add_u32 v154, 0x9000, v154
    v_xor_b32 v156, 0, v155
    v_lshl_add_u32 v160, v156, 5, v154
    v_xor_b32 v156, 1, v155
    v_lshl_add_u32 v161, v156, 5, v154
    v_xor_b32 v156, 2, v155
    v_lshl_add_u32 v162, v156, 5, v154
    v_xor_b32 v156, 3, v155
    v_lshl_add_u32 v163, v156, 5, v154
    v_xor_b32 v156, 4, v155
    v_lshl_add_u32 v164, v156, 5, v154
    v_xor_b32 v156, 5, v155
    v_lshl_add_u32 v165, v156, 5, v154
    v_xor_b32 v156, 6, v155
    v_lshl_add_u32 v166, v156, 5, v154
    v_xor_b32 v156, 7, v155
    v_lshl_add_u32 v167, v156, 5, v154
    s_cmp_lg_u32 s88, 0
    s_cbranch_scc1 k_late_done
    v_cmp_eq_u32 vcc, 1, v153
    s_cmp_eq_u64 vcc, -1
    s_cbranch_scc0 chk_2_slow
chk_2_ok:
    s_add_u32 s77, s33, 0x0
    buffer_load_dwordx4 a[160:163], v179, s[16:19], s77 offen offset:0 sc1
    buffer_load_dwordx4 a[164:167], v179, s[16:19], s77 offen offset:1024 sc1
    buffer_load_dwordx4 a[168:171], v179, s[16:19], s77 offen offset:2048 sc1
    buffer_load_dwordx4 a[172:175], v179, s[16:19], s77 offen offset:3072 sc1
    s_add_u32 s77, s33, 0x4000
    buffer_load_dwordx4 a[176:179], v179, s[16:19], s77 offen offset:0 sc1
    buffer_load_dwordx4 a[180:183], v179, s[16:19], s77 offen offset:1024 sc1
    buffer_load_dwordx4 a[184:187], v179, s[16:19], s77 offen offset:2048 sc1
    buffer_load_dwordx4 a[188:191], v179, s[16:19], s77 offen offset:3072 sc1
    s_add_u32 s77, s33, 0x7000
    buffer_load_dwordx4 a[192:195], v179, s[16:19], s77 offen offset:0 sc1
    buffer_load_dwordx4 a[196:199], v179, s[16:19], s77 offen offset:1024 sc1
    buffer_load_dwordx4 a[200:203], v179, s[16:19], s77 offen offset:2048 sc1
    buffer_load_dwordx4 a[204:207], v179, s[16:19], s77 offen offset:3072 sc1
    s_add_u32 s77, s33, 0xb000
    buffer_load_dwordx4 a[208:211], v179, s[16:19], s77 offen offset:0 sc1
    buffer_load_dwordx4 a[212:215], v179, s[16:19], s77 offen offset:1024 sc1
    buffer_load_dwordx4 a[216:219], v179, s[16:19], s77 offen offset:2048 sc1
    buffer_load_dwordx4 a[220:223], v179, s[16:19], s77 offen offset:3072 sc1
    s_add_u32 s77, s33, 0xe000
    buffer_load_dwordx4 a[224:227], v179, s[16:19], s77 offen offset:0 sc1
    buffer_load_dwordx4 a[228:231], v179, s[16:19], s77 offen offset:1024 sc1
    buffer_load_dwordx4 a[232:235], v179, s[16:19], s77 offen offset:2048 sc1
    buffer_load_dwordx4 a[236:239], v179, s[16:19], s77 offen offset:3072 sc1
    s_add_u32 s77, s33, 0x12000
    buffer_load_dwordx4 a[240:243], v179, s[16:19], s77 offen offset:0 sc1
    buffer_load_dwordx4 a[244:247], v179, s[16:19], s77 offen offset:1024 sc1
    buffer_load_dwordx4 a[248:251], v179, s[16:19], s77 offen offset:2048 sc1
    buffer_load_dwordx4 a[252:255], v179, s[16:19], s77 offen offset:3072 sc1
k_late_done:
    buffer_store_dwordx4 v[112:115], v179, s[16:19], s86 offen offset:0 sc1
    buffer_store_dwordx4 v[116:119], v179, s[16:19], s86 offen offset:1024 sc1
    buffer_store_dwordx4 v[120:123], v179, s[16:19], s86 offen offset:2048 sc1
    buffer_store_dwordx4 v[124:127], v179, s[16:19], s86 offen offset:3072 sc1
    buffer_store_dwordx4 v[180:183], v191, s[16:19], s82 offen offset:0 sc1
    buffer_store_dwordx4 v[184:187], v191, s[16:19], s82 offen offset:2048 sc1
    s_waitcnt vmcnt(17) lgkmcnt(0)
    s_barrier
    ds_read_b64_tr_b16 v[128:129], v160 offset:0
    ds_read_b64_tr_b16 v[130:131], v160 offset:4096
    s_add_u32 m0, s3, 0xc000
    s_add_u32 s76, s34, 0x150000
    s_nop 0
    ds_read_b64_tr_b16 v[132:133], v161 offset:0
    buffer_load_dwordx4 v188, s[8:11], s76 offen offset:0 lds
    s_mov_b32 s12, s46
    s_mov_b32 s13, s47
    s_mov_b32 s14, 0x200000
    ds_read_b64_tr_b16 v[134:135], v161 offset:4096
    s_mov_b32 s15, 0x20000
    s_mov_b32 s24, s48
    s_mov_b32 s25, s49
    s_mov_b32 s26, 0x200000
    ds_read_b64_tr_b16 v[136:137], v162 offset:0
    buffer_load_dwordx4 v189, s[8:11], s76 offen offset:1024 lds
    s_mov_b32 s27, 0x20000
    s_mov_b32 s96, s64
    s_mov_b32 s97, s65
    ds_read_b64_tr_b16 v[138:139], v162 offset:4096
    s_mov_b32 s98, 0x800000
    s_mov_b32 s99, 0x20000
    s_mov_b32 s72, s52
    s_mov_b32 s73, s53
    ds_read_b64_tr_b16 v[140:141], v163 offset:0
    buffer_load_dwordx4 v190, s[8:11], s76 offen offset:2048 lds
    s_mov_b32 s74, 0x800
    s_mov_b32 s75, 0x20000
    v_lshrrev_b32 v92, 1, v226
    ds_read_b64_tr_b16 v[142:143], v163 offset:4096
    v_xor_b32 v92, v92, v227
    v_lshlrev_b32 v93, 7, v226
    v_lshl_add_u32 v168, v92, 4, v93
    v_add_u32 v168, 0x9000, v168
    ds_read_b64_tr_b16 v[144:145], v164 offset:0
    buffer_load_dwordx4 v192, s[8:11], s76 offen offset:3072 lds
    v_xor_b32 v169, 64, v168
    s_add_u32 s80, s28, s100
    s_and_b32 s80, s80, 3
    ds_read_b64_tr_b16 v[146:147], v164 offset:4096
    s_lshl_b32 s80, s80, 5
    s_lshl_b32 s81, s32, 7
    s_add_u32 s80, s80, s81
    v_lshrrev_b32 v92, 3, v224
    v_add_u32 v92, s80, v92
    v_lshlrev_b32 v92, 11, v92
    v_and_b32 v93, 7, v224
    v_xor_b32 v93, v93, v227
    v_xor_b32 v94, 4, v93
    v_lshl_add_u32 v93, v93, 4, v92
    v_lshl_add_u32 v94, v94, 4, v92
    v_add_u32 v170, 0x0, v93
    v_add_u32 v171, 0x3c00, v94
    v_add_u32 v172, 0x7800, v93
    ds_read_b64_tr_b16 v[148:149], v165 offset:0
    v_add_u32 v173, 0xb400, v94
    s_lshl_b32 s80, s31, 19
    s_lshl_b32 s81, s28, 17
    s_add_u32 s80, s80, s81
    s_waitcnt lgkmcnt(9)
    v_mfma_f32_16x16x32_bf16 a[0:3], v[128:131], a[160:163], 0
    s_add_u32 s77, s33, 0x15000
    buffer_load_dwordx4 a[128:131], v179, s[16:19], s77 offen offset:0 sc1
    s_lshl_b32 s81, s32, 8
    s_add_u32 s80, s80, s81
    s_lshl_b32 s81, s100, 6
    v_mfma_f32_16x16x32_bf16 a[4:7], v[128:131], a[164:167], 0
    ds_read_b64_tr_b16 v[150:151], v165 offset:4096
    s_add_u32 s80, s80, s81
    v_lshlrev_b32 v199, 11, v224
    buffer_load_dword v199, v199, s[4:7], s80 offen
    v_mfma_f32_16x16x32_bf16 a[8:11], v[128:131], a[168:171], 0
    v_mfma_f32_16x16x32_bf16 a[12:15], v[128:131], a[172:175], 0
    ds_read_b64_tr_b16 v[152:153], v166 offset:0
    s_waitcnt lgkmcnt(9)
    v_mfma_f32_16x16x32_bf16 a[28:31], v[132:135], a[172:175], 0
    buffer_load_dwordx4 a[132:135], v179, s[16:19], s77 offen offset:1024 sc1
    v_mfma_f32_16x16x32_bf16 a[24:27], v[132:135], a[168:171], 0
    ds_read_b64_tr_b16 v[154:155], v166 offset:4096
    v_mfma_f32_16x16x32_bf16 a[20:23], v[132:135], a[164:167], 0
    v_mfma_f32_16x16x32_bf16 a[16:19], v[132:135], a[160:163], 0
    ds_read_b64_tr_b16 v[156:157], v167 offset:0
    s_waitcnt lgkmcnt(9)
    v_mfma_f32_16x16x32_bf16 a[32:35], v[136:139], a[160:163], 0
    buffer_load_dwordx4 a[136:139], v179, s[16:19], s77 offen offset:2048 sc1
    v_mfma_f32_16x16x32_bf16 a[36:39], v[136:139], a[164:167], 0
    ds_read_b64_tr_b16 v[158:159], v167 offset:4096
    v_mfma_f32_16x16x32_bf16 a[40:43], v[136:139], a[168:171], 0
    v_mfma_f32_16x16x32_bf16 a[44:47], v[136:139], a[172:175], 0
    ds_read_b64_tr_b16 v[128:129], v160 offset:8192
    s_waitcnt lgkmcnt(9)
    v_mfma_f32_16x16x32_bf16 a[60:63], v[140:143], a[172:175], 0
    buffer_load_dwordx4 a[140:143], v179, s[16:19], s77 offen offset:3072 sc1
    v_mfma_f32_16x16x32_bf16 a[56:59], v[140:143], a[168:171], 0
    ds_read_b64_tr_b16 v[130:131], v160 offset:12288
    v_mfma_f32_16x16x32_bf16 a[52:55], v[140:143], a[164:167], 0
    v_mfma_f32_16x16x32_bf16 a[48:51], v[140:143], a[160:163], 0
    ds_read_b64_tr_b16 v[132:133], v161 offset:8192
    s_waitcnt lgkmcnt(9)
    v_mfma_f32_16x16x32_bf16 a[64:67], v[144:147], a[160:163], 0
    s_add_u32 s77, s33, 0x19000
    buffer_load_dwordx4 a[144:147], v179, s[16:19], s77 offen offset:0 sc1
    v_mfma_f32_16x16x32_bf16 a[68:71], v[144:147], a[164:167], 0
    ds_read_b64_tr_b16 v[134:135], v161 offset:12288
    v_mfma_f32_16x16x32_bf16 a[72:75], v[144:147], a[168:171], 0
    v_mfma_f32_16x16x32_bf16 a[76:79], v[144:147], a[172:175], 0
    ds_read_b64_tr_b16 v[136:137], v162 offset:8192
    s_waitcnt lgkmcnt(9)
    v_mfma_f32_16x16x32_bf16 a[92:95], v[148:151], a[172:175], 0
    buffer_load_dwordx4 a[148:151], v179, s[16:19], s77 offen offset:1024 sc1
    v_mfma_f32_16x16x32_bf16 a[88:91], v[148:151], a[168:171], 0
    ds_read_b64_tr_b16 v[138:139], v162 offset:12288
    v_mfma_f32_16x16x32_bf16 a[84:87], v[148:151], a[164:167], 0
    v_mfma_f32_16x16x32_bf16 a[80:83], v[148:151], a[160:163], 0
    ds_read_b64_tr_b16 v[140:141], v163 offset:8192
    s_waitcnt lgkmcnt(9)
    v_mfma_f32_16x16x32_bf16 a[96:99], v[152:155], a[160:163], 0
    buffer_load_dwordx4 a[152:155], v179, s[16:19], s77 offen offset:2048 sc1
    v_mfma_f32_16x16x32_bf16 a[100:103], v[152:155], a[164:167], 0
    ds_read_b64_tr_b16 v[142:143], v163 offset:12288
    v_mfma_f32_16x16x32_bf16 a[104:107], v[152:155], a[168:171], 0
    v_mfma_f32_16x16x32_bf16 a[108:111], v[152:155], a[172:175], 0
    ds_read_b64_tr_b16 v[144:145], v164 offset:8192
    s_waitcnt lgkmcnt(9)
    v_mfma_f32_16x16x32_bf16 a[124:127], v[156:159], a[172:175], 0
    buffer_load_dwordx4 a[156:159], v179, s[16:19], s77 offen offset:3072 sc1
    v_mfma_f32_16x16x32_bf16 a[120:123], v[156:159], a[168:171], 0
    ds_read_b64_tr_b16 v[146:147], v164 offset:12288
    v_mfma_f32_16x16x32_bf16 a[116:119], v[156:159], a[164:167], 0
    v_mfma_f32_16x16x32_bf16 a[112:115], v[156:159], a[160:163], 0
    ds_read_b64_tr_b16 v[148:149], v165 offset:8192
    s_waitcnt lgkmcnt(9)
    v_mfma_f32_16x16x32_bf16 a[0:3], v[128:131], a[176:179], a[0:3]
    v_mfma_f32_16x16x32_bf16 a[4:7], v[128:131], a[180:183], a[4:7]
    ds_read_b64_tr_b16 v[150:151], v165 offset:12288
    v_mfma_f32_16x16x32_bf16 a[8:11], v[128:131], a[184:187], a[8:11]
    v_mfma_f32_16x16x32_bf16 a[12:15], v[128:131], a[188:191], a[12:15]
    ds_read_b64_tr_b16 v[152:153], v166 offset:8192
    s_waitcnt lgkmcnt(9)
    v_mfma_f32_16x16x32_bf16 a[28:31], v[132:135], a[188:191], a[28:31]
    v_mfma_f32_16x16x32_bf16 a[24:27], v[132:135], a[184:187], a[24:27]
    ds_read_b64_tr_b16 v[154:155], v166 offset:12288
    v_mfma_f32_16x16x32_bf16 a[20:23], v[132:135], a[180:183], a[20:23]
    v_mfma_f32_16x16x32_bf16 a[16:19], v[132:135], a[176:179], a[16:19]
    ds_read_b64_tr_b16 v[156:157], v167 offset:8192
    s_waitcnt lgkmcnt(9)
    v_mfma_f32_16x16x32_bf16 a[32:35], v[136:139], a[176:179], a[32:35]
    v_mfma_f32_16x16x32_bf16 a[36:39], v[136:139], a[180:183], a[36:39]
    ds_read_b64_tr_b16 v[158:159], v167 offset:12288
    v_mfma_f32_16x16x32_bf16 a[40:43], v[136:139], a[184:187], a[40:43]
    v_mfma_f32_16x16x32_bf16 a[44:47], v[136:139], a[188:191], a[44:47]
    s_waitcnt lgkmcnt(8)
    v_mfma_f32_16x16x32_bf16 a[60:63], v[140:143], a[188:191], a[60:63]
    v_mfma_f32_16x16x32_bf16 a[56:59], v[140:143], a[184:187], a[56:59]
    v_mfma_f32_16x16x32_bf16 a[52:55], v[140:143], a[180:183], a[52:55]
    v_mfma_f32_16x16x32_bf16 a[48:51], v[140:143], a[176:179], a[48:51]
    s_waitcnt lgkmcnt(6)
    v_mfma_f32_16x16x32_bf16 a[64:67], v[144:147], a[176:179], a[64:67]
    v_mfma_f32_16x16x32_bf16 a[68:71], v[144:147], a[180:183], a[68:71]
    v_mfma_f32_16x16x32_bf16 a[72:75], v[144:147], a[184:187], a[72:75]
    v_mfma_f32_16x16x32_bf16 a[76:79], v[144:147], a[188:191], a[76:79]
    s_waitcnt vmcnt(26) lgkmcnt(0)
    s_barrier
    ds_read_b64_tr_b16 v[128:129], v160 offset:16384
    s_waitcnt vmcnt(15)
    s_mov_b64 exec, 0x4
    buffer_store_dword v203, v248, s[16:19], 0 offen sc1
    s_mov_b64 exec, -1
    s_waitcnt vmcnt(14)
    s_mov_b64 exec, 0x8
    buffer_store_dword v203, v248, s[16:19], 0 offen sc1
    s_mov_b64 exec, -1
    v_mfma_f32_16x16x32_bf16 a[92:95], v[148:151], a[188:191], a[92:95]
    ds_read_b64_tr_b16 v[130:131], v160 offset:20480
    s_add_u32 m0, s3, 0x0
    s_add_u32 s76, s34, 0x10000
    v_mfma_f32_16x16x32_bf16 a[88:91], v[148:151], a[184:187], a[88:91]
    ds_read_b64_tr_b16 v[132:133], v161 offset:16384
    buffer_load_dwordx4 v188, s[8:11], s76 offen offset:0 lds
    v_mfma_f32_16x16x32_bf16 a[84:87], v[148:151], a[180:183], a[84:87]
    ds_read_b64_tr_b16 v[134:135], v161 offset:20480
    v_mfma_f32_16x16x32_bf16 a[80:83], v[148:151], a[176:179], a[80:83]
    ds_read_b64_tr_b16 v[136:137], v162 offset:16384
    buffer_load_dwordx4 v189, s[8:11], s76 offen offset:1024 lds
    v_mfma_f32_16x16x32_bf16 a[96:99], v[152:155], a[176:179], a[96:99]
    ds_read_b64_tr_b16 v[138:139], v162 offset:20480
    v_mfma_f32_16x16x32_bf16 a[100:103], v[152:155], a[180:183], a[100:103]
    ds_read_b64_tr_b16 v[140:141], v163 offset:16384
    buffer_load_dwordx4 v190, s[8:11], s76 offen offset:2048 lds
    v_mfma_f32_16x16x32_bf16 a[104:107], v[152:155], a[184:187], a[104:107]
    ds_read_b64_tr_b16 v[142:143], v163 offset:20480
    v_mfma_f32_16x16x32_bf16 a[108:111], v[152:155], a[188:191], a[108:111]
    ds_read_b64_tr_b16 v[144:145], v164 offset:16384
    buffer_load_dwordx4 v192, s[8:11], s76 offen offset:3072 lds
    v_mfma_f32_16x16x32_bf16 a[124:127], v[156:159], a[188:191], a[124:127]
    ds_read_b64_tr_b16 v[146:147], v164 offset:20480
    v_mfma_f32_16x16x32_bf16 a[120:123], v[156:159], a[184:187], a[120:123]
    v_mfma_f32_16x16x32_bf16 a[116:119], v[156:159], a[180:183], a[116:119]
    v_mfma_f32_16x16x32_bf16 a[112:115], v[156:159], a[176:179], a[112:115]
    ds_read_b64_tr_b16 v[148:149], v165 offset:16384
    s_waitcnt lgkmcnt(9)
    v_mfma_f32_16x16x32_bf16 a[0:3], v[128:131], a[192:195], a[0:3]
    v_mfma_f32_16x16x32_bf16 a[4:7], v[128:131], a[196:199], a[4:7]
    ds_read_b64_tr_b16 v[150:151], v165 offset:20480
    v_mfma_f32_16x16x32_bf16 a[8:11], v[128:131], a[200:203], a[8:11]
    v_mfma_f32_16x16x32_bf16 a[12:15], v[128:131], a[204:207], a[12:15]
    ds_read_b64_tr_b16 v[152:153], v166 offset:16384
    s_waitcnt lgkmcnt(9)
    v_mfma_f32_16x16x32_bf16 a[28:31], v[132:135], a[204:207], a[28:31]
    v_mfma_f32_16x16x32_bf16 a[24:27], v[132:135], a[200:203], a[24:27]
    ds_read_b64_tr_b16 v[154:155], v166 offset:20480
    v_mfma_f32_16x16x32_bf16 a[20:23], v[132:135], a[196:199], a[20:23]
    v_mfma_f32_16x16x32_bf16 a[16:19], v[132:135], a[192:195], a[16:19]
    ds_read_b64_tr_b16 v[156:157], v167 offset:16384
    s_waitcnt lgkmcnt(9)
    v_mfma_f32_16x16x32_bf16 a[32:35], v[136:139], a[192:195], a[32:35]
    v_mfma_f32_16x16x32_bf16 a[36:39], v[136:139], a[196:199], a[36:39]
    ds_read_b64_tr_b16 v[158:159], v167 offset:20480
    v_mfma_f32_16x16x32_bf16 a[40:43], v[136:139], a[200:203], a[40:43]
    v_mfma_f32_16x16x32_bf16 a[44:47], v[136:139], a[204:207], a[44:47]
    ds_read_b64_tr_b16 v[128:129], v160 offset:24576
    s_waitcnt lgkmcnt(9)
    v_mfma_f32_16x16x32_bf16 a[60:63], v[140:143], a[204:207], a[60:63]
    v_mfma_f32_16x16x32_bf16 a[56:59], v[140:143], a[200:203], a[56:59]
    ds_read_b64_tr_b16 v[130:131], v160 offset:28672
    v_mfma_f32_16x16x32_bf16 a[52:55], v[140:143], a[196:199], a[52:55]
    v_mfma_f32_16x16x32_bf16 a[48:51], v[140:143], a[192:195], a[48:51]
    ds_read_b64_tr_b16 v[132:133], v161 offset:24576
    s_waitcnt lgkmcnt(9)
    v_mfma_f32_16x16x32_bf16 a[64:67], v[144:147], a[192:195], a[64:67]
    v_mfma_f32_16x16x32_bf16 a[68:71], v[144:147], a[196:199], a[68:71]
    ds_read_b64_tr_b16 v[134:135], v161 offset:28672
    buffer_load_dword v174, v254, s[16:19], s78 offen offset:128 sc1
    v_mfma_f32_16x16x32_bf16 a[72:75], v[144:147], a[200:203], a[72:75]
    v_mfma_f32_16x16x32_bf16 a[76:79], v[144:147], a[204:207], a[76:79]
    ds_read_b64_tr_b16 v[136:137], v162 offset:24576
    s_waitcnt lgkmcnt(9)
    v_mfma_f32_16x16x32_bf16 a[92:95], v[148:151], a[204:207], a[92:95]
    v_mfma_f32_16x16x32_bf16 a[88:91], v[148:151], a[200:203], a[88:91]
    ds_read_b64_tr_b16 v[138:139], v162 offset:28672
    v_mfma_f32_16x16x32_bf16 a[84:87], v[148:151], a[196:199], a[84:87]
    v_mfma_f32_16x16x32_bf16 a[80:83], v[148:151], a[192:195], a[80:83]
    ds_read_b64_tr_b16 v[140:141], v163 offset:24576
    s_waitcnt lgkmcnt(9)
    v_mfma_f32_16x16x32_bf16 a[96:99], v[152:155], a[192:195], a[96:99]
    v_mfma_f32_16x16x32_bf16 a[100:103], v[152:155], a[196:199], a[100:103]
    ds_read_b64_tr_b16 v[142:143], v163 offset:28672
    v_mfma_f32_16x16x32_bf16 a[104:107], v[152:155], a[200:203], a[104:107]
    v_mfma_f32_16x16x32_bf16 a[108:111], v[152:155], a[204:207], a[108:111]
    ds_read_b64_tr_b16 v[144:145], v164 offset:24576
    s_waitcnt lgkmcnt(9)
    v_mfma_f32_16x16x32_bf16 a[124:127], v[156:159], a[204:207], a[124:127]
    v_mfma_f32_16x16x32_bf16 a[120:123], v[156:159], a[200:203], a[120:123]
    ds_read_b64_tr_b16 v[146:147], v164 offset:28672
    v_mfma_f32_16x16x32_bf16 a[116:119], v[156:159], a[196:199], a[116:119]
    v_mfma_f32_16x16x32_bf16 a[112:115], v[156:159], a[192:195], a[112:115]
    ds_read_b64_tr_b16 v[148:149], v165 offset:24576
    s_waitcnt lgkmcnt(9)
    v_mfma_f32_16x16x32_bf16 a[0:3], v[128:131], a[208:211], a[0:3]
    v_mfma_f32_16x16x32_bf16 a[4:7], v[128:131], a[212:215], a[4:7]
    ds_read_b64_tr_b16 v[150:151], v165 offset:28672
    v_mfma_f32_16x16x32_bf16 a[8:11], v[128:131], a[216:219], a[8:11]
    v_mfma_f32_16x16x32_bf16 a[12:15], v[128:131], a[220:223], a[12:15]
    ds_read_b64_tr_b16 v[152:153], v166 offset:24576
    s_waitcnt lgkmcnt(9)
    v_mfma_f32_16x16x32_bf16 a[28:31], v[132:135], a[220:223], a[28:31]
    v_mfma_f32_16x16x32_bf16 a[24:27], v[132:135], a[216:219], a[24:27]
    ds_read_b64_tr_b16 v[154:155], v166 offset:28672
    s_sub_u32 s80, s29, 7
    s_lshl_b32 s80, s80, 8
    v_add_u32 v92, s80, v178
    v_add_u32 v64, 0x0, v92
    v_mfma_f32_16x16x32_bf16 a[20:23], v[132:135], a[212:215], a[20:23]
    buffer_load_dwordx4 v[64:67], v64, s[92:95], 0 offen sc1
    v_add_u32 v68, 0x100, v92
    buffer_load_dwordx4 v[68:71], v68, s[92:95], 0 offen sc1
    v_add_u32 v72, 0x200, v92
    buffer_load_dwordx4 v[72:75], v72, s[92:95], 0 offen sc1
    v_mfma_f32_16x16x32_bf16 a[16:19], v[132:135], a[208:211], a[16:19]
    ds_read_b64_tr_b16 v[156:157], v167 offset:24576
    v_add_u32 v76, 0x300, v92
    buffer_load_dwordx4 v[76:79], v76, s[92:95], 0 offen sc1
    v_add_u32 v80, 0x400, v92
    buffer_load_dwordx4 v[80:83], v80, s[92:95], 0 offen sc1
    s_waitcnt lgkmcnt(9)
    v_mfma_f32_16x16x32_bf16 a[32:35], v[136:139], a[208:211], a[32:35]
    v_add_u32 v84, 0x500, v92
    buffer_load_dwordx4 v[84:87], v84, s[92:95], 0 offen sc1
    v_add_u32 v88, 0x600, v92
    buffer_load_dwordx4 v[88:91], v88, s[92:95], 0 offen sc1
    v_mfma_f32_16x16x32_bf16 a[36:39], v[136:139], a[212:215], a[36:39]
    ds_read_b64_tr_b16 v[158:159], v167 offset:28672
    v_mfma_f32_16x16x32_bf16 a[40:43], v[136:139], a[216:219], a[40:43]
    v_mfma_f32_16x16x32_bf16 a[44:47], v[136:139], a[220:223], a[44:47]
    s_waitcnt lgkmcnt(8)
    v_mfma_f32_16x16x32_bf16 a[60:63], v[140:143], a[220:223], a[60:63]
    v_mfma_f32_16x16x32_bf16 a[56:59], v[140:143], a[216:219], a[56:59]
    v_mfma_f32_16x16x32_bf16 a[52:55], v[140:143], a[212:215], a[52:55]
    v_mfma_f32_16x16x32_bf16 a[48:51], v[140:143], a[208:211], a[48:51]
    s_waitcnt lgkmcnt(6)
    v_mfma_f32_16x16x32_bf16 a[64:67], v[144:147], a[208:211], a[64:67]
    v_mfma_f32_16x16x32_bf16 a[68:71], v[144:147], a[212:215], a[68:71]
    v_mfma_f32_16x16x32_bf16 a[72:75], v[144:147], a[216:219], a[72:75]
    v_mfma_f32_16x16x32_bf16 a[76:79], v[144:147], a[220:223], a[76:79]
    s_waitcnt vmcnt(33) lgkmcnt(0)
    s_barrier
    ds_read_b64_tr_b16 v[128:129], v160 offset:32768
    v_mfma_f32_16x16x32_bf16 a[92:95], v[148:151], a[220:223], a[92:95]
    ds_read_b64_tr_b16 v[130:131], v160 offset:36864
    s_add_u32 m0, s3, 0x4000
    s_add_u32 s76, s34, 0x80000
    v_mfma_f32_16x16x32_bf16 a[88:91], v[148:151], a[216:219], a[88:91]
    ds_read_b64_tr_b16 v[132:133], v161 offset:32768
    buffer_load_dwordx4 v188, s[8:11], s76 offen offset:0 lds
    v_mfma_f32_16x16x32_bf16 a[84:87], v[148:151], a[212:215], a[84:87]
    ds_read_b64_tr_b16 v[134:135], v161 offset:36864
    v_mfma_f32_16x16x32_bf16 a[80:83], v[148:151], a[208:211], a[80:83]
    ds_read_b64_tr_b16 v[136:137], v162 offset:32768
    buffer_load_dwordx4 v189, s[8:11], s76 offen offset:1024 lds
    v_mfma_f32_16x16x32_bf16 a[96:99], v[152:155], a[208:211], a[96:99]
    ds_read_b64_tr_b16 v[138:139], v162 offset:36864
    v_mfma_f32_16x16x32_bf16 a[100:103], v[152:155], a[212:215], a[100:103]
    ds_read_b64_tr_b16 v[140:141], v163 offset:32768
    buffer_load_dwordx4 v190, s[8:11], s76 offen offset:2048 lds
    v_mfma_f32_16x16x32_bf16 a[104:107], v[152:155], a[216:219], a[104:107]
    ds_read_b64_tr_b16 v[142:143], v163 offset:36864
    v_mfma_f32_16x16x32_bf16 a[108:111], v[152:155], a[220:223], a[108:111]
    ds_read_b64_tr_b16 v[144:145], v164 offset:32768
    buffer_load_dwordx4 v192, s[8:11], s76 offen offset:3072 lds
    v_mfma_f32_16x16x32_bf16 a[124:127], v[156:159], a[220:223], a[124:127]
    ds_read_b64_tr_b16 v[146:147], v164 offset:36864
    v_mfma_f32_16x16x32_bf16 a[120:123], v[156:159], a[216:219], a[120:123]
    v_mfma_f32_16x16x32_bf16 a[116:119], v[156:159], a[212:215], a[116:119]
    v_mfma_f32_16x16x32_bf16 a[112:115], v[156:159], a[208:211], a[112:115]
    ds_read_b64_tr_b16 v[148:149], v165 offset:32768
    s_waitcnt lgkmcnt(9)
    v_mfma_f32_16x16x32_bf16 a[0:3], v[128:131], a[224:227], a[0:3]
    s_waitcnt vmcnt(11)
    v_cmp_eq_u32 vcc, 1, v174
    s_cmp_eq_u64 vcc, -1
    s_cbranch_scc0 chk_4_slow
chk_4_ok:
    s_add_u32 s77, s33, 0x1000
    buffer_load_dwordx4 a[160:163], v179, s[16:19], s77 offen offset:0 sc1
    v_mfma_f32_16x16x32_bf16 a[4:7], v[128:131], a[228:231], a[4:7]
    ds_read_b64_tr_b16 v[150:151], v165 offset:36864
    v_mfma_f32_16x16x32_bf16 a[8:11], v[128:131], a[232:235], a[8:11]
    v_mfma_f32_16x16x32_bf16 a[12:15], v[128:131], a[236:239], a[12:15]
    ds_read_b64_tr_b16 v[152:153], v166 offset:32768
    buffer_load_dwordx4 a[164:167], v179, s[16:19], s77 offen offset:1024 sc1
    s_waitcnt lgkmcnt(9)
    v_mfma_f32_16x16x32_bf16 a[28:31], v[132:135], a[236:239], a[28:31]
    v_mfma_f32_16x16x32_bf16 a[24:27], v[132:135], a[232:235], a[24:27]
    ds_read_b64_tr_b16 v[154:155], v166 offset:36864
    v_mfma_f32_16x16x32_bf16 a[20:23], v[132:135], a[228:231], a[20:23]
    buffer_load_dwordx4 a[168:171], v179, s[16:19], s77 offen offset:2048 sc1
    v_mfma_f32_16x16x32_bf16 a[16:19], v[132:135], a[224:227], a[16:19]
    ds_read_b64_tr_b16 v[156:157], v167 offset:32768
    s_waitcnt lgkmcnt(9)
    v_mfma_f32_16x16x32_bf16 a[32:35], v[136:139], a[224:227], a[32:35]
    v_mfma_f32_16x16x32_bf16 a[36:39], v[136:139], a[228:231], a[36:39]
    ds_read_b64_tr_b16 v[158:159], v167 offset:36864
    buffer_load_dwordx4 a[172:175], v179, s[16:19], s77 offen offset:3072 sc1
    v_mfma_f32_16x16x32_bf16 a[40:43], v[136:139], a[232:235], a[40:43]
    v_mfma_f32_16x16x32_bf16 a[44:47], v[136:139], a[236:239], a[44:47]
    ds_read_b64_tr_b16 v[128:129], v160 offset:40960
    s_waitcnt lgkmcnt(9)
    v_mfma_f32_16x16x32_bf16 a[60:63], v[140:143], a[236:239], a[60:63]
    s_add_u32 s77, s33, 0x5000
    buffer_load_dwordx4 a[176:179], v179, s[16:19], s77 offen offset:0 sc1
    v_mfma_f32_16x16x32_bf16 a[56:59], v[140:143], a[232:235], a[56:59]
    ds_read_b64_tr_b16 v[130:131], v160 offset:45056
    v_mfma_f32_16x16x32_bf16 a[52:55], v[140:143], a[228:231], a[52:55]
    v_mfma_f32_16x16x32_bf16 a[48:51], v[140:143], a[224:227], a[48:51]
    ds_read_b64_tr_b16 v[132:133], v161 offset:40960
    buffer_load_dwordx4 a[180:183], v179, s[16:19], s77 offen offset:1024 sc1
    s_waitcnt lgkmcnt(9)
    v_mfma_f32_16x16x32_bf16 a[64:67], v[144:147], a[224:227], a[64:67]
    v_mfma_f32_16x16x32_bf16 a[68:71], v[144:147], a[228:231], a[68:71]
    ds_read_b64_tr_b16 v[134:135], v161 offset:45056
    v_mfma_f32_16x16x32_bf16 a[72:75], v[144:147], a[232:235], a[72:75]
    buffer_load_dwordx4 a[184:187], v179, s[16:19], s77 offen offset:2048 sc1
    v_mfma_f32_16x16x32_bf16 a[76:79], v[144:147], a[236:239], a[76:79]
    ds_read_b64_tr_b16 v[136:137], v162 offset:40960
    s_waitcnt lgkmcnt(9)
    v_mfma_f32_16x16x32_bf16 a[92:95], v[148:151], a[236:239], a[92:95]
    v_mfma_f32_16x16x32_bf16 a[88:91], v[148:151], a[232:235], a[88:91]
    ds_read_b64_tr_b16 v[138:139], v162 offset:45056
    buffer_load_dwordx4 a[188:191], v179, s[16:19], s77 offen offset:3072 sc1
    v_mfma_f32_16x16x32_bf16 a[84:87], v[148:151], a[228:231], a[84:87]
    v_mfma_f32_16x16x32_bf16 a[80:83], v[148:151], a[224:227], a[80:83]
    ds_read_b64_tr_b16 v[140:141], v163 offset:40960
    s_waitcnt lgkmcnt(9)
    v_mfma_f32_16x16x32_bf16 a[96:99], v[152:155], a[224:227], a[96:99]
    s_add_u32 s77, s33, 0x8000
    buffer_load_dwordx4 a[192:195], v179, s[16:19], s77 offen offset:0 sc1
    v_mfma_f32_16x16x32_bf16 a[100:103], v[152:155], a[228:231], a[100:103]
    ds_read_b64_tr_b16 v[142:143], v163 offset:45056
    v_mfma_f32_16x16x32_bf16 a[104:107], v[152:155], a[232:235], a[104:107]
    v_mfma_f32_16x16x32_bf16 a[108:111], v[152:155], a[236:239], a[108:111]
    ds_read_b64_tr_b16 v[144:145], v164 offset:40960
    buffer_load_dwordx4 a[196:199], v179, s[16:19], s77 offen offset:1024 sc1
    s_waitcnt vmcnt(14)
    v_max3_u32 v93, v64, v65, v66
    v_max3_u32 v94, v67, v68, v69
    s_waitcnt lgkmcnt(9)
    v_mfma_f32_16x16x32_bf16 a[124:127], v[156:159], a[236:239], a[124:127]
    v_max3_u32 v93, v93, v70, v71
    v_max3_u32 v94, v94, v72, v73
    v_max3_u32 v93, v93, v74, v75
    v_max3_u32 v94, v94, v76, v77
    v_max3_u32 v93, v93, v78, v79
    v_mfma_f32_16x16x32_bf16 a[120:123], v[156:159], a[232:235], a[120:123]
    ds_read_b64_tr_b16 v[146:147], v164 offset:45056
    v_max3_u32 v94, v94, v80, v81
    v_max3_u32 v93, v93, v82, v83
    v_max3_u32 v94, v94, v84, v85
    v_max3_u32 v93, v93, v86, v87
    v_mfma_f32_16x16x32_bf16 a[116:119], v[156:159], a[228:231], a[116:119]
    buffer_load_dwordx4 a[200:203], v179, s[16:19], s77 offen offset:2048 sc1
    v_max3_u32 v94, v94, v88, v89
    v_max3_u32 v93, v93, v90, v91
    v_max_u32 v93, v93, v94
    v_cmp_eq_u32 vcc, -1, v93
    s_cmp_eq_u64 vcc, 0
    s_cbranch_scc0 lbc_slow
lbc_ok:
    v_mfma_f32_16x16x32_bf16 a[112:115], v[156:159], a[224:227], a[112:115]
    ds_read_b64_tr_b16 v[148:149], v165 offset:40960
    v_fma_f32 v104, v216, v64, v68
    v_fma_f32 v105, v217, v65, v69
    v_fma_f32 v106, v216, v66, v70
    s_waitcnt lgkmcnt(9)
    v_mfma_f32_16x16x32_bf16 a[0:3], v[128:131], a[240:243], a[0:3]
    v_fma_f32 v107, v217, v67, v71
    v_fma_f32 v100, -v218, v66, v104
    v_fma_f32 v101, -v219, v67, v105
    v_fma_f32 v102, v218, v64, v106
    v_fma_f32 v103, v219, v65, v107
    v_mfma_f32_16x16x32_bf16 a[4:7], v[128:131], a[244:247], a[4:7]
    ds_read_b64_tr_b16 v[150:151], v165 offset:45056
    buffer_load_dwordx4 a[204:207], v179, s[16:19], s77 offen offset:3072 sc1
    v_fma_f32 v104, v216, v100, v72
    v_fma_f32 v105, v217, v101, v73
    v_fma_f32 v106, v216, v102, v74
    v_mfma_f32_16x16x32_bf16 a[8:11], v[128:131], a[248:251], a[8:11]
    v_fma_f32 v107, v217, v103, v75
    v_fma_f32 v96, -v218, v102, v104
    v_fma_f32 v97, -v219, v103, v105
    v_fma_f32 v98, v218, v100, v106
    v_fma_f32 v99, v219, v101, v107
    v_mfma_f32_16x16x32_bf16 a[12:15], v[128:131], a[252:255], a[12:15]
    ds_read_b64_tr_b16 v[152:153], v166 offset:40960
    v_fma_f32 v104, v216, v96, v76
    v_fma_f32 v105, v217, v97, v77
    v_fma_f32 v106, v216, v98, v78
    v_fma_f32 v107, v217, v99, v79
    s_waitcnt lgkmcnt(9)
    v_mfma_f32_16x16x32_bf16 a[28:31], v[132:135], a[252:255], a[28:31]
    s_add_u32 s77, s33, 0xc000
    buffer_load_dwordx4 a[208:211], v179, s[16:19], s77 offen offset:0 sc1
    v_fma_f32 v100, -v218, v98, v104
    v_fma_f32 v101, -v219, v99, v105
    v_fma_f32 v102, v218, v96, v106
    v_mfma_f32_16x16x32_bf16 a[24:27], v[132:135], a[248:251], a[24:27]
    ds_read_b64_tr_b16 v[154:155], v166 offset:45056
    v_fma_f32 v103, v219, v97, v107
    v_fma_f32 v104, v216, v100, v80
    v_fma_f32 v105, v217, v101, v81
    v_fma_f32 v106, v216, v102, v82
    v_mfma_f32_16x16x32_bf16 a[20:23], v[132:135], a[244:247], a[20:23]
    v_fma_f32 v107, v217, v103, v83
    v_fma_f32 v96, -v218, v102, v104
    v_fma_f32 v97, -v219, v103, v105
    v_fma_f32 v98, v218, v100, v106
    v_fma_f32 v99, v219, v101, v107
    v_mfma_f32_16x16x32_bf16 a[16:19], v[132:135], a[240:243], a[16:19]
    ds_read_b64_tr_b16 v[156:157], v167 offset:40960
    buffer_load_dwordx4 a[212:215], v179, s[16:19], s77 offen offset:1024 sc1
    v_fma_f32 v104, v216, v96, v84
    v_fma_f32 v105, v217, v97, v85
    v_fma_f32 v106, v216, v98, v86
    s_waitcnt lgkmcnt(9)
    v_mfma_f32_16x16x32_bf16 a[32:35], v[136:139], a[240:243], a[32:35]
    v_fma_f32 v107, v217, v99, v87
    v_fma_f32 v100, -v218, v98, v104
    v_fma_f32 v101, -v219, v99, v105
    v_fma_f32 v102, v218, v96, v106
    v_fma_f32 v103, v219, v97, v107
    v_mfma_f32_16x16x32_bf16 a[36:39], v[136:139], a[244:247], a[36:39]
    ds_read_b64_tr_b16 v[158:159], v167 offset:45056
    v_fma_f32 v104, v216, v100, v88
    v_fma_f32 v105, v217, v101, v89
    v_fma_f32 v106, v216, v102, v90
    v_fma_f32 v107, v217, v103, v91
    v_mfma_f32_16x16x32_bf16 a[40:43], v[136:139], a[248:251], a[40:43]
    buffer_load_dwordx4 a[216:219], v179, s[16:19], s77 offen offset:2048 sc1
    v_fma_f32 v96, -v218, v102, v104
    v_fma_f32 v97, -v219, v103, v105
    v_fma_f32 v98, v218, v100, v106
    v_fma_f32 v99, v219, v101, v107
    v_mfma_f32_16x16x32_bf16 a[44:47], v[136:139], a[252:255], a[44:47]
    v_fma_f32 v104, v220, v96, v236
    v_fma_f32 v105, v221, v97, v237
    v_fma_f32 v106, v220, v98, v238
    v_fma_f32 v107, v221, v99, v239
    v_fma_f32 v232, -v222, v98, v104
    s_waitcnt lgkmcnt(8)
    v_mfma_f32_16x16x32_bf16 a[60:63], v[140:143], a[252:255], a[60:63]
    v_fma_f32 v233, -v223, v99, v105
    v_fma_f32 v234, v222, v96, v106
    v_fma_f32 v235, v223, v97, v107
    v_fma_f32 v104, v244, v232, v228
    v_fma_f32 v105, v245, v233, v229
    v_mfma_f32_16x16x32_bf16 a[56:59], v[140:143], a[248:251], a[56:59]
    buffer_load_dwordx4 a[220:223], v179, s[16:19], s77 offen offset:3072 sc1
    v_fma_f32 v106, v244, v234, v230
    v_fma_f32 v107, v245, v235, v231
    v_fma_f32 v240, -v246, v234, v104
    v_fma_f32 v241, -v247, v235, v105
    v_mfma_f32_16x16x32_bf16 a[52:55], v[140:143], a[244:247], a[52:55]
    v_fma_f32 v242, v246, v232, v106
    v_fma_f32 v243, v247, v233, v107
    v_mov_b32 v64, v232
    v_mov_b32 v65, v240
    v_mov_b32 v66, v234
    v_mfma_f32_16x16x32_bf16 a[48:51], v[140:143], a[240:243], a[48:51]
    v_mov_b32 v67, v242
    v_mov_b32 v72, v233
    v_mov_b32 v73, v241
    v_mov_b32 v74, v235
    v_mov_b32 v75, v243
    s_waitcnt lgkmcnt(6)
    v_mfma_f32_16x16x32_bf16 a[64:67], v[144:147], a[240:243], a[64:67]
    v_fma_f32 v68, v204, v64, v0
    v_fma_f32 v69, v204, v65, v1
    v_fma_f32 v70, v204, v66, v16
    v_fma_f32 v71, v204, v67, v17
    v_fma_f32 v76, v206, v72, v32
    v_mfma_f32_16x16x32_bf16 a[68:71], v[144:147], a[244:247], a[68:71]
    v_fma_f32 v77, v206, v73, v33
    v_fma_f32 v78, v206, v74, v48
    v_fma_f32 v79, v206, v75, v49
    v_fma_f32 v68, -v205, v66, v68
    v_fma_f32 v69, -v205, v67, v69
    v_mfma_f32_16x16x32_bf16 a[72:75], v[144:147], a[248:251], a[72:75]
    v_fma_f32 v70, v205, v64, v70
    v_fma_f32 v71, v205, v65, v71
    v_fma_f32 v76, -v207, v74, v76
    v_fma_f32 v77, -v207, v75, v77
    v_fma_f32 v78, v207, v72, v78
    v_mfma_f32_16x16x32_bf16 a[76:79], v[144:147], a[252:255], a[76:79]
    s_waitcnt vmcnt(34) lgkmcnt(0)
    s_barrier
    ds_read_b64_tr_b16 v[128:129], v160 offset:49152
    v_mfma_f32_16x16x32_bf16 a[92:95], v[148:151], a[252:255], a[92:95]
    ds_read_b64_tr_b16 v[130:131], v160 offset:53248
    s_add_u32 m0, s3, 0x8000
    s_add_u32 s76, s34, 0xf0000
    v_mfma_f32_16x16x32_bf16 a[88:91], v[148:151], a[248:251], a[88:91]
    ds_read_b64_tr_b16 v[132:133], v161 offset:49152
    buffer_load_dwordx4 v188, s[8:11], s76 offen offset:0 lds
    v_fma_f32 v79, v207, v73, v79
    v_mul_f32_e64 v80, v208, v68
    v_mul_f32_e64 v81, v208, v69
    v_mfma_f32_16x16x32_bf16 a[84:87], v[148:151], a[244:247], a[84:87]
    ds_read_b64_tr_b16 v[134:135], v161 offset:53248
    v_mul_f32_e64 v82, -v208, v70
    v_mul_f32_e64 v83, -v208, v71
    v_mul_f32_e64 v84, v210, v76
    v_mul_f32_e64 v85, v210, v77
    v_mfma_f32_16x16x32_bf16 a[80:83], v[148:151], a[240:243], a[80:83]
    ds_read_b64_tr_b16 v[136:137], v162 offset:49152
    buffer_load_dwordx4 v189, s[8:11], s76 offen offset:1024 lds
    v_mul_f32_e64 v86, -v210, v78
    v_mul_f32_e64 v87, -v210, v79
    v_fma_f32 v0, -v209, v70, v80
    v_mfma_f32_16x16x32_bf16 a[96:99], v[152:155], a[240:243], a[96:99]
    ds_read_b64_tr_b16 v[138:139], v162 offset:53248
    v_fma_f32 v1, -v209, v71, v81
    v_fma_f32 v16, -v209, v68, v82
    v_fma_f32 v17, -v209, v69, v83
    v_fma_f32 v32, -v211, v78, v84
    v_mfma_f32_16x16x32_bf16 a[100:103], v[152:155], a[244:247], a[100:103]
    ds_read_b64_tr_b16 v[140:141], v163 offset:49152
    buffer_load_dwordx4 v190, s[8:11], s76 offen offset:2048 lds
    v_fma_f32 v33, -v211, v79, v85
    v_fma_f32 v48, -v211, v76, v86
    v_fma_f32 v49, -v211, v77, v87
    v_mfma_f32_16x16x32_bf16 a[104:107], v[152:155], a[248:251], a[104:107]
    ds_read_b64_tr_b16 v[142:143], v163 offset:53248
    v_fma_f32 v64, v204, v68, v2
    v_fma_f32 v65, v204, v69, v3
    v_fma_f32 v66, v204, v70, v18
    v_fma_f32 v67, v204, v71, v19
    v_mfma_f32_16x16x32_bf16 a[108:111], v[152:155], a[252:255], a[108:111]
    ds_read_b64_tr_b16 v[144:145], v164 offset:49152
    buffer_load_dwordx4 v192, s[8:11], s76 offen offset:3072 lds
    v_fma_f32 v72, v206, v76, v34
    v_fma_f32 v73, v206, v77, v35
    v_fma_f32 v74, v206, v78, v50
    v_mfma_f32_16x16x32_bf16 a[124:127], v[156:159], a[252:255], a[124:127]
    ds_read_b64_tr_b16 v[146:147], v164 offset:53248
    v_fma_f32 v75, v206, v79, v51
    v_fma_f32 v64, -v205, v70, v64
    v_fma_f32 v65, -v205, v71, v65
    v_fma_f32 v66, v205, v68, v66
    v_mfma_f32_16x16x32_bf16 a[120:123], v[156:159], a[248:251], a[120:123]
    v_fma_f32 v67, v205, v69, v67
    v_fma_f32 v72, -v207, v78, v72
    v_fma_f32 v73, -v207, v79, v73
    v_fma_f32 v74, v207, v76, v74
    v_fma_f32 v75, v207, v77, v75
    v_mfma_f32_16x16x32_bf16 a[116:119], v[156:159], a[244:247], a[116:119]
    v_mul_f32_e64 v80, v208, v64
    v_mul_f32_e64 v81, v208, v65
    v_mul_f32_e64 v82, -v208, v66
    v_mul_f32_e64 v83, -v208, v67
    v_mul_f32_e64 v84, v210, v72
    v_mfma_f32_16x16x32_bf16 a[112:115], v[156:159], a[240:243], a[112:115]
    ds_read_b64_tr_b16 v[148:149], v165 offset:49152
    v_mul_f32_e64 v85, v210, v73
    v_mul_f32_e64 v86, -v210, v74
    v_mul_f32_e64 v87, -v210, v75
    v_fma_f32 v2, -v209, v66, v80
    s_waitcnt lgkmcnt(9)
    v_mfma_f32_16x16x32_bf16 a[0:3], v[128:131], a[128:131], a[0:3]
    s_add_u32 s77, s33, 0xf000
    buffer_load_dwordx4 a[224:227], v179, s[16:19], s77 offen offset:0 sc1
    v_fma_f32 v3, -v209, v67, v81
    v_fma_f32 v18, -v209, v64, v82
    v_fma_f32 v19, -v209, v65, v83
    v_mfma_f32_16x16x32_bf16 a[4:7], v[128:131], a[132:135], a[4:7]
    ds_read_b64_tr_b16 v[150:151], v165 offset:53248
    v_fma_f32 v34, -v211, v74, v84
    v_fma_f32 v35, -v211, v75, v85
    v_fma_f32 v50, -v211, v72, v86
    v_fma_f32 v51, -v211, v73, v87
    v_mfma_f32_16x16x32_bf16 a[8:11], v[128:131], a[136:139], a[8:11]
    v_fma_f32 v68, v204, v64, v4
    v_fma_f32 v69, v204, v65, v5
    v_fma_f32 v70, v204, v66, v20
    v_fma_f32 v71, v204, v67, v21
    v_fma_f32 v76, v206, v72, v36
    v_mfma_f32_16x16x32_bf16 a[12:15], v[128:131], a[140:143], a[12:15]
    ds_read_b64_tr_b16 v[152:153], v166 offset:49152
    v_fma_f32 v77, v206, v73, v37
    v_fma_f32 v78, v206, v74, v52
    v_fma_f32 v79, v206, v75, v53
    v_fma_f32 v68, -v205, v66, v68
    s_waitcnt lgkmcnt(9)
    v_mfma_f32_16x16x32_bf16 a[28:31], v[132:135], a[140:143], a[28:31]
    buffer_load_dwordx4 a[228:231], v179, s[16:19], s77 offen offset:1024 sc1
    v_fma_f32 v69, -v205, v67, v69
    v_fma_f32 v70, v205, v64, v70
    v_fma_f32 v71, v205, v65, v71
    v_fma_f32 v76, -v207, v74, v76
    v_mfma_f32_16x16x32_bf16 a[24:27], v[132:135], a[136:139], a[24:27]
    ds_read_b64_tr_b16 v[154:155], v166 offset:53248
    v_fma_f32 v77, -v207, v75, v77
    v_fma_f32 v78, v207, v72, v78
    v_fma_f32 v79, v207, v73, v79
    v_mul_f32_e64 v80, v208, v68
    v_mfma_f32_16x16x32_bf16 a[20:23], v[132:135], a[132:135], a[20:23]
    v_mul_f32_e64 v81, v208, v69
    v_mul_f32_e64 v82, -v208, v70
    v_mul_f32_e64 v83, -v208, v71
    v_mul_f32_e64 v84, v210, v76
    v_mul_f32_e64 v85, v210, v77
    v_mfma_f32_16x16x32_bf16 a[16:19], v[132:135], a[128:131], a[16:19]
    ds_read_b64_tr_b16 v[156:157], v167 offset:49152
    v_mul_f32_e64 v86, -v210, v78
    v_mul_f32_e64 v87, -v210, v79
    v_fma_f32 v4, -v209, v70, v80
    v_fma_f32 v5, -v209, v71, v81
    s_waitcnt lgkmcnt(9)
    v_mfma_f32_16x16x32_bf16 a[32:35], v[136:139], a[128:131], a[32:35]
    buffer_load_dwordx4 a[232:235], v179, s[16:19], s77 offen offset:2048 sc1
    v_fma_f32 v20, -v209, v68, v82
    v_fma_f32 v21, -v209, v69, v83
    v_fma_f32 v36, -v211, v78, v84
    v_fma_f32 v37, -v211, v79, v85
    v_mfma_f32_16x16x32_bf16 a[36:39], v[136:139], a[132:135], a[36:39]
    ds_read_b64_tr_b16 v[158:159], v167 offset:53248
    v_fma_f32 v52, -v211, v76, v86
    v_fma_f32 v53, -v211, v77, v87
    v_fma_f32 v64, v204, v68, v6
    v_fma_f32 v65, v204, v69, v7
    v_mfma_f32_16x16x32_bf16 a[40:43], v[136:139], a[136:139], a[40:43]
    v_fma_f32 v66, v204, v70, v22
    v_fma_f32 v67, v204, v71, v23
    v_fma_f32 v72, v206, v76, v38
    v_fma_f32 v73, v206, v77, v39
    v_fma_f32 v74, v206, v78, v54
    v_mfma_f32_16x16x32_bf16 a[44:47], v[136:139], a[140:143], a[44:47]
    ds_read_b64_tr_b16 v[128:129], v160 offset:57344
    v_fma_f32 v75, v206, v79, v55
    v_fma_f32 v64, -v205, v70, v64
    v_fma_f32 v65, -v205, v71, v65
    v_fma_f32 v66, v205, v68, v66
    s_waitcnt lgkmcnt(9)
    v_mfma_f32_16x16x32_bf16 a[60:63], v[140:143], a[140:143], a[60:63]
    buffer_load_dwordx4 a[236:239], v179, s[16:19], s77 offen offset:3072 sc1
    v_fma_f32 v67, v205, v69, v67
    v_fma_f32 v72, -v207, v78, v72
    v_fma_f32 v73, -v207, v79, v73
    v_fma_f32 v74, v207, v76, v74
    v_mfma_f32_16x16x32_bf16 a[56:59], v[140:143], a[136:139], a[56:59]
    ds_read_b64_tr_b16 v[130:131], v160 offset:61440
    v_fma_f32 v75, v207, v77, v75
    v_mul_f32_e64 v80, v208, v64
    v_mul_f32_e64 v81, v208, v65
    v_mul_f32_e64 v82, -v208, v66
    v_mfma_f32_16x16x32_bf16 a[52:55], v[140:143], a[132:135], a[52:55]
    v_mul_f32_e64 v83, -v208, v67
    v_mul_f32_e64 v84, v210, v72
    v_mul_f32_e64 v85, v210, v73
    v_mul_f32_e64 v86, -v210, v74
    v_mul_f32_e64 v87, -v210, v75
    v_mfma_f32_16x16x32_bf16 a[48:51], v[140:143], a[128:131], a[48:51]
    ds_read_b64_tr_b16 v[132:133], v161 offset:57344
    v_fma_f32 v6, -v209, v66, v80
    v_fma_f32 v7, -v209, v67, v81
    v_fma_f32 v22, -v209, v64, v82
    v_fma_f32 v23, -v209, v65, v83
    s_waitcnt lgkmcnt(9)
    v_mfma_f32_16x16x32_bf16 a[64:67], v[144:147], a[128:131], a[64:67]
    s_add_u32 s77, s33, 0x13000
    buffer_load_dwordx4 a[240:243], v179, s[16:19], s77 offen offset:0 sc1
    v_fma_f32 v38, -v211, v74, v84
    v_fma_f32 v39, -v211, v75, v85
    v_fma_f32 v54, -v211, v72, v86
    v_mfma_f32_16x16x32_bf16 a[68:71], v[144:147], a[132:135], a[68:71]
    ds_read_b64_tr_b16 v[134:135], v161 offset:61440
    v_fma_f32 v55, -v211, v73, v87
    v_fma_f32 v68, v204, v64, v8
    v_fma_f32 v69, v204, v65, v9
    v_fma_f32 v70, v204, v66, v24
    v_mfma_f32_16x16x32_bf16 a[72:75], v[144:147], a[136:139], a[72:75]
    v_fma_f32 v71, v204, v67, v25
    v_fma_f32 v76, v206, v72, v40
    v_fma_f32 v77, v206, v73, v41
    v_fma_f32 v78, v206, v74, v56
    v_fma_f32 v79, v206, v75, v57
    v_mfma_f32_16x16x32_bf16 a[76:79], v[144:147], a[140:143], a[76:79]
    ds_read_b64_tr_b16 v[136:137], v162 offset:57344
    v_fma_f32 v68, -v205, v66, v68
    v_fma_f32 v69, -v205, v67, v69
    v_fma_f32 v70, v205, v64, v70
    v_fma_f32 v71, v205, v65, v71
    s_waitcnt lgkmcnt(9)
    v_mfma_f32_16x16x32_bf16 a[92:95], v[148:151], a[140:143], a[92:95]
    buffer_load_dwordx4 a[244:247], v179, s[16:19], s77 offen offset:1024 sc1
    v_fma_f32 v76, -v207, v74, v76
    v_fma_f32 v77, -v207, v75, v77
    v_fma_f32 v78, v207, v72, v78
    v_fma_f32 v79, v207, v73, v79
    v_mfma_f32_16x16x32_bf16 a[88:91], v[148:151], a[136:139], a[88:91]
    ds_read_b64_tr_b16 v[138:139], v162 offset:61440
    v_mul_f32_e64 v80, v208, v68
    v_mul_f32_e64 v81, v208, v69
    v_mul_f32_e64 v82, -v208, v70
    v_mul_f32_e64 v83, -v208, v71
    v_mfma_f32_16x16x32_bf16 a[84:87], v[148:151], a[132:135], a[84:87]
    v_mul_f32_e64 v84, v210, v76
    v_mul_f32_e64 v85, v210, v77
    v_mul_f32_e64 v86, -v210, v78
    v_mul_f32_e64 v87, -v210, v79
    v_fma_f32 v8, -v209, v70, v80
    v_mfma_f32_16x16x32_bf16 a[80:83], v[148:151], a[128:131], a[80:83]
    ds_read_b64_tr_b16 v[140:141], v163 offset:57344
    v_fma_f32 v9, -v209, v71, v81
    v_fma_f32 v24, -v209, v68, v82
    v_fma_f32 v25, -v209, v69, v83
    v_fma_f32 v40, -v211, v78, v84
    s_waitcnt lgkmcnt(9)
    v_mfma_f32_16x16x32_bf16 a[96:99], v[152:155], a[128:131], a[96:99]
    buffer_load_dwordx4 a[248:251], v179, s[16:19], s77 offen offset:2048 sc1
    v_fma_f32 v41, -v211, v79, v85
    v_fma_f32 v56, -v211, v76, v86
    v_fma_f32 v57, -v211, v77, v87
    v_fma_f32 v64, v204, v68, v10
    v_mfma_f32_16x16x32_bf16 a[100:103], v[152:155], a[132:135], a[100:103]
    ds_read_b64_tr_b16 v[142:143], v163 offset:61440
    v_fma_f32 v65, v204, v69, v11
    v_fma_f32 v66, v204, v70, v26
    v_fma_f32 v67, v204, v71, v27
    v_fma_f32 v72, v206, v76, v42
    v_mfma_f32_16x16x32_bf16 a[104:107], v[152:155], a[136:139], a[104:107]
    v_fma_f32 v73, v206, v77, v43
    v_fma_f32 v74, v206, v78, v58
    v_fma_f32 v75, v206, v79, v59
    v_fma_f32 v64, -v205, v70, v64
    v_fma_f32 v65, -v205, v71, v65
    v_mfma_f32_16x16x32_bf16 a[108:111], v[152:155], a[140:143], a[108:111]
    ds_read_b64_tr_b16 v[144:145], v164 offset:57344
    v_fma_f32 v66, v205, v68, v66
    v_fma_f32 v67, v205, v69, v67
    v_fma_f32 v72, -v207, v78, v72
    v_fma_f32 v73, -v207, v79, v73
    s_waitcnt lgkmcnt(9)
    v_mfma_f32_16x16x32_bf16 a[124:127], v[156:159], a[140:143], a[124:127]
    buffer_load_dwordx4 a[252:255], v179, s[16:19], s77 offen offset:3072 sc1
    v_fma_f32 v74, v207, v76, v74
    v_fma_f32 v75, v207, v77, v75
    v_mul_f32_e64 v80, v208, v64
    v_mul_f32_e64 v81, v208, v65
    v_mfma_f32_16x16x32_bf16 a[120:123], v[156:159], a[136:139], a[120:123]
    ds_read_b64_tr_b16 v[146:147], v164 offset:61440
    v_mul_f32_e64 v82, -v208, v66
    v_mul_f32_e64 v83, -v208, v67
    v_mul_f32_e64 v84, v210, v72
    v_mul_f32_e64 v85, v210, v73
    v_mfma_f32_16x16x32_bf16 a[116:119], v[156:159], a[132:135], a[116:119]
    v_mul_f32_e64 v86, -v210, v74
    v_mul_f32_e64 v87, -v210, v75
    v_fma_f32 v10, -v209, v66, v80
    v_fma_f32 v11, -v209, v67, v81
    v_fma_f32 v26, -v209, v64, v82
    v_mfma_f32_16x16x32_bf16 a[112:115], v[156:159], a[128:131], a[112:115]
    ds_read_b64_tr_b16 v[148:149], v165 offset:57344
    v_fma_f32 v27, -v209, v65, v83
    v_fma_f32 v42, -v211, v74, v84
    v_fma_f32 v43, -v211, v75, v85
    v_fma_f32 v58, -v211, v72, v86
    s_waitcnt lgkmcnt(9)
    v_mfma_f32_16x16x32_bf16 a[0:3], v[128:131], a[144:147], a[0:3]
    v_fma_f32 v59, -v211, v73, v87
    v_fma_f32 v68, v204, v64, v12
    v_fma_f32 v69, v204, v65, v13
    v_fma_f32 v70, v204, v66, v28
    v_fma_f32 v71, v204, v67, v29
    v_mfma_f32_16x16x32_bf16 a[4:7], v[128:131], a[148:151], a[4:7]
    ds_read_b64_tr_b16 v[150:151], v165 offset:61440
    v_fma_f32 v76, v206, v72, v44
    v_fma_f32 v77, v206, v73, v45
    v_fma_f32 v78, v206, v74, v60
    v_fma_f32 v79, v206, v75, v61
    v_mfma_f32_16x16x32_bf16 a[8:11], v[128:131], a[152:155], a[8:11]
    v_fma_f32 v68, -v205, v66, v68
    v_fma_f32 v69, -v205, v67, v69
    v_fma_f32 v70, v205, v64, v70
    v_fma_f32 v71, v205, v65, v71
    v_fma_f32 v76, -v207, v74, v76
    v_mfma_f32_16x16x32_bf16 a[12:15], v[128:131], a[156:159], a[12:15]
    ds_read_b64_tr_b16 v[152:153], v166 offset:57344
    v_fma_f32 v77, -v207, v75, v77
    v_fma_f32 v78, v207, v72, v78
    v_fma_f32 v79, v207, v73, v79
    v_mul_f32_e64 v80, v208, v68
    s_waitcnt lgkmcnt(9)
    v_mfma_f32_16x16x32_bf16 a[28:31], v[132:135], a[156:159], a[28:31]
    v_mul_f32_e64 v81, v208, v69
    v_mul_f32_e64 v82, -v208, v70
    v_mul_f32_e64 v83, -v208, v71
    v_mul_f32_e64 v84, v210, v76
    v_mul_f32_e64 v85, v210, v77
    v_mfma_f32_16x16x32_bf16 a[24:27], v[132:135], a[152:155], a[24:27]
    ds_read_b64_tr_b16 v[154:155], v166 offset:61440
    v_mul_f32_e64 v86, -v210, v78
    v_mul_f32_e64 v87, -v210, v79
    v_fma_f32 v12, -v209, v70, v80
    v_fma_f32 v13, -v209, v71, v81
    v_mfma_f32_16x16x32_bf16 a[20:23], v[132:135], a[148:151], a[20:23]
    v_fma_f32 v28, -v209, v68, v82
    v_fma_f32 v29, -v209, v69, v83
    v_fma_f32 v44, -v211, v78, v84
    v_fma_f32 v45, -v211, v79, v85
    v_fma_f32 v60, -v211, v76, v86
    v_mfma_f32_16x16x32_bf16 a[16:19], v[132:135], a[144:147], a[16:19]
    ds_read_b64_tr_b16 v[156:157], v167 offset:57344
    v_fma_f32 v61, -v211, v77, v87
    v_fma_f32 v64, v204, v68, v14
    v_fma_f32 v65, v204, v69, v15
    v_fma_f32 v66, v204, v70, v30
    s_waitcnt lgkmcnt(9)
    v_mfma_f32_16x16x32_bf16 a[32:35], v[136:139], a[144:147], a[32:35]
    v_fma_f32 v67, v204, v71, v31
    v_fma_f32 v72, v206, v76, v46
    v_fma_f32 v73, v206, v77, v47
    v_fma_f32 v74, v206, v78, v62
    v_fma_f32 v75, v206, v79, v63
    v_mfma_f32_16x16x32_bf16 a[36:39], v[136:139], a[148:151], a[36:39]
    ds_read_b64_tr_b16 v[158:159], v167 offset:61440
    v_fma_f32 v64, -v205, v70, v64
    v_fma_f32 v65, -v205, v71, v65
    v_fma_f32 v66, v205, v68, v66
    v_fma_f32 v67, v205, v69, v67
    v_mfma_f32_16x16x32_bf16 a[40:43], v[136:139], a[152:155], a[40:43]
    v_fma_f32 v72, -v207, v78, v72
    v_fma_f32 v73, -v207, v79, v73
    v_fma_f32 v74, v207, v76, v74
    v_fma_f32 v75, v207, v77, v75
    v_mul_f32_e64 v80, v208, v64
    v_mfma_f32_16x16x32_bf16 a[44:47], v[136:139], a[156:159], a[44:47]
    v_mul_f32_e64 v81, v208, v65
    v_mul_f32_e64 v82, -v208, v66
    v_mul_f32_e64 v83, -v208, v67
    v_mul_f32_e64 v84, v210, v72
    v_mul_f32_e64 v85, v210, v73
    s_waitcnt lgkmcnt(8)
    v_mfma_f32_16x16x32_bf16 a[60:63], v[140:143], a[156:159], a[60:63]
    v_mul_f32_e64 v86, -v210, v74
    v_mul_f32_e64 v87, -v210, v75
    v_fma_f32 v14, -v209, v66, v80
    v_fma_f32 v15, -v209, v67, v81
    v_fma_f32 v30, -v209, v64, v82
    v_mfma_f32_16x16x32_bf16 a[56:59], v[140:143], a[152:155], a[56:59]
    v_fma_f32 v31, -v209, v65, v83
    v_fma_f32 v46, -v211, v74, v84
    v_fma_f32 v47, -v211, v75, v85
    v_fma_f32 v62, -v211, v72, v86
    v_fma_f32 v63, -v211, v73, v87
    v_mfma_f32_16x16x32_bf16 a[52:55], v[140:143], a[148:151], a[52:55]
    s_mul_i32 s80, s28, 8704
    s_add_u32 s80, s80, 0x19000
    v_mul_u32_u24 v88, 0x88, v226
    v_lshl_add_u32 v88, v227, 3, v88
    v_add_u32 v88, s80, v88
    v_mfma_f32_16x16x32_bf16 a[48:51], v[140:143], a[144:147], a[48:51]
    v_bfe_u32 v89, v224, 2, 2
    v_lshl_add_u32 v89, v227, 3, v89
    v_mul_u32_u24 v89, 0x88, v89
    v_and_b32 v90, 3, v224
    v_lshl_add_u32 v89, v90, 3, v89
    s_waitcnt lgkmcnt(6)
    v_mfma_f32_16x16x32_bf16 a[64:67], v[144:147], a[144:147], a[64:67]
    v_add_u32 v89, s80, v89
    v_cvt_pk_bf16_f32 v0, v0, v1
    v_cvt_pk_bf16_f32 v1, v2, v3
    ds_write_b64 v88, v[0:1] offset:0
    v_cvt_pk_bf16_f32 v4, v4, v5
    v_mfma_f32_16x16x32_bf16 a[68:71], v[144:147], a[148:151], a[68:71]
    v_cvt_pk_bf16_f32 v5, v6, v7
    ds_write_b64 v88, v[4:5] offset:32
    v_cvt_pk_bf16_f32 v8, v8, v9
    v_cvt_pk_bf16_f32 v9, v10, v11
    ds_write_b64 v88, v[8:9] offset:64
    v_mfma_f32_16x16x32_bf16 a[72:75], v[144:147], a[152:155], a[72:75]
    v_cvt_pk_bf16_f32 v12, v12, v13
    v_cvt_pk_bf16_f32 v13, v14, v15
    ds_write_b64 v88, v[12:13] offset:96
    v_cvt_pk_bf16_f32 v32, v32, v33
    v_cvt_pk_bf16_f32 v33, v34, v35
    v_mfma_f32_16x16x32_bf16 a[76:79], v[144:147], a[156:159], a[76:79]
    s_waitcnt vmcnt(20) lgkmcnt(0)
    s_barrier
    ds_read_b64_tr_b16 v[128:129], v160 offset:0
    v_mfma_f32_16x16x32_bf16 a[92:95], v[148:151], a[156:159], a[92:95]
    ds_read_b64_tr_b16 v[130:131], v160 offset:4096
    s_add_u32 m0, s3, 0xc000
    s_add_u32 s76, s34, 0x160000
    v_mfma_f32_16x16x32_bf16 a[88:91], v[148:151], a[152:155], a[88:91]
    ds_read_b64_tr_b16 v[132:133], v161 offset:0
    buffer_load_dwordx4 v188, s[8:11], s76 offen offset:0 lds
    ds_write_b64 v88, v[32:33] offset:2176
    v_cvt_pk_bf16_f32 v36, v36, v37
    v_cvt_pk_bf16_f32 v37, v38, v39
    v_mfma_f32_16x16x32_bf16 a[84:87], v[148:151], a[148:151], a[84:87]
    ds_read_b64_tr_b16 v[134:135], v161 offset:4096
    ds_write_b64 v88, v[36:37] offset:2208
    v_cvt_pk_bf16_f32 v40, v40, v41
    v_cvt_pk_bf16_f32 v41, v42, v43
    ds_write_b64 v88, v[40:41] offset:2240
    v_mfma_f32_16x16x32_bf16 a[80:83], v[148:151], a[144:147], a[80:83]
    ds_read_b64_tr_b16 v[136:137], v162 offset:0
    buffer_load_dwordx4 v189, s[8:11], s76 offen offset:1024 lds
    v_cvt_pk_bf16_f32 v44, v44, v45
    v_cvt_pk_bf16_f32 v45, v46, v47
    ds_write_b64 v88, v[44:45] offset:2272
    v_mfma_f32_16x16x32_bf16 a[96:99], v[152:155], a[144:147], a[96:99]
    ds_read_b64_tr_b16 v[138:139], v162 offset:4096
    v_cvt_pk_bf16_f32 v16, v16, v17
    v_cvt_pk_bf16_f32 v17, v18, v19
    ds_write_b64 v88, v[16:17] offset:4352
    v_cvt_pk_bf16_f32 v20, v20, v21
    v_mfma_f32_16x16x32_bf16 a[100:103], v[152:155], a[148:151], a[100:103]
    ds_read_b64_tr_b16 v[140:141], v163 offset:0
    buffer_load_dwordx4 v190, s[8:11], s76 offen offset:2048 lds
    v_cvt_pk_bf16_f32 v21, v22, v23
    ds_write_b64 v88, v[20:21] offset:4384
    v_cvt_pk_bf16_f32 v24, v24, v25
    v_mfma_f32_16x16x32_bf16 a[104:107], v[152:155], a[152:155], a[104:107]
    ds_read_b64_tr_b16 v[142:143], v163 offset:4096
    v_cvt_pk_bf16_f32 v25, v26, v27
    ds_write_b64 v88, v[24:25] offset:4416
    v_cvt_pk_bf16_f32 v28, v28, v29
    v_cvt_pk_bf16_f32 v29, v30, v31
    v_mfma_f32_16x16x32_bf16 a[108:111], v[152:155], a[156:159], a[108:111]
    ds_read_b64_tr_b16 v[144:145], v164 offset:0
    buffer_load_dwordx4 v192, s[8:11], s76 offen offset:3072 lds
    ds_write_b64 v88, v[28:29] offset:4448
    v_cvt_pk_bf16_f32 v48, v48, v49
    v_cvt_pk_bf16_f32 v49, v50, v51
    v_mfma_f32_16x16x32_bf16 a[124:127], v[156:159], a[156:159], a[124:127]
    ds_read_b64_tr_b16 v[146:147], v164 offset:4096
    ds_write_b64 v88, v[48:49] offset:6528
    v_cvt_pk_bf16_f32 v52, v52, v53
    v_cvt_pk_bf16_f32 v53, v54, v55
    ds_write_b64 v88, v[52:53] offset:6560
    v_mfma_f32_16x16x32_bf16 a[120:123], v[156:159], a[152:155], a[120:123]
    v_cvt_pk_bf16_f32 v56, v56, v57
    v_cvt_pk_bf16_f32 v57, v58, v59
    ds_write_b64 v88, v[56:57] offset:6592
    v_cvt_pk_bf16_f32 v60, v60, v61
    v_cvt_pk_bf16_f32 v61, v62, v63
    v_mfma_f32_16x16x32_bf16 a[116:119], v[156:159], a[148:151], a[116:119]
    ds_write_b64 v88, v[60:61] offset:6624
    s_waitcnt lgkmcnt(13)
    ds_read_b64_tr_b16 v[96:97], v89 offset:0
    ds_read_b64_tr_b16 v[98:99], v89 offset:544
    ds_read_b64_tr_b16 v[100:101], v89 offset:32
    v_mfma_f32_16x16x32_bf16 a[112:115], v[156:159], a[144:147], a[112:115]
    ds_read_b64_tr_b16 v[148:149], v165 offset:0
    ds_read_b64_tr_b16 v[102:103], v89 offset:576
    ds_read_b64_tr_b16 v[104:105], v89 offset:64
    ds_read_b64_tr_b16 v[106:107], v89 offset:608
    ds_read_b64_tr_b16 v[108:109], v89 offset:96
    v_mfma_f32_16x16x32_bf16 a[0:3], v[128:131], a[160:163], a[0:3]
    s_add_u32 s77, s33, 0x16000
    buffer_load_dwordx4 a[128:131], v179, s[16:19], s77 offen offset:0 sc1
    ds_read_b64_tr_b16 v[110:111], v89 offset:640
    s_waitcnt lgkmcnt(9)
    ds_read_b64_tr_b16 v[112:113], v89 offset:4352
    v_mfma_f32_16x16x32_bf16 a[4:7], v[128:131], a[164:167], a[4:7]
    ds_read_b64_tr_b16 v[150:151], v165 offset:4096
    ds_read_b64_tr_b16 v[114:115], v89 offset:4896
    ds_read_b64_tr_b16 v[116:117], v89 offset:4384
    ds_read_b64_tr_b16 v[118:119], v89 offset:4928
    ds_read_b64_tr_b16 v[120:121], v89 offset:4416
    v_mfma_f32_16x16x32_bf16 a[8:11], v[128:131], a[168:171], a[8:11]
    ds_read_b64_tr_b16 v[122:123], v89 offset:4960
    ds_read_b64_tr_b16 v[124:125], v89 offset:4448
    ds_read_b64_tr_b16 v[126:127], v89 offset:4992
    s_add_u32 s70, s71, 8192
    v_mfma_f32_16x16x32_bf16 a[12:15], v[128:131], a[172:175], a[12:15]
    ds_read_b64_tr_b16 v[152:153], v166 offset:0
    v_mfma_f32_16x16x32_bf16 a[28:31], v[132:135], a[172:175], a[28:31]
    buffer_load_dwordx4 a[132:135], v179, s[16:19], s77 offen offset:1024 sc1
    v_mfma_f32_16x16x32_bf16 a[24:27], v[132:135], a[168:171], a[24:27]
    ds_read_b64_tr_b16 v[154:155], v166 offset:4096
    v_mfma_f32_16x16x32_bf16 a[20:23], v[132:135], a[164:167], a[20:23]
    v_mfma_f32_16x16x32_bf16 a[16:19], v[132:135], a[160:163], a[16:19]
    ds_read_b64_tr_b16 v[156:157], v167 offset:0
    v_mfma_f32_16x16x32_bf16 a[32:35], v[136:139], a[160:163], a[32:35]
    buffer_load_dwordx4 a[136:139], v179, s[16:19], s77 offen offset:2048 sc1
    v_mfma_f32_16x16x32_bf16 a[36:39], v[136:139], a[164:167], a[36:39]
    ds_read_b64_tr_b16 v[158:159], v167 offset:4096
    v_mfma_f32_16x16x32_bf16 a[40:43], v[136:139], a[168:171], a[40:43]
    v_mfma_f32_16x16x32_bf16 a[44:47], v[136:139], a[172:175], a[44:47]
    ds_read_b64_tr_b16 v[128:129], v160 offset:8192
    v_mfma_f32_16x16x32_bf16 a[60:63], v[140:143], a[172:175], a[60:63]
    buffer_load_dwordx4 a[140:143], v179, s[16:19], s77 offen offset:3072 sc1
    v_mfma_f32_16x16x32_bf16 a[56:59], v[140:143], a[168:171], a[56:59]
    ds_read_b64_tr_b16 v[130:131], v160 offset:12288
    v_mfma_f32_16x16x32_bf16 a[52:55], v[140:143], a[164:167], a[52:55]
    v_mfma_f32_16x16x32_bf16 a[48:51], v[140:143], a[160:163], a[48:51]
    ds_read_b64_tr_b16 v[132:133], v161 offset:8192
    v_mfma_f32_16x16x32_bf16 a[64:67], v[144:147], a[160:163], a[64:67]
    s_add_u32 s77, s33, 0x1a000
    buffer_load_dwordx4 a[144:147], v179, s[16:19], s77 offen offset:0 sc1
    v_mfma_f32_16x16x32_bf16 a[68:71], v[144:147], a[164:167], a[68:71]
    ds_read_b64_tr_b16 v[134:135], v161 offset:12288
    buffer_load_dword v174, v254, s[16:19], s78 offen offset:256 sc1
    v_mfma_f32_16x16x32_bf16 a[72:75], v[144:147], a[168:171], a[72:75]
    v_mfma_f32_16x16x32_bf16 a[76:79], v[144:147], a[172:175], a[76:79]
    ds_read_b64_tr_b16 v[136:137], v162 offset:8192
    s_waitcnt lgkmcnt(15)
    v_mfma_f32_16x16x32_bf16 a[92:95], v[148:151], a[172:175], a[92:95]
    buffer_load_dwordx4 a[148:151], v179, s[16:19], s77 offen offset:1024 sc1
    v_mfma_f32_16x16x32_bf16 a[88:91], v[148:151], a[168:171], a[88:91]
    ds_read_b64_tr_b16 v[138:139], v162 offset:12288
    v_mfma_f32_16x16x32_bf16 a[84:87], v[148:151], a[164:167], a[84:87]
    v_mfma_f32_16x16x32_bf16 a[80:83], v[148:151], a[160:163], a[80:83]
    ds_read_b64_tr_b16 v[140:141], v163 offset:8192
    s_waitcnt lgkmcnt(9)
    v_mfma_f32_16x16x32_bf16 a[96:99], v[152:155], a[160:163], a[96:99]
    buffer_load_dwordx4 a[152:155], v179, s[16:19], s77 offen offset:2048 sc1
    v_mfma_f32_16x16x32_bf16 a[100:103], v[152:155], a[164:167], a[100:103]
    ds_read_b64_tr_b16 v[142:143], v163 offset:12288
    v_mfma_f32_16x16x32_bf16 a[104:107], v[152:155], a[168:171], a[104:107]
    v_mfma_f32_16x16x32_bf16 a[108:111], v[152:155], a[172:175], a[108:111]
    ds_read_b64_tr_b16 v[144:145], v164 offset:8192
    s_waitcnt lgkmcnt(9)
    v_mfma_f32_16x16x32_bf16 a[124:127], v[156:159], a[172:175], a[124:127]
    buffer_load_dwordx4 a[156:159], v179, s[16:19], s77 offen offset:3072 sc1
    v_mfma_f32_16x16x32_bf16 a[120:123], v[156:159], a[168:171], a[120:123]
    ds_read_b64_tr_b16 v[146:147], v164 offset:12288
    v_mfma_f32_16x16x32_bf16 a[116:119], v[156:159], a[164:167], a[116:119]
    v_mfma_f32_16x16x32_bf16 a[112:115], v[156:159], a[160:163], a[112:115]
    ds_read_b64_tr_b16 v[148:149], v165 offset:8192
    s_waitcnt lgkmcnt(9)
    v_mfma_f32_16x16x32_bf16 a[0:3], v[128:131], a[176:179], a[0:3]
    v_mfma_f32_16x16x32_bf16 a[4:7], v[128:131], a[180:183], a[4:7]
    ds_read_b64_tr_b16 v[150:151], v165 offset:12288
    v_mfma_f32_16x16x32_bf16 a[8:11], v[128:131], a[184:187], a[8:11]
    v_mfma_f32_16x16x32_bf16 a[12:15], v[128:131], a[188:191], a[12:15]
    ds_read_b64_tr_b16 v[152:153], v166 offset:8192
    s_waitcnt lgkmcnt(9)
    v_mfma_f32_16x16x32_bf16 a[28:31], v[132:135], a[188:191], a[28:31]
    v_mfma_f32_16x16x32_bf16 a[24:27], v[132:135], a[184:187], a[24:27]
    ds_read_b64_tr_b16 v[154:155], v166 offset:12288
    v_mfma_f32_16x16x32_bf16 a[20:23], v[132:135], a[180:183], a[20:23]
    v_mfma_f32_16x16x32_bf16 a[16:19], v[132:135], a[176:179], a[16:19]
    ds_read_b64_tr_b16 v[156:157], v167 offset:8192
    s_waitcnt lgkmcnt(9)
    v_mfma_f32_16x16x32_bf16 a[32:35], v[136:139], a[176:179], a[32:35]
    v_mfma_f32_16x16x32_bf16 a[36:39], v[136:139], a[180:183], a[36:39]
    ds_read_b64_tr_b16 v[158:159], v167 offset:12288
    v_mfma_f32_16x16x32_bf16 a[40:43], v[136:139], a[184:187], a[40:43]
    v_mfma_f32_16x16x32_bf16 a[44:47], v[136:139], a[188:191], a[44:47]
    s_waitcnt lgkmcnt(8)
    v_mfma_f32_16x16x32_bf16 a[60:63], v[140:143], a[188:191], a[60:63]
    v_mfma_f32_16x16x32_bf16 a[56:59], v[140:143], a[184:187], a[56:59]
    v_mfma_f32_16x16x32_bf16 a[52:55], v[140:143], a[180:183], a[52:55]
    v_mfma_f32_16x16x32_bf16 a[48:51], v[140:143], a[176:179], a[48:51]
    s_waitcnt lgkmcnt(6)
    v_mfma_f32_16x16x32_bf16 a[64:67], v[144:147], a[176:179], a[64:67]
    v_mfma_f32_16x16x32_bf16 a[68:71], v[144:147], a[180:183], a[68:71]
    v_mfma_f32_16x16x32_bf16 a[72:75], v[144:147], a[184:187], a[72:75]
    v_mfma_f32_16x16x32_bf16 a[76:79], v[144:147], a[188:191], a[76:79]
    s_waitcnt vmcnt(25) lgkmcnt(0)
    s_barrier
    ds_read_b64_tr_b16 v[128:129], v160 offset:16384
    v_mfma_f32_16x16x32_bf16 a[92:95], v[148:151], a[188:191], a[92:95]
    ds_read_b64_tr_b16 v[130:131], v160 offset:20480
    s_add_u32 m0, s3, 0x0
    s_add_u32 s76, s34, 0x20000
    v_mfma_f32_16x16x32_bf16 a[88:91], v[148:151], a[184:187], a[88:91]
    ds_read_b64_tr_b16 v[132:133], v161 offset:16384
    buffer_load_dwordx4 v188, s[8:11], s76 offen offset:0 lds
    s_lshl_b32 s80, s31, 8
    s_lshl_b32 s81, s28, 6
    s_add_u32 s80, s80, s81
    v_mfma_f32_16x16x32_bf16 a[84:87], v[148:151], a[180:183], a[84:87]
    ds_read_b64_tr_b16 v[134:135], v161 offset:20480
    v_lshrrev_b32 v228, 2, v226
    v_lshlrev_b32 v228, 4, v228
    v_bfe_u32 v229, v226, 1, 1
    v_add3_u32 v228, v228, v229, s80
    v_mfma_f32_16x16x32_bf16 a[80:83], v[148:151], a[176:179], a[80:83]
    ds_read_b64_tr_b16 v[136:137], v162 offset:16384
    buffer_load_dwordx4 v189, s[8:11], s76 offen offset:1024 lds
    v_and_b32 v229, 1, v226
    v_lshl_add_u32 v228, v229, 3, v228
    s_lshl_b32 s80, s32, 7
    v_mfma_f32_16x16x32_bf16 a[96:99], v[152:155], a[176:179], a[96:99]
    ds_read_b64_tr_b16 v[138:139], v162 offset:20480
    s_lshl_b32 s81, s100, 5
    s_add_u32 s80, s80, s81
    v_lshl_add_u32 v229, v227, 2, s80
    v_add_u32 v231, s80, v226
    v_mfma_f32_16x16x32_bf16 a[100:103], v[152:155], a[180:183], a[100:103]
    ds_read_b64_tr_b16 v[140:141], v163 offset:16384
    buffer_load_dwordx4 v190, s[8:11], s76 offen offset:2048 lds
    v_lshlrev_b32 v231, 1, v231
    s_lshl_b32 s81, s80, 1
    v_and_b32 v230, 1, v228
    v_mfma_f32_16x16x32_bf16 a[104:107], v[152:155], a[184:187], a[104:107]
    ds_read_b64_tr_b16 v[142:143], v163 offset:20480
    buffer_store_dwordx4 v[96:99], v179, s[16:19], s71 offen offset:0 sc1
    v_mul_u32_u24 v230, 3, v230
    v_add_lshl_u32 v230, v230, v228, 2
    s_mov_b32 s80, 0x1800000
    v_mfma_f32_16x16x32_bf16 a[108:111], v[152:155], a[188:191], a[108:111]
    ds_read_b64_tr_b16 v[144:145], v164 offset:16384
    buffer_load_dwordx4 v192, s[8:11], s76 offen offset:3072 lds
    buffer_load_dwordx4 v[250:253], v230, s[16:19], s80 offen sc1
    v_mfma_f32_16x16x32_bf16 a[124:127], v[156:159], a[188:191], a[124:127]
    ds_read_b64_tr_b16 v[146:147], v164 offset:20480
    buffer_load_ushort v194, v231, s[72:75], 0 offen offset:0
    v_mfma_f32_16x16x32_bf16 a[120:123], v[156:159], a[184:187], a[120:123]
    buffer_load_ushort v195, v231, s[72:75], 0 offen offset:32
    v_mfma_f32_16x16x32_bf16 a[116:119], v[156:159], a[180:183], a[116:119]
    v_mfma_f32_16x16x32_bf16 a[112:115], v[156:159], a[176:179], a[112:115]
    ds_read_b64_tr_b16 v[148:149], v165 offset:16384
    s_waitcnt lgkmcnt(9)
    v_mfma_f32_16x16x32_bf16 a[0:3], v[128:131], a[192:195], a[0:3]
    s_waitcnt vmcnt(11)
    v_cmp_eq_u32 vcc, 1, v174
    s_cmp_eq_u64 vcc, -1
    s_cbranch_scc0 chk_5_slow
chk_5_ok:
    s_add_u32 s77, s33, 0x2000
    buffer_load_dwordx4 a[160:163], v179, s[16:19], s77 offen offset:0 sc1
    v_mfma_f32_16x16x32_bf16 a[4:7], v[128:131], a[196:199], a[4:7]
    ds_read_b64_tr_b16 v[150:151], v165 offset:20480
    buffer_store_dwordx4 v[100:103], v179, s[16:19], s71 offen offset:1024 sc1
    v_mfma_f32_16x16x32_bf16 a[8:11], v[128:131], a[200:203], a[8:11]
    v_mfma_f32_16x16x32_bf16 a[12:15], v[128:131], a[204:207], a[12:15]
    ds_read_b64_tr_b16 v[152:153], v166 offset:16384
    s_waitcnt lgkmcnt(9)
    v_mfma_f32_16x16x32_bf16 a[28:31], v[132:135], a[204:207], a[28:31]
    buffer_load_dwordx4 a[164:167], v179, s[16:19], s77 offen offset:1024 sc1
    v_mfma_f32_16x16x32_bf16 a[24:27], v[132:135], a[200:203], a[24:27]
    ds_read_b64_tr_b16 v[154:155], v166 offset:20480
    v_mfma_f32_16x16x32_bf16 a[20:23], v[132:135], a[196:199], a[20:23]
    v_mfma_f32_16x16x32_bf16 a[16:19], v[132:135], a[192:195], a[16:19]
    ds_read_b64_tr_b16 v[156:157], v167 offset:16384
    s_waitcnt lgkmcnt(9)
    v_mfma_f32_16x16x32_bf16 a[32:35], v[136:139], a[192:195], a[32:35]
    buffer_load_dwordx4 a[168:171], v179, s[16:19], s77 offen offset:2048 sc1
    buffer_store_dwordx4 v[104:107], v179, s[16:19], s71 offen offset:2048 sc1
    v_mfma_f32_16x16x32_bf16 a[36:39], v[136:139], a[196:199], a[36:39]
    ds_read_b64_tr_b16 v[158:159], v167 offset:20480
    v_mfma_f32_16x16x32_bf16 a[40:43], v[136:139], a[200:203], a[40:43]
    v_mfma_f32_16x16x32_bf16 a[44:47], v[136:139], a[204:207], a[44:47]
    ds_read_b64_tr_b16 v[128:129], v160 offset:24576
    s_waitcnt lgkmcnt(9)
    v_mfma_f32_16x16x32_bf16 a[60:63], v[140:143], a[204:207], a[60:63]
    buffer_load_dwordx4 a[172:175], v179, s[16:19], s77 offen offset:3072 sc1
    v_mfma_f32_16x16x32_bf16 a[56:59], v[140:143], a[200:203], a[56:59]
    ds_read_b64_tr_b16 v[130:131], v160 offset:28672
    v_mfma_f32_16x16x32_bf16 a[52:55], v[140:143], a[196:199], a[52:55]
    v_mfma_f32_16x16x32_bf16 a[48:51], v[140:143], a[192:195], a[48:51]
    ds_read_b64_tr_b16 v[132:133], v161 offset:24576
    buffer_store_dwordx4 v[108:111], v179, s[16:19], s71 offen offset:3072 sc1
    s_waitcnt lgkmcnt(9)
    v_mfma_f32_16x16x32_bf16 a[64:67], v[144:147], a[192:195], a[64:67]
    s_add_u32 s77, s33, 0x6000
    buffer_load_dwordx4 a[176:179], v179, s[16:19], s77 offen offset:0 sc1
    v_mfma_f32_16x16x32_bf16 a[68:71], v[144:147], a[196:199], a[68:71]
    ds_read_b64_tr_b16 v[134:135], v161 offset:28672
    v_mfma_f32_16x16x32_bf16 a[72:75], v[144:147], a[200:203], a[72:75]
    v_mfma_f32_16x16x32_bf16 a[76:79], v[144:147], a[204:207], a[76:79]
    ds_read_b64_tr_b16 v[136:137], v162 offset:24576
    s_waitcnt lgkmcnt(9)
    v_mfma_f32_16x16x32_bf16 a[92:95], v[148:151], a[204:207], a[92:95]
    buffer_load_dwordx4 a[180:183], v179, s[16:19], s77 offen offset:1024 sc1
    v_mfma_f32_16x16x32_bf16 a[88:91], v[148:151], a[200:203], a[88:91]
    ds_read_b64_tr_b16 v[138:139], v162 offset:28672
    v_mfma_f32_16x16x32_bf16 a[84:87], v[148:151], a[196:199], a[84:87]
    buffer_store_dwordx4 v[112:115], v179, s[16:19], s70 offen offset:0 sc1
    v_mfma_f32_16x16x32_bf16 a[80:83], v[148:151], a[192:195], a[80:83]
    ds_read_b64_tr_b16 v[140:141], v163 offset:24576
    s_waitcnt lgkmcnt(9)
    v_mfma_f32_16x16x32_bf16 a[96:99], v[152:155], a[192:195], a[96:99]
    buffer_load_dwordx4 a[184:187], v179, s[16:19], s77 offen offset:2048 sc1
    v_mfma_f32_16x16x32_bf16 a[100:103], v[152:155], a[196:199], a[100:103]
    ds_read_b64_tr_b16 v[142:143], v163 offset:28672
    v_mfma_f32_16x16x32_bf16 a[104:107], v[152:155], a[200:203], a[104:107]
    v_mfma_f32_16x16x32_bf16 a[108:111], v[152:155], a[204:207], a[108:111]
    ds_read_b64_tr_b16 v[144:145], v164 offset:24576
    s_waitcnt lgkmcnt(9)
    v_mfma_f32_16x16x32_bf16 a[124:127], v[156:159], a[204:207], a[124:127]
    buffer_load_dwordx4 a[188:191], v179, s[16:19], s77 offen offset:3072 sc1
    v_mfma_f32_16x16x32_bf16 a[120:123], v[156:159], a[200:203], a[120:123]
    ds_read_b64_tr_b16 v[146:147], v164 offset:28672
    buffer_store_dwordx4 v[116:119], v179, s[16:19], s70 offen offset:1024 sc1
    v_mfma_f32_16x16x32_bf16 a[116:119], v[156:159], a[196:199], a[116:119]
    v_mfma_f32_16x16x32_bf16 a[112:115], v[156:159], a[192:195], a[112:115]
    ds_read_b64_tr_b16 v[148:149], v165 offset:24576
    s_waitcnt lgkmcnt(9)
    v_mfma_f32_16x16x32_bf16 a[0:3], v[128:131], a[208:211], a[0:3]
    v_mfma_f32_16x16x32_bf16 a[4:7], v[128:131], a[212:215], a[4:7]
    ds_read_b64_tr_b16 v[150:151], v165 offset:28672
    v_mfma_f32_16x16x32_bf16 a[8:11], v[128:131], a[216:219], a[8:11]
    v_mfma_f32_16x16x32_bf16 a[12:15], v[128:131], a[220:223], a[12:15]
    ds_read_b64_tr_b16 v[152:153], v166 offset:24576
    s_waitcnt lgkmcnt(9)
    v_mfma_f32_16x16x32_bf16 a[28:31], v[132:135], a[220:223], a[28:31]
    buffer_store_dwordx4 v[120:123], v179, s[16:19], s70 offen offset:2048 sc1
    v_mfma_f32_16x16x32_bf16 a[24:27], v[132:135], a[216:219], a[24:27]
    ds_read_b64_tr_b16 v[154:155], v166 offset:28672
    v_mfma_f32_16x16x32_bf16 a[20:23], v[132:135], a[212:215], a[20:23]
    v_mfma_f32_16x16x32_bf16 a[16:19], v[132:135], a[208:211], a[16:19]
    ds_read_b64_tr_b16 v[156:157], v167 offset:24576
    s_waitcnt lgkmcnt(9)
    v_mfma_f32_16x16x32_bf16 a[32:35], v[136:139], a[208:211], a[32:35]
    v_mfma_f32_16x16x32_bf16 a[36:39], v[136:139], a[212:215], a[36:39]
    ds_read_b64_tr_b16 v[158:159], v167 offset:28672
    v_mfma_f32_16x16x32_bf16 a[40:43], v[136:139], a[216:219], a[40:43]
    v_mfma_f32_16x16x32_bf16 a[44:47], v[136:139], a[220:223], a[44:47]
    buffer_store_dwordx4 v[124:127], v179, s[16:19], s70 offen offset:3072 sc1
    s_waitcnt lgkmcnt(8)
    v_mfma_f32_16x16x32_bf16 a[60:63], v[140:143], a[220:223], a[60:63]
    v_mfma_f32_16x16x32_bf16 a[56:59], v[140:143], a[216:219], a[56:59]
    v_mfma_f32_16x16x32_bf16 a[52:55], v[140:143], a[212:215], a[52:55]
    v_mfma_f32_16x16x32_bf16 a[48:51], v[140:143], a[208:211], a[48:51]
    s_waitcnt lgkmcnt(6)
    v_mfma_f32_16x16x32_bf16 a[64:67], v[144:147], a[208:211], a[64:67]
    v_mfma_f32_16x16x32_bf16 a[68:71], v[144:147], a[212:215], a[68:71]
    v_mfma_f32_16x16x32_bf16 a[72:75], v[144:147], a[216:219], a[72:75]
    v_mfma_f32_16x16x32_bf16 a[76:79], v[144:147], a[220:223], a[76:79]
    s_waitcnt vmcnt(36) lgkmcnt(0)
    s_barrier
    ds_read_b64_tr_b16 v[128:129], v160 offset:32768
    v_mfma_f32_16x16x32_bf16 a[92:95], v[148:151], a[220:223], a[92:95]
    ds_read_b64_tr_b16 v[130:131], v160 offset:36864
    s_add_u32 m0, s3, 0x4000
    s_add_u32 s76, s34, 0x90000
    v_mfma_f32_16x16x32_bf16 a[88:91], v[148:151], a[216:219], a[88:91]
    ds_read_b64_tr_b16 v[132:133], v161 offset:32768
    buffer_load_dwordx4 v188, s[8:11], s76 offen offset:0 lds
    v_lshlrev_b32 v228, 11, v228
    v_lshl_add_u32 v230, v227, 4, v228
    v_lshl_add_u32 v228, v229, 1, v228
    v_mfma_f32_16x16x32_bf16 a[84:87], v[148:151], a[212:215], a[84:87]
    ds_read_b64_tr_b16 v[134:135], v161 offset:36864
    buffer_load_dwordx4 v[204:207], v230, s[4:7], s81 offen
    v_mfma_f32_16x16x32_bf16 a[80:83], v[148:151], a[208:211], a[80:83]
    ds_read_b64_tr_b16 v[136:137], v162 offset:32768
    buffer_load_dwordx4 v189, s[8:11], s76 offen offset:1024 lds
    v_add_u32 v230, 0x1000, v230
    v_lshlrev_b32 v180, 1, v228
    v_add_u32 v228, 0x1000, v228
    v_mfma_f32_16x16x32_bf16 a[96:99], v[152:155], a[208:211], a[96:99]
    ds_read_b64_tr_b16 v[138:139], v162 offset:36864
    buffer_load_dwordx4 v[208:211], v230, s[4:7], s81 offen
    v_mfma_f32_16x16x32_bf16 a[100:103], v[152:155], a[212:215], a[100:103]
    ds_read_b64_tr_b16 v[140:141], v163 offset:32768
    buffer_load_dwordx4 v190, s[8:11], s76 offen offset:2048 lds
    v_mfma_f32_16x16x32_bf16 a[104:107], v[152:155], a[216:219], a[104:107]
    ds_read_b64_tr_b16 v[142:143], v163 offset:36864
    v_mfma_f32_16x16x32_bf16 a[108:111], v[152:155], a[220:223], a[108:111]
    ds_read_b64_tr_b16 v[144:145], v164 offset:32768
    buffer_load_dwordx4 v192, s[8:11], s76 offen offset:3072 lds
    v_mfma_f32_16x16x32_bf16 a[124:127], v[156:159], a[220:223], a[124:127]
    ds_read_b64_tr_b16 v[146:147], v164 offset:36864
    v_mfma_f32_16x16x32_bf16 a[120:123], v[156:159], a[216:219], a[120:123]
    v_mfma_f32_16x16x32_bf16 a[116:119], v[156:159], a[212:215], a[116:119]
    v_mfma_f32_16x16x32_bf16 a[112:115], v[156:159], a[208:211], a[112:115]
    ds_read_b64_tr_b16 v[148:149], v165 offset:32768
    s_waitcnt lgkmcnt(9)
    v_mfma_f32_16x16x32_bf16 a[0:3], v[128:131], a[224:227], a[0:3]
    s_add_u32 s77, s33, 0x9000
    buffer_load_dwordx4 a[192:195], v179, s[16:19], s77 offen offset:0 sc1
    v_mfma_f32_16x16x32_bf16 a[4:7], v[128:131], a[228:231], a[4:7]
    ds_read_b64_tr_b16 v[150:151], v165 offset:36864
    v_mfma_f32_16x16x32_bf16 a[8:11], v[128:131], a[232:235], a[8:11]
    v_mfma_f32_16x16x32_bf16 a[12:15], v[128:131], a[236:239], a[12:15]
    ds_read_b64_tr_b16 v[152:153], v166 offset:32768
    s_waitcnt lgkmcnt(9)
    v_mfma_f32_16x16x32_bf16 a[28:31], v[132:135], a[236:239], a[28:31]
    buffer_load_dwordx4 a[196:199], v179, s[16:19], s77 offen offset:1024 sc1
    v_mfma_f32_16x16x32_bf16 a[24:27], v[132:135], a[232:235], a[24:27]
    ds_read_b64_tr_b16 v[154:155], v166 offset:36864
    v_mfma_f32_16x16x32_bf16 a[20:23], v[132:135], a[228:231], a[20:23]
    v_mfma_f32_16x16x32_bf16 a[16:19], v[132:135], a[224:227], a[16:19]
    ds_read_b64_tr_b16 v[156:157], v167 offset:32768
    s_waitcnt lgkmcnt(9)
    v_mfma_f32_16x16x32_bf16 a[32:35], v[136:139], a[224:227], a[32:35]
    buffer_load_dwordx4 a[200:203], v179, s[16:19], s77 offen offset:2048 sc1
    v_mfma_f32_16x16x32_bf16 a[36:39], v[136:139], a[228:231], a[36:39]
    ds_read_b64_tr_b16 v[158:159], v167 offset:36864
    v_mfma_f32_16x16x32_bf16 a[40:43], v[136:139], a[232:235], a[40:43]
    v_mfma_f32_16x16x32_bf16 a[44:47], v[136:139], a[236:239], a[44:47]
    ds_read_b64_tr_b16 v[128:129], v160 offset:40960
    s_waitcnt lgkmcnt(9)
    v_mfma_f32_16x16x32_bf16 a[60:63], v[140:143], a[236:239], a[60:63]
    buffer_load_dwordx4 a[204:207], v179, s[16:19], s77 offen offset:3072 sc1
    v_mfma_f32_16x16x32_bf16 a[56:59], v[140:143], a[232:235], a[56:59]
    ds_read_b64_tr_b16 v[130:131], v160 offset:45056
    v_mfma_f32_16x16x32_bf16 a[52:55], v[140:143], a[228:231], a[52:55]
    v_mfma_f32_16x16x32_bf16 a[48:51], v[140:143], a[224:227], a[48:51]
    ds_read_b64_tr_b16 v[132:133], v161 offset:40960
    s_waitcnt lgkmcnt(9)
    v_mfma_f32_16x16x32_bf16 a[64:67], v[144:147], a[224:227], a[64:67]
    s_add_u32 s77, s33, 0xd000
    buffer_load_dwordx4 a[208:211], v179, s[16:19], s77 offen offset:0 sc1
    v_mfma_f32_16x16x32_bf16 a[68:71], v[144:147], a[228:231], a[68:71]
    ds_read_b64_tr_b16 v[134:135], v161 offset:45056
    v_mfma_f32_16x16x32_bf16 a[72:75], v[144:147], a[232:235], a[72:75]
    v_mfma_f32_16x16x32_bf16 a[76:79], v[144:147], a[236:239], a[76:79]
    ds_read_b64_tr_b16 v[136:137], v162 offset:40960
    s_waitcnt lgkmcnt(9)
    v_mfma_f32_16x16x32_bf16 a[92:95], v[148:151], a[236:239], a[92:95]
    buffer_load_dwordx4 a[212:215], v179, s[16:19], s77 offen offset:1024 sc1
    v_mfma_f32_16x16x32_bf16 a[88:91], v[148:151], a[232:235], a[88:91]
    ds_read_b64_tr_b16 v[138:139], v162 offset:45056
    v_mfma_f32_16x16x32_bf16 a[84:87], v[148:151], a[228:231], a[84:87]
    v_mfma_f32_16x16x32_bf16 a[80:83], v[148:151], a[224:227], a[80:83]
    ds_read_b64_tr_b16 v[140:141], v163 offset:40960
    s_waitcnt lgkmcnt(9)
    v_mfma_f32_16x16x32_bf16 a[96:99], v[152:155], a[224:227], a[96:99]
    buffer_load_dwordx4 a[216:219], v179, s[16:19], s77 offen offset:2048 sc1
    v_mfma_f32_16x16x32_bf16 a[100:103], v[152:155], a[228:231], a[100:103]
    ds_read_b64_tr_b16 v[142:143], v163 offset:45056
    v_mfma_f32_16x16x32_bf16 a[104:107], v[152:155], a[232:235], a[104:107]
    v_mfma_f32_16x16x32_bf16 a[108:111], v[152:155], a[236:239], a[108:111]
    ds_read_b64_tr_b16 v[144:145], v164 offset:40960
    s_waitcnt lgkmcnt(9)
    v_mfma_f32_16x16x32_bf16 a[124:127], v[156:159], a[236:239], a[124:127]
    buffer_load_dwordx4 a[220:223], v179, s[16:19], s77 offen offset:3072 sc1
    v_mfma_f32_16x16x32_bf16 a[120:123], v[156:159], a[232:235], a[120:123]
    ds_read_b64_tr_b16 v[146:147], v164 offset:45056
    v_mfma_f32_16x16x32_bf16 a[116:119], v[156:159], a[228:231], a[116:119]
    v_mfma_f32_16x16x32_bf16 a[112:115], v[156:159], a[224:227], a[112:115]
    ds_read_b64_tr_b16 v[148:149], v165 offset:40960
    s_waitcnt lgkmcnt(9)
    v_mfma_f32_16x16x32_bf16 a[0:3], v[128:131], a[240:243], a[0:3]
    v_mfma_f32_16x16x32_bf16 a[4:7], v[128:131], a[244:247], a[4:7]
    ds_read_b64_tr_b16 v[150:151], v165 offset:45056
    v_mfma_f32_16x16x32_bf16 a[8:11], v[128:131], a[248:251], a[8:11]
    v_mfma_f32_16x16x32_bf16 a[12:15], v[128:131], a[252:255], a[12:15]
    ds_read_b64_tr_b16 v[152:153], v166 offset:40960
    s_waitcnt lgkmcnt(9)
    v_mfma_f32_16x16x32_bf16 a[28:31], v[132:135], a[252:255], a[28:31]
    v_mfma_f32_16x16x32_bf16 a[24:27], v[132:135], a[248:251], a[24:27]
    ds_read_b64_tr_b16 v[154:155], v166 offset:45056
    v_mfma_f32_16x16x32_bf16 a[20:23], v[132:135], a[244:247], a[20:23]
    v_mfma_f32_16x16x32_bf16 a[16:19], v[132:135], a[240:243], a[16:19]
    ds_read_b64_tr_b16 v[156:157], v167 offset:40960
    s_waitcnt lgkmcnt(9)
    v_mfma_f32_16x16x32_bf16 a[32:35], v[136:139], a[240:243], a[32:35]
    v_mfma_f32_16x16x32_bf16 a[36:39], v[136:139], a[244:247], a[36:39]
    ds_read_b64_tr_b16 v[158:159], v167 offset:45056
    v_mfma_f32_16x16x32_bf16 a[40:43], v[136:139], a[248:251], a[40:43]
    v_mfma_f32_16x16x32_bf16 a[44:47], v[136:139], a[252:255], a[44:47]
    s_waitcnt lgkmcnt(8)
    v_mfma_f32_16x16x32_bf16 a[60:63], v[140:143], a[252:255], a[60:63]
    v_mfma_f32_16x16x32_bf16 a[56:59], v[140:143], a[248:251], a[56:59]
    v_mfma_f32_16x16x32_bf16 a[52:55], v[140:143], a[244:247], a[52:55]
    v_mfma_f32_16x16x32_bf16 a[48:51], v[140:143], a[240:243], a[48:51]
    s_waitcnt lgkmcnt(6)
    v_mfma_f32_16x16x32_bf16 a[64:67], v[144:147], a[240:243], a[64:67]
    v_mfma_f32_16x16x32_bf16 a[68:71], v[144:147], a[244:247], a[68:71]
    v_mfma_f32_16x16x32_bf16 a[72:75], v[144:147], a[248:251], a[72:75]
    v_mfma_f32_16x16x32_bf16 a[76:79], v[144:147], a[252:255], a[76:79]
    s_waitcnt vmcnt(37) lgkmcnt(0)
    s_barrier
    ds_read_b64_tr_b16 v[128:129], v160 offset:49152
    s_waitcnt vmcnt(14)
    s_mov_b64 exec, 0x10
    buffer_store_dword v203, v248, s[16:19], 0 offen sc1
    s_mov_b64 exec, -1
    v_mfma_f32_16x16x32_bf16 a[92:95], v[148:151], a[252:255], a[92:95]
    ds_read_b64_tr_b16 v[130:131], v160 offset:53248
    s_add_u32 m0, s3, 0x8000
    s_add_u32 s76, s34, 0x100000
    v_mfma_f32_16x16x32_bf16 a[88:91], v[148:151], a[248:251], a[88:91]
    ds_read_b64_tr_b16 v[132:133], v161 offset:49152
    buffer_load_dwordx4 v188, s[8:11], s76 offen offset:0 lds
    v_add_u32 v230, 0x1000, v230
    v_lshlrev_b32 v181, 1, v228
    v_add_u32 v228, 0x1000, v228
    v_mfma_f32_16x16x32_bf16 a[84:87], v[148:151], a[244:247], a[84:87]
    ds_read_b64_tr_b16 v[134:135], v161 offset:53248
    buffer_load_dwordx4 v[212:215], v230, s[4:7], s81 offen
    v_mfma_f32_16x16x32_bf16 a[80:83], v[148:151], a[240:243], a[80:83]
    ds_read_b64_tr_b16 v[136:137], v162 offset:49152
    buffer_load_dwordx4 v189, s[8:11], s76 offen offset:1024 lds
    v_add_u32 v230, 0x1000, v230
    v_lshlrev_b32 v182, 1, v228
    v_add_u32 v228, 0x1000, v228
    v_mfma_f32_16x16x32_bf16 a[96:99], v[152:155], a[240:243], a[96:99]
    ds_read_b64_tr_b16 v[138:139], v162 offset:53248
    buffer_load_dwordx4 v[216:219], v230, s[4:7], s81 offen
    v_mfma_f32_16x16x32_bf16 a[100:103], v[152:155], a[244:247], a[100:103]
    ds_read_b64_tr_b16 v[140:141], v163 offset:49152
    buffer_load_dwordx4 v190, s[8:11], s76 offen offset:2048 lds
    v_add_u32 v230, 0x1000, v230
    v_lshlrev_b32 v183, 1, v228
    v_add_u32 v228, 0x1000, v228
    v_mfma_f32_16x16x32_bf16 a[104:107], v[152:155], a[248:251], a[104:107]
    ds_read_b64_tr_b16 v[142:143], v163 offset:53248
    v_mfma_f32_16x16x32_bf16 a[108:111], v[152:155], a[252:255], a[108:111]
    ds_read_b64_tr_b16 v[144:145], v164 offset:49152
    buffer_load_dwordx4 v192, s[8:11], s76 offen offset:3072 lds
    v_mfma_f32_16x16x32_bf16 a[124:127], v[156:159], a[252:255], a[124:127]
    ds_read_b64_tr_b16 v[146:147], v164 offset:53248
    v_mfma_f32_16x16x32_bf16 a[120:123], v[156:159], a[248:251], a[120:123]
    v_mfma_f32_16x16x32_bf16 a[116:119], v[156:159], a[244:247], a[116:119]
    v_mfma_f32_16x16x32_bf16 a[112:115], v[156:159], a[240:243], a[112:115]
    ds_read_b64_tr_b16 v[148:149], v165 offset:49152
    s_waitcnt lgkmcnt(9)
    v_mfma_f32_16x16x32_bf16 a[0:3], v[128:131], a[128:131], a[0:3]
    s_add_u32 s77, s33, 0x10000
    buffer_load_dwordx4 a[224:227], v179, s[16:19], s77 offen offset:0 sc1
    v_mfma_f32_16x16x32_bf16 a[4:7], v[128:131], a[132:135], a[4:7]
    ds_read_b64_tr_b16 v[150:151], v165 offset:53248
    v_mfma_f32_16x16x32_bf16 a[8:11], v[128:131], a[136:139], a[8:11]
    v_mfma_f32_16x16x32_bf16 a[12:15], v[128:131], a[140:143], a[12:15]
    ds_read_b64_tr_b16 v[152:153], v166 offset:49152
    s_waitcnt lgkmcnt(9)
    v_mfma_f32_16x16x32_bf16 a[28:31], v[132:135], a[140:143], a[28:31]
    buffer_load_dwordx4 a[228:231], v179, s[16:19], s77 offen offset:1024 sc1
    v_mfma_f32_16x16x32_bf16 a[24:27], v[132:135], a[136:139], a[24:27]
    ds_read_b64_tr_b16 v[154:155], v166 offset:53248
    v_mfma_f32_16x16x32_bf16 a[20:23], v[132:135], a[132:135], a[20:23]
    v_mfma_f32_16x16x32_bf16 a[16:19], v[132:135], a[128:131], a[16:19]
    ds_read_b64_tr_b16 v[156:157], v167 offset:49152
    s_waitcnt lgkmcnt(9)
    v_mfma_f32_16x16x32_bf16 a[32:35], v[136:139], a[128:131], a[32:35]
    buffer_load_dwordx4 a[232:235], v179, s[16:19], s77 offen offset:2048 sc1
    v_mfma_f32_16x16x32_bf16 a[36:39], v[136:139], a[132:135], a[36:39]
    ds_read_b64_tr_b16 v[158:159], v167 offset:53248
    v_mfma_f32_16x16x32_bf16 a[40:43], v[136:139], a[136:139], a[40:43]
    v_mfma_f32_16x16x32_bf16 a[44:47], v[136:139], a[140:143], a[44:47]
    ds_read_b64_tr_b16 v[128:129], v160 offset:57344
    s_waitcnt lgkmcnt(9)
    v_mfma_f32_16x16x32_bf16 a[60:63], v[140:143], a[140:143], a[60:63]
    buffer_load_dwordx4 a[236:239], v179, s[16:19], s77 offen offset:3072 sc1
    v_mfma_f32_16x16x32_bf16 a[56:59], v[140:143], a[136:139], a[56:59]
    ds_read_b64_tr_b16 v[130:131], v160 offset:61440
    v_mfma_f32_16x16x32_bf16 a[52:55], v[140:143], a[132:135], a[52:55]
    v_mfma_f32_16x16x32_bf16 a[48:51], v[140:143], a[128:131], a[48:51]
    ds_read_b64_tr_b16 v[132:133], v161 offset:57344
    s_waitcnt lgkmcnt(9)
    v_mfma_f32_16x16x32_bf16 a[64:67], v[144:147], a[128:131], a[64:67]
    s_add_u32 s77, s33, 0x14000
    buffer_load_dwordx4 a[240:243], v179, s[16:19], s77 offen offset:0 sc1
    v_mfma_f32_16x16x32_bf16 a[68:71], v[144:147], a[132:135], a[68:71]
    ds_read_b64_tr_b16 v[134:135], v161 offset:61440
    v_mfma_f32_16x16x32_bf16 a[72:75], v[144:147], a[136:139], a[72:75]
    v_mfma_f32_16x16x32_bf16 a[76:79], v[144:147], a[140:143], a[76:79]
    ds_read_b64_tr_b16 v[136:137], v162 offset:57344
    s_waitcnt lgkmcnt(9)
    v_mfma_f32_16x16x32_bf16 a[92:95], v[148:151], a[140:143], a[92:95]
    buffer_load_dwordx4 a[244:247], v179, s[16:19], s77 offen offset:1024 sc1
    v_mfma_f32_16x16x32_bf16 a[88:91], v[148:151], a[136:139], a[88:91]
    ds_read_b64_tr_b16 v[138:139], v162 offset:61440
    v_mfma_f32_16x16x32_bf16 a[84:87], v[148:151], a[132:135], a[84:87]
    v_mfma_f32_16x16x32_bf16 a[80:83], v[148:151], a[128:131], a[80:83]
    ds_read_b64_tr_b16 v[140:141], v163 offset:57344
    s_waitcnt lgkmcnt(9)
    v_mfma_f32_16x16x32_bf16 a[96:99], v[152:155], a[128:131], a[96:99]
    buffer_load_dwordx4 a[248:251], v179, s[16:19], s77 offen offset:2048 sc1
    v_mfma_f32_16x16x32_bf16 a[100:103], v[152:155], a[132:135], a[100:103]
    ds_read_b64_tr_b16 v[142:143], v163 offset:61440
    v_mfma_f32_16x16x32_bf16 a[104:107], v[152:155], a[136:139], a[104:107]
    v_mfma_f32_16x16x32_bf16 a[108:111], v[152:155], a[140:143], a[108:111]
    ds_read_b64_tr_b16 v[144:145], v164 offset:57344
    s_waitcnt lgkmcnt(9)
    v_mfma_f32_16x16x32_bf16 a[124:127], v[156:159], a[140:143], a[124:127]
    buffer_load_dwordx4 a[252:255], v179, s[16:19], s77 offen offset:3072 sc1
    v_mfma_f32_16x16x32_bf16 a[120:123], v[156:159], a[136:139], a[120:123]
    ds_read_b64_tr_b16 v[146:147], v164 offset:61440
    v_mfma_f32_16x16x32_bf16 a[116:119], v[156:159], a[132:135], a[116:119]
    v_mfma_f32_16x16x32_bf16 a[112:115], v[156:159], a[128:131], a[112:115]
    ds_read_b64_tr_b16 v[148:149], v165 offset:57344
    s_waitcnt lgkmcnt(9)
    v_mfma_f32_16x16x32_bf16 a[0:3], v[128:131], a[144:147], a[0:3]
    v_mfma_f32_16x16x32_bf16 a[4:7], v[128:131], a[148:151], a[4:7]
    ds_read_b64_tr_b16 v[150:151], v165 offset:61440
    v_mfma_f32_16x16x32_bf16 a[8:11], v[128:131], a[152:155], a[8:11]
    v_mfma_f32_16x16x32_bf16 a[12:15], v[128:131], a[156:159], a[12:15]
    ds_read_b64_tr_b16 v[152:153], v166 offset:57344
    s_waitcnt lgkmcnt(9)
    v_mfma_f32_16x16x32_bf16 a[28:31], v[132:135], a[156:159], a[28:31]
    v_mfma_f32_16x16x32_bf16 a[24:27], v[132:135], a[152:155], a[24:27]
    ds_read_b64_tr_b16 v[154:155], v166 offset:61440
    v_mfma_f32_16x16x32_bf16 a[20:23], v[132:135], a[148:151], a[20:23]
    v_mfma_f32_16x16x32_bf16 a[16:19], v[132:135], a[144:147], a[16:19]
    ds_read_b64_tr_b16 v[156:157], v167 offset:57344
    s_waitcnt lgkmcnt(9)
    v_mfma_f32_16x16x32_bf16 a[32:35], v[136:139], a[144:147], a[32:35]
    v_mfma_f32_16x16x32_bf16 a[36:39], v[136:139], a[148:151], a[36:39]
    ds_read_b64_tr_b16 v[158:159], v167 offset:61440
    v_mfma_f32_16x16x32_bf16 a[40:43], v[136:139], a[152:155], a[40:43]
    v_mfma_f32_16x16x32_bf16 a[44:47], v[136:139], a[156:159], a[44:47]
    s_waitcnt lgkmcnt(8)
    v_mfma_f32_16x16x32_bf16 a[60:63], v[140:143], a[156:159], a[60:63]
    v_mfma_f32_16x16x32_bf16 a[56:59], v[140:143], a[152:155], a[56:59]
    v_mfma_f32_16x16x32_bf16 a[52:55], v[140:143], a[148:151], a[52:55]
    v_mfma_f32_16x16x32_bf16 a[48:51], v[140:143], a[144:147], a[48:51]
    s_waitcnt lgkmcnt(6)
    v_mfma_f32_16x16x32_bf16 a[64:67], v[144:147], a[144:147], a[64:67]
    v_mfma_f32_16x16x32_bf16 a[68:71], v[144:147], a[148:151], a[68:71]
    v_mfma_f32_16x16x32_bf16 a[72:75], v[144:147], a[152:155], a[72:75]
    v_mfma_f32_16x16x32_bf16 a[76:79], v[144:147], a[156:159], a[76:79]
    s_waitcnt vmcnt(32) lgkmcnt(0)
    s_barrier
    ds_read_b64_tr_b16 v[128:129], v160 offset:0
    v_mfma_f32_16x16x32_bf16 a[92:95], v[148:151], a[156:159], a[92:95]
    ds_read_b64_tr_b16 v[130:131], v160 offset:4096
    s_add_u32 m0, s3, 0xc000
    s_add_u32 s76, s34, 0x170000
    v_mfma_f32_16x16x32_bf16 a[88:91], v[148:151], a[152:155], a[88:91]
    ds_read_b64_tr_b16 v[132:133], v161 offset:0
    buffer_load_dwordx4 v188, s[8:11], s76 offen offset:0 lds
    s_waitcnt vmcnt(11)
    v_and_b32 v228, 1, v226
    v_lshlrev_b32 v228, 4, v228
    v_mfma_f32_16x16x32_bf16 a[84:87], v[148:151], a[148:151], a[84:87]
    ds_read_b64_tr_b16 v[134:135], v161 offset:4096
    v_lshrrev_b32 v229, 1, v226
    v_lshlrev_b32 v230, 2, v227
    v_sub_u32 v229, v229, v230
    v_lshlrev_b32 v230, 16, v194
    v_mfma_f32_16x16x32_bf16 a[80:83], v[148:151], a[144:147], a[80:83]
    ds_read_b64_tr_b16 v[136:137], v162 offset:0
    buffer_load_dwordx4 v189, s[8:11], s76 offen offset:1024 lds
    v_mul_f32 v230, 0.5, v230
    v_cvt_pk_bf16_f32 v230, v230, 0
    v_lshlrev_b32 v230, v228, v230
    v_mfma_f32_16x16x32_bf16 a[96:99], v[152:155], a[144:147], a[96:99]
    ds_read_b64_tr_b16 v[138:139], v162 offset:4096
    v_cmp_eq_u32 vcc, 0, v229
    s_nop 1
    v_cndmask_b32 v220, 0, v230, vcc
    v_mfma_f32_16x16x32_bf16 a[100:103], v[152:155], a[148:151], a[100:103]
    ds_read_b64_tr_b16 v[140:141], v163 offset:0
    buffer_load_dwordx4 v190, s[8:11], s76 offen offset:2048 lds
    v_cmp_eq_u32 vcc, 1, v229
    s_nop 1
    v_cndmask_b32 v221, 0, v230, vcc
    v_mfma_f32_16x16x32_bf16 a[104:107], v[152:155], a[152:155], a[104:107]
    ds_read_b64_tr_b16 v[142:143], v163 offset:4096
    v_cmp_eq_u32 vcc, 2, v229
    s_nop 1
    v_cndmask_b32 v222, 0, v230, vcc
    v_mfma_f32_16x16x32_bf16 a[108:111], v[152:155], a[156:159], a[108:111]
    ds_read_b64_tr_b16 v[144:145], v164 offset:0
    buffer_load_dwordx4 v192, s[8:11], s76 offen offset:3072 lds
    v_cmp_eq_u32 vcc, 3, v229
    s_nop 1
    v_cndmask_b32 v223, 0, v230, vcc
    v_mfma_f32_16x16x32_bf16 a[124:127], v[156:159], a[156:159], a[124:127]
    ds_read_b64_tr_b16 v[146:147], v164 offset:4096
    s_nop 1
    v_mfma_f32_16x16x32_bf16 v[0:3], v[220:223], v[204:207], 0
    v_mfma_f32_16x16x32_bf16 v[4:7], v[220:223], v[208:211], 0
    v_mfma_f32_16x16x32_bf16 v[8:11], v[220:223], v[212:215], 0
    v_mfma_f32_16x16x32_bf16 a[120:123], v[156:159], a[152:155], a[120:123]
    v_mfma_f32_16x16x32_bf16 v[12:15], v[220:223], v[216:219], 0
    v_lshlrev_b32 v230, 16, v195
    v_mul_f32 v230, 0.5, v230
    v_cvt_pk_bf16_f32 v230, v230, 0
    v_lshlrev_b32 v230, v228, v230
    v_mfma_f32_16x16x32_bf16 a[116:119], v[156:159], a[148:151], a[116:119]
    v_cmp_eq_u32 vcc, -8, v229
    s_nop 1
    v_cndmask_b32 v240, 0, v230, vcc
    v_mfma_f32_16x16x32_bf16 a[112:115], v[156:159], a[144:147], a[112:115]
    ds_read_b64_tr_b16 v[148:149], v165 offset:0
    v_cmp_eq_u32 vcc, -7, v229
    s_nop 1
    v_cndmask_b32 v241, 0, v230, vcc
    s_waitcnt lgkmcnt(9)
    v_mfma_f32_16x16x32_bf16 a[0:3], v[128:131], a[160:163], a[0:3]
    s_add_u32 s77, s33, 0x17000
    buffer_load_dwordx4 a[128:131], v179, s[16:19], s77 offen offset:0 sc1
    v_cmp_eq_u32 vcc, -6, v229
    s_nop 1
    v_cndmask_b32 v242, 0, v230, vcc
    v_mfma_f32_16x16x32_bf16 a[4:7], v[128:131], a[164:167], a[4:7]
    ds_read_b64_tr_b16 v[150:151], v165 offset:4096
    v_cmp_eq_u32 vcc, -5, v229
    s_nop 1
    v_cndmask_b32 v243, 0, v230, vcc
    v_mfma_f32_16x16x32_bf16 a[8:11], v[128:131], a[168:171], a[8:11]
    s_nop 1
    v_mfma_f32_16x16x32_bf16 v[16:19], v[240:243], v[204:207], 0
    v_mfma_f32_16x16x32_bf16 v[20:23], v[240:243], v[208:211], 0
    v_mfma_f32_16x16x32_bf16 v[24:27], v[240:243], v[212:215], 0
    v_mfma_f32_16x16x32_bf16 v[28:31], v[240:243], v[216:219], 0
    v_mfma_f32_16x16x32_bf16 a[12:15], v[128:131], a[172:175], a[12:15]
    ds_read_b64_tr_b16 v[152:153], v166 offset:0
    v_sub_f32 v232, 1.0, v250
    v_cvt_pk_bf16_f32 v232, v232, v232
    s_waitcnt lgkmcnt(9)
    v_mfma_f32_16x16x32_bf16 a[28:31], v[132:135], a[172:175], a[28:31]
    buffer_load_dwordx4 a[132:135], v179, s[16:19], s77 offen offset:1024 sc1
    v_lshlrev_b32 v232, 16, v232
    v_add_f32 v236, v250, v250
    v_sub_f32 v233, 1.0, v251
    v_cvt_pk_bf16_f32 v233, v233, v233
    v_mfma_f32_16x16x32_bf16 a[24:27], v[132:135], a[168:171], a[24:27]
    ds_read_b64_tr_b16 v[154:155], v166 offset:4096
    v_lshlrev_b32 v233, 16, v233
    v_add_f32 v237, v251, v251
    v_sub_f32 v234, 1.0, v252
    v_cvt_pk_bf16_f32 v234, v234, v234
    v_mfma_f32_16x16x32_bf16 a[20:23], v[132:135], a[164:167], a[20:23]
    v_lshlrev_b32 v234, 16, v234
    v_add_f32 v238, v252, v252
    v_sub_f32 v235, 1.0, v253
    v_cvt_pk_bf16_f32 v235, v235, v235
    v_lshlrev_b32 v235, 16, v235
    v_mfma_f32_16x16x32_bf16 a[16:19], v[132:135], a[160:163], a[16:19]
    ds_read_b64_tr_b16 v[156:157], v167 offset:0
    v_add_f32 v239, v253, v253
    s_add_u32 s80, s100, 1
    s_and_b32 s80, s80, 3
    s_lshl_b32 s81, s101, 2
    s_waitcnt lgkmcnt(9)
    v_mfma_f32_16x16x32_bf16 a[32:35], v[136:139], a[160:163], a[32:35]
    buffer_load_dwordx4 a[136:139], v179, s[16:19], s77 offen offset:2048 sc1
    s_add_u32 s80, s80, s81
    s_mul_i32 s80, s80, 3
    s_add_u32 s80, s80, 0
    s_lshl_b32 s80, s80, 2
    v_mfma_f32_16x16x32_bf16 a[36:39], v[136:139], a[164:167], a[36:39]
    ds_read_b64_tr_b16 v[158:159], v167 offset:4096
    s_add_u32 s80, s80, s28
    s_lshl_b32 s80, s80, 12
    s_add_u32 s83, s80, 0x2000000
    s_add_u32 s80, s100, 2
    v_mfma_f32_16x16x32_bf16 a[40:43], v[136:139], a[168:171], a[40:43]
    s_and_b32 s80, s80, 3
    s_lshl_b32 s81, s101, 2
    s_add_u32 s80, s80, s81
    s_mul_i32 s80, s80, 3
    s_add_u32 s80, s80, 1
    v_mfma_f32_16x16x32_bf16 a[44:47], v[136:139], a[172:175], a[44:47]
    ds_read_b64_tr_b16 v[128:129], v160 offset:8192
    s_lshl_b32 s80, s80, 2
    s_add_u32 s80, s80, s28
    s_lshl_b32 s80, s80, 12
    s_add_u32 s84, s80, 0x2000000
    s_waitcnt lgkmcnt(9)
    v_mfma_f32_16x16x32_bf16 a[60:63], v[140:143], a[172:175], a[60:63]
    buffer_load_dwordx4 a[140:143], v179, s[16:19], s77 offen offset:3072 sc1
    s_add_u32 s80, s100, 3
    s_and_b32 s80, s80, 3
    s_lshl_b32 s81, s101, 2
    s_add_u32 s80, s80, s81
    v_mfma_f32_16x16x32_bf16 a[56:59], v[140:143], a[168:171], a[56:59]
    ds_read_b64_tr_b16 v[130:131], v160 offset:12288
    s_mul_i32 s80, s80, 3
    s_add_u32 s80, s80, 2
    s_lshl_b32 s80, s80, 2
    s_add_u32 s80, s80, s28
    v_mfma_f32_16x16x32_bf16 a[52:55], v[140:143], a[164:167], a[52:55]
    s_lshl_b32 s80, s80, 12
    s_add_u32 s85, s80, 0x2000000
    s_lshl_b32 s80, s101, 2
    s_add_u32 s80, s80, s100
    s_mul_i32 s80, s80, 12
    v_mfma_f32_16x16x32_bf16 a[48:51], v[140:143], a[160:163], a[48:51]
    ds_read_b64_tr_b16 v[132:133], v161 offset:8192
    s_add_u32 s80, s80, s28
    s_lshl_b32 s80, s80, 12
    s_add_u32 s86, s80, 0x2000000
    s_lshl_b32 s87, s101, 7
    s_waitcnt lgkmcnt(9)
    v_mfma_f32_16x16x32_bf16 a[64:67], v[144:147], a[160:163], a[64:67]
    s_add_u32 s77, s33, 0x1b000
    buffer_load_dwordx4 a[144:147], v179, s[16:19], s77 offen offset:0 sc1
    s_lshl_b32 s80, s28, 4
    s_add_u32 s87, s87, s80
    s_add_u32 s87, s87, 0x1a08000
    v_mfma_f32_16x16x32_bf16 a[68:71], v[144:147], a[164:167], a[68:71]
    ds_read_b64_tr_b16 v[134:135], v161 offset:12288
    buffer_load_dword v174, v254, s[16:19], s78 offen offset:384 sc1
    v_and_b32 v175, 12, v254
    v_and_b32 v231, 31, v224
    v_lshlrev_b32 v231, 2, v231
    v_mfma_f32_16x16x32_bf16 a[72:75], v[144:147], a[168:171], a[72:75]
    s_lshl_b32 s82, s100, 5
    s_sub_u32 s82, s78, s82
    v_mfma_f32_16x16x32_bf16 a[76:79], v[144:147], a[172:175], a[76:79]
    ds_read_b64_tr_b16 v[136:137], v162 offset:8192
    s_waitcnt lgkmcnt(9)
    v_mfma_f32_16x16x32_bf16 a[92:95], v[148:151], a[172:175], a[92:95]
    buffer_load_dwordx4 a[148:151], v179, s[16:19], s77 offen offset:1024 sc1
    v_mfma_f32_16x16x32_bf16 a[88:91], v[148:151], a[168:171], a[88:91]
    ds_read_b64_tr_b16 v[138:139], v162 offset:12288
    v_mfma_f32_16x16x32_bf16 a[84:87], v[148:151], a[164:167], a[84:87]
    v_mfma_f32_16x16x32_bf16 a[80:83], v[148:151], a[160:163], a[80:83]
    ds_read_b64_tr_b16 v[140:141], v163 offset:8192
    s_waitcnt lgkmcnt(9)
    v_mfma_f32_16x16x32_bf16 a[96:99], v[152:155], a[160:163], a[96:99]
    buffer_load_dwordx4 a[152:155], v179, s[16:19], s77 offen offset:2048 sc1
    v_mfma_f32_16x16x32_bf16 a[100:103], v[152:155], a[164:167], a[100:103]
    ds_read_b64_tr_b16 v[142:143], v163 offset:12288
    v_mfma_f32_16x16x32_bf16 a[104:107], v[152:155], a[168:171], a[104:107]
    v_mfma_f32_16x16x32_bf16 a[108:111], v[152:155], a[172:175], a[108:111]
    ds_read_b64_tr_b16 v[144:145], v164 offset:8192
    s_waitcnt lgkmcnt(9)
    v_mfma_f32_16x16x32_bf16 a[124:127], v[156:159], a[172:175], a[124:127]
    buffer_load_dwordx4 a[156:159], v179, s[16:19], s77 offen offset:3072 sc1
    v_mfma_f32_16x16x32_bf16 a[120:123], v[156:159], a[168:171], a[120:123]
    ds_read_b64_tr_b16 v[146:147], v164 offset:12288
    v_mfma_f32_16x16x32_bf16 a[116:119], v[156:159], a[164:167], a[116:119]
    v_mfma_f32_16x16x32_bf16 a[112:115], v[156:159], a[160:163], a[112:115]
    ds_read_b64_tr_b16 v[148:149], v165 offset:8192
    s_waitcnt lgkmcnt(9)
    v_mfma_f32_16x16x32_bf16 a[0:3], v[128:131], a[176:179], a[0:3]
    v_mfma_f32_16x16x32_bf16 a[4:7], v[128:131], a[180:183], a[4:7]
    ds_read_b64_tr_b16 v[150:151], v165 offset:12288
    v_mfma_f32_16x16x32_bf16 a[8:11], v[128:131], a[184:187], a[8:11]
    v_mfma_f32_16x16x32_bf16 a[12:15], v[128:131], a[188:191], a[12:15]
    ds_read_b64_tr_b16 v[152:153], v166 offset:8192
    s_waitcnt lgkmcnt(9)
    v_mfma_f32_16x16x32_bf16 a[28:31], v[132:135], a[188:191], a[28:31]
    v_mfma_f32_16x16x32_bf16 a[24:27], v[132:135], a[184:187], a[24:27]
    ds_read_b64_tr_b16 v[154:155], v166 offset:12288
    v_mfma_f32_16x16x32_bf16 a[20:23], v[132:135], a[180:183], a[20:23]
    v_mfma_f32_16x16x32_bf16 a[16:19], v[132:135], a[176:179], a[16:19]
    ds_read_b64_tr_b16 v[156:157], v167 offset:8192
    s_waitcnt lgkmcnt(9)
    v_mfma_f32_16x16x32_bf16 a[32:35], v[136:139], a[176:179], a[32:35]
    v_mfma_f32_16x16x32_bf16 a[36:39], v[136:139], a[180:183], a[36:39]
    ds_read_b64_tr_b16 v[158:159], v167 offset:12288
    v_mfma_f32_16x16x32_bf16 a[40:43], v[136:139], a[184:187], a[40:43]
    v_mfma_f32_16x16x32_bf16 a[44:47], v[136:139], a[188:191], a[44:47]
    s_waitcnt lgkmcnt(8)
    v_mfma_f32_16x16x32_bf16 a[60:63], v[140:143], a[188:191], a[60:63]
    v_mfma_f32_16x16x32_bf16 a[56:59], v[140:143], a[184:187], a[56:59]
    v_mfma_f32_16x16x32_bf16 a[52:55], v[140:143], a[180:183], a[52:55]
    v_mfma_f32_16x16x32_bf16 a[48:51], v[140:143], a[176:179], a[48:51]
    s_waitcnt lgkmcnt(6)
    v_mfma_f32_16x16x32_bf16 a[64:67], v[144:147], a[176:179], a[64:67]
    v_mfma_f32_16x16x32_bf16 a[68:71], v[144:147], a[180:183], a[68:71]
    v_mfma_f32_16x16x32_bf16 a[72:75], v[144:147], a[184:187], a[72:75]
    v_mfma_f32_16x16x32_bf16 a[76:79], v[144:147], a[188:191], a[76:79]
    s_waitcnt vmcnt(28) lgkmcnt(0)
    s_barrier
    ds_read_b64_tr_b16 v[128:129], v160 offset:16384
    v_mfma_f32_16x16x32_bf16 a[92:95], v[148:151], a[188:191], a[92:95]
    ds_read_b64_tr_b16 v[130:131], v160 offset:20480
    s_add_u32 m0, s3, 0x0
    s_add_u32 s76, s35, 0x30000
    v_mfma_f32_16x16x32_bf16 a[88:91], v[148:151], a[184:187], a[88:91]
    ds_read_b64_tr_b16 v[132:133], v161 offset:16384
    buffer_load_dwordx4 v188, s[8:11], s76 offen offset:0 lds
    v_mfma_f32_16x16x32_bf16 a[84:87], v[148:151], a[180:183], a[84:87]
    ds_read_b64_tr_b16 v[134:135], v161 offset:20480
    v_mfma_f32_16x16x32_bf16 a[80:83], v[148:151], a[176:179], a[80:83]
    ds_read_b64_tr_b16 v[136:137], v162 offset:16384
    s_add_u32 s76, s76, 0x2000
    v_mfma_f32_16x16x32_bf16 a[96:99], v[152:155], a[176:179], a[96:99]
    ds_read_b64_tr_b16 v[138:139], v162 offset:20480
    buffer_load_dwordx4 v189, s[8:11], s76 offen offset:1024 lds
    v_mfma_f32_16x16x32_bf16 a[100:103], v[152:155], a[180:183], a[100:103]
    ds_read_b64_tr_b16 v[140:141], v163 offset:16384
    v_mfma_f32_16x16x32_bf16 a[104:107], v[152:155], a[184:187], a[104:107]
    ds_read_b64_tr_b16 v[142:143], v163 offset:20480
    s_add_u32 s76, s76, 0x2000
    v_mfma_f32_16x16x32_bf16 a[108:111], v[152:155], a[188:191], a[108:111]
    ds_read_b64_tr_b16 v[144:145], v164 offset:16384
    buffer_load_dwordx4 v190, s[8:11], s76 offen offset:2048 lds
    v_mfma_f32_16x16x32_bf16 a[124:127], v[156:159], a[188:191], a[124:127]
    ds_read_b64_tr_b16 v[146:147], v164 offset:20480
    v_mfma_f32_16x16x32_bf16 a[120:123], v[156:159], a[184:187], a[120:123]
    s_add_u32 s76, s76, 0x2000
    v_mfma_f32_16x16x32_bf16 a[116:119], v[156:159], a[180:183], a[116:119]
    buffer_load_dwordx4 v192, s[8:11], s76 offen offset:3072 lds
    v_mfma_f32_16x16x32_bf16 a[112:115], v[156:159], a[176:179], a[112:115]
    ds_read_b64_tr_b16 v[148:149], v165 offset:16384
    s_waitcnt lgkmcnt(9)
    v_mfma_f32_16x16x32_bf16 a[0:3], v[128:131], a[192:195], a[0:3]
    s_waitcnt vmcnt(7)
    v_cmp_eq_u32 vcc, 1, v174
    s_cmp_eq_u64 vcc, -1
    s_cbranch_scc0 chk_6_slow
chk_6_ok:
    s_add_u32 s77, s33, 0x3000
    buffer_load_dwordx4 a[160:163], v179, s[16:19], s77 offen offset:0 sc1
    v_mfma_f32_16x16x32_bf16 a[4:7], v[128:131], a[196:199], a[4:7]
    ds_read_b64_tr_b16 v[150:151], v165 offset:20480
    v_mfma_f32_16x16x32_bf16 a[8:11], v[128:131], a[200:203], a[8:11]
    v_mfma_f32_16x16x32_bf16 a[12:15], v[128:131], a[204:207], a[12:15]
    ds_read_b64_tr_b16 v[152:153], v166 offset:16384
    s_waitcnt lgkmcnt(9)
    v_mfma_f32_16x16x32_bf16 a[28:31], v[132:135], a[204:207], a[28:31]
    buffer_load_dwordx4 a[164:167], v179, s[16:19], s77 offen offset:1024 sc1
    v_mfma_f32_16x16x32_bf16 a[24:27], v[132:135], a[200:203], a[24:27]
    ds_read_b64_tr_b16 v[154:155], v166 offset:20480
    v_mfma_f32_16x16x32_bf16 a[20:23], v[132:135], a[196:199], a[20:23]
    v_mfma_f32_16x16x32_bf16 a[16:19], v[132:135], a[192:195], a[16:19]
    ds_read_b64_tr_b16 v[156:157], v167 offset:16384
    s_waitcnt lgkmcnt(9)
    v_mfma_f32_16x16x32_bf16 a[32:35], v[136:139], a[192:195], a[32:35]
    buffer_load_dwordx4 a[168:171], v179, s[16:19], s77 offen offset:2048 sc1
    v_mfma_f32_16x16x32_bf16 a[36:39], v[136:139], a[196:199], a[36:39]
    ds_read_b64_tr_b16 v[158:159], v167 offset:20480
    v_mfma_f32_16x16x32_bf16 a[40:43], v[136:139], a[200:203], a[40:43]
    v_mfma_f32_16x16x32_bf16 a[44:47], v[136:139], a[204:207], a[44:47]
    ds_read_b64_tr_b16 v[128:129], v160 offset:24576
    s_waitcnt lgkmcnt(9)
    v_mfma_f32_16x16x32_bf16 a[60:63], v[140:143], a[204:207], a[60:63]
    buffer_load_dwordx4 a[172:175], v179, s[16:19], s77 offen offset:3072 sc1
    v_mfma_f32_16x16x32_bf16 a[56:59], v[140:143], a[200:203], a[56:59]
    ds_read_b64_tr_b16 v[130:131], v160 offset:28672
    v_mfma_f32_16x16x32_bf16 a[52:55], v[140:143], a[196:199], a[52:55]
    v_mfma_f32_16x16x32_bf16 a[48:51], v[140:143], a[192:195], a[48:51]
    ds_read_b64_tr_b16 v[132:133], v161 offset:24576
    s_waitcnt lgkmcnt(9)
    v_mfma_f32_16x16x32_bf16 a[64:67], v[144:147], a[192:195], a[64:67]
    s_add_u32 s77, s33, 0xa000
    buffer_load_dwordx4 a[176:179], v179, s[16:19], s77 offen offset:0 sc1
    v_mfma_f32_16x16x32_bf16 a[68:71], v[144:147], a[196:199], a[68:71]
    ds_read_b64_tr_b16 v[134:135], v161 offset:28672
    v_mfma_f32_16x16x32_bf16 a[72:75], v[144:147], a[200:203], a[72:75]
    v_mfma_f32_16x16x32_bf16 a[76:79], v[144:147], a[204:207], a[76:79]
    ds_read_b64_tr_b16 v[136:137], v162 offset:24576
    s_waitcnt lgkmcnt(9)
    v_mfma_f32_16x16x32_bf16 a[92:95], v[148:151], a[204:207], a[92:95]
    buffer_load_dwordx4 a[180:183], v179, s[16:19], s77 offen offset:1024 sc1
    v_mfma_f32_16x16x32_bf16 a[88:91], v[148:151], a[200:203], a[88:91]
    ds_read_b64_tr_b16 v[138:139], v162 offset:28672
    v_mfma_f32_16x16x32_bf16 a[84:87], v[148:151], a[196:199], a[84:87]
    v_mfma_f32_16x16x32_bf16 a[80:83], v[148:151], a[192:195], a[80:83]
    ds_read_b64_tr_b16 v[140:141], v163 offset:24576
    s_waitcnt lgkmcnt(9)
    v_mfma_f32_16x16x32_bf16 a[96:99], v[152:155], a[192:195], a[96:99]
    buffer_load_dwordx4 a[184:187], v179, s[16:19], s77 offen offset:2048 sc1
    v_mfma_f32_16x16x32_bf16 a[100:103], v[152:155], a[196:199], a[100:103]
    ds_read_b64_tr_b16 v[142:143], v163 offset:28672
    v_mfma_f32_16x16x32_bf16 a[104:107], v[152:155], a[200:203], a[104:107]
    v_mfma_f32_16x16x32_bf16 a[108:111], v[152:155], a[204:207], a[108:111]
    ds_read_b64_tr_b16 v[144:145], v164 offset:24576
    s_waitcnt lgkmcnt(9)
    v_mfma_f32_16x16x32_bf16 a[124:127], v[156:159], a[204:207], a[124:127]
    buffer_load_dwordx4 a[188:191], v179, s[16:19], s77 offen offset:3072 sc1
    v_mfma_f32_16x16x32_bf16 a[120:123], v[156:159], a[200:203], a[120:123]
    ds_read_b64_tr_b16 v[146:147], v164 offset:28672
    v_mfma_f32_16x16x32_bf16 a[116:119], v[156:159], a[196:199], a[116:119]
    v_mfma_f32_16x16x32_bf16 a[112:115], v[156:159], a[192:195], a[112:115]
    ds_read_b64_tr_b16 v[148:149], v165 offset:24576
    s_waitcnt lgkmcnt(9)
    v_mfma_f32_16x16x32_bf16 a[0:3], v[128:131], a[208:211], a[0:3]
    v_mfma_f32_16x16x32_bf16 a[4:7], v[128:131], a[212:215], a[4:7]
    ds_read_b64_tr_b16 v[150:151], v165 offset:28672
    v_mfma_f32_16x16x32_bf16 a[8:11], v[128:131], a[216:219], a[8:11]
    v_mfma_f32_16x16x32_bf16 a[12:15], v[128:131], a[220:223], a[12:15]
    ds_read_b64_tr_b16 v[152:153], v166 offset:24576
    s_waitcnt lgkmcnt(9)
    v_mfma_f32_16x16x32_bf16 a[28:31], v[132:135], a[220:223], a[28:31]
    v_mfma_f32_16x16x32_bf16 a[24:27], v[132:135], a[216:219], a[24:27]
    ds_read_b64_tr_b16 v[154:155], v166 offset:28672
    v_mfma_f32_16x16x32_bf16 a[20:23], v[132:135], a[212:215], a[20:23]
    v_mfma_f32_16x16x32_bf16 a[16:19], v[132:135], a[208:211], a[16:19]
    ds_read_b64_tr_b16 v[156:157], v167 offset:24576
    s_waitcnt lgkmcnt(9)
    v_mfma_f32_16x16x32_bf16 a[32:35], v[136:139], a[208:211], a[32:35]
    v_mfma_f32_16x16x32_bf16 a[36:39], v[136:139], a[212:215], a[36:39]
    ds_read_b64_tr_b16 v[158:159], v167 offset:28672
    v_mfma_f32_16x16x32_bf16 a[40:43], v[136:139], a[216:219], a[40:43]
    v_mfma_f32_16x16x32_bf16 a[44:47], v[136:139], a[220:223], a[44:47]
    s_waitcnt lgkmcnt(8)
    v_mfma_f32_16x16x32_bf16 a[60:63], v[140:143], a[220:223], a[60:63]
    v_mfma_f32_16x16x32_bf16 a[56:59], v[140:143], a[216:219], a[56:59]
    v_mfma_f32_16x16x32_bf16 a[52:55], v[140:143], a[212:215], a[52:55]
    v_mfma_f32_16x16x32_bf16 a[48:51], v[140:143], a[208:211], a[48:51]
    s_waitcnt lgkmcnt(6)
    v_mfma_f32_16x16x32_bf16 a[64:67], v[144:147], a[208:211], a[64:67]
    v_mfma_f32_16x16x32_bf16 a[68:71], v[144:147], a[212:215], a[68:71]
    v_mfma_f32_16x16x32_bf16 a[72:75], v[144:147], a[216:219], a[72:75]
    v_mfma_f32_16x16x32_bf16 a[76:79], v[144:147], a[220:223], a[76:79]
    s_waitcnt vmcnt(25) lgkmcnt(0)
    s_barrier
    ds_read_b64_tr_b16 v[128:129], v160 offset:32768
    v_mfma_f32_16x16x32_bf16 a[92:95], v[148:151], a[220:223], a[92:95]
    ds_read_b64_tr_b16 v[130:131], v160 offset:36864
    s_add_u32 m0, s3, 0x4000
    s_add_u32 s76, s35, 0x110000
    v_mfma_f32_16x16x32_bf16 a[88:91], v[148:151], a[216:219], a[88:91]
    ds_read_b64_tr_b16 v[132:133], v161 offset:32768
    buffer_load_dwordx4 v188, s[8:11], s76 offen offset:0 lds
    v_mfma_f32_16x16x32_bf16 a[84:87], v[148:151], a[212:215], a[84:87]
    ds_read_b64_tr_b16 v[134:135], v161 offset:36864
    v_mfma_f32_16x16x32_bf16 a[80:83], v[148:151], a[208:211], a[80:83]
    ds_read_b64_tr_b16 v[136:137], v162 offset:32768
    s_add_u32 s76, s76, 0x2000
    v_mfma_f32_16x16x32_bf16 a[96:99], v[152:155], a[208:211], a[96:99]
    ds_read_b64_tr_b16 v[138:139], v162 offset:36864
    buffer_load_dwordx4 v189, s[8:11], s76 offen offset:1024 lds
    v_mfma_f32_16x16x32_bf16 a[100:103], v[152:155], a[212:215], a[100:103]
    ds_read_b64_tr_b16 v[140:141], v163 offset:32768
    v_mfma_f32_16x16x32_bf16 a[104:107], v[152:155], a[216:219], a[104:107]
    ds_read_b64_tr_b16 v[142:143], v163 offset:36864
    s_add_u32 s76, s76, 0x2000
    v_mfma_f32_16x16x32_bf16 a[108:111], v[152:155], a[220:223], a[108:111]
    ds_read_b64_tr_b16 v[144:145], v164 offset:32768
    buffer_load_dwordx4 v190, s[8:11], s76 offen offset:2048 lds
    v_mfma_f32_16x16x32_bf16 a[124:127], v[156:159], a[220:223], a[124:127]
    ds_read_b64_tr_b16 v[146:147], v164 offset:36864
    v_mfma_f32_16x16x32_bf16 a[120:123], v[156:159], a[216:219], a[120:123]
    s_add_u32 s76, s76, 0x2000
    v_mfma_f32_16x16x32_bf16 a[116:119], v[156:159], a[212:215], a[116:119]
    buffer_load_dwordx4 v192, s[8:11], s76 offen offset:3072 lds
    v_mfma_f32_16x16x32_bf16 a[112:115], v[156:159], a[208:211], a[112:115]
    ds_read_b64_tr_b16 v[148:149], v165 offset:32768
    s_waitcnt lgkmcnt(9)
    v_mfma_f32_16x16x32_bf16 a[0:3], v[128:131], a[224:227], a[0:3]
    s_add_u32 s77, s33, 0x11000
    buffer_load_dwordx4 a[192:195], v179, s[16:19], s77 offen offset:0 sc1
    v_mfma_f32_16x16x32_bf16 a[4:7], v[128:131], a[228:231], a[4:7]
    ds_read_b64_tr_b16 v[150:151], v165 offset:36864
    v_mfma_f32_16x16x32_bf16 a[8:11], v[128:131], a[232:235], a[8:11]
    v_mfma_f32_16x16x32_bf16 a[12:15], v[128:131], a[236:239], a[12:15]
    ds_read_b64_tr_b16 v[152:153], v166 offset:32768
    s_waitcnt lgkmcnt(9)
    v_mfma_f32_16x16x32_bf16 a[28:31], v[132:135], a[236:239], a[28:31]
    buffer_load_dwordx4 a[196:199], v179, s[16:19], s77 offen offset:1024 sc1
    v_mfma_f32_16x16x32_bf16 a[24:27], v[132:135], a[232:235], a[24:27]
    ds_read_b64_tr_b16 v[154:155], v166 offset:36864
    v_mfma_f32_16x16x32_bf16 a[20:23], v[132:135], a[228:231], a[20:23]
    v_mfma_f32_16x16x32_bf16 a[16:19], v[132:135], a[224:227], a[16:19]
    ds_read_b64_tr_b16 v[156:157], v167 offset:32768
    s_waitcnt lgkmcnt(9)
    v_mfma_f32_16x16x32_bf16 a[32:35], v[136:139], a[224:227], a[32:35]
    buffer_load_dwordx4 a[200:203], v179, s[16:19], s77 offen offset:2048 sc1
    v_mfma_f32_16x16x32_bf16 a[36:39], v[136:139], a[228:231], a[36:39]
    ds_read_b64_tr_b16 v[158:159], v167 offset:36864
    v_mfma_f32_16x16x32_bf16 a[40:43], v[136:139], a[232:235], a[40:43]
    v_mfma_f32_16x16x32_bf16 a[44:47], v[136:139], a[236:239], a[44:47]
    ds_read_b64_tr_b16 v[128:129], v160 offset:40960
    s_waitcnt lgkmcnt(9)
    v_mfma_f32_16x16x32_bf16 a[60:63], v[140:143], a[236:239], a[60:63]
    buffer_load_dwordx4 a[204:207], v179, s[16:19], s77 offen offset:3072 sc1
    v_mfma_f32_16x16x32_bf16 a[56:59], v[140:143], a[232:235], a[56:59]
    ds_read_b64_tr_b16 v[130:131], v160 offset:45056
    v_mfma_f32_16x16x32_bf16 a[52:55], v[140:143], a[228:231], a[52:55]
    v_mfma_f32_16x16x32_bf16 a[48:51], v[140:143], a[224:227], a[48:51]
    ds_read_b64_tr_b16 v[132:133], v161 offset:40960
    s_waitcnt lgkmcnt(9)
    v_mfma_f32_16x16x32_bf16 a[64:67], v[144:147], a[224:227], a[64:67]
    s_add_u32 s77, s33, 0x18000
    buffer_load_dwordx4 a[208:211], v179, s[16:19], s77 offen offset:0 sc1
    v_mfma_f32_16x16x32_bf16 a[68:71], v[144:147], a[228:231], a[68:71]
    ds_read_b64_tr_b16 v[134:135], v161 offset:45056
    buffer_load_dword v174, v254, s[16:19], s78 offen offset:512 sc1
    v_mfma_f32_16x16x32_bf16 a[72:75], v[144:147], a[232:235], a[72:75]
    v_mfma_f32_16x16x32_bf16 a[76:79], v[144:147], a[236:239], a[76:79]
    ds_read_b64_tr_b16 v[136:137], v162 offset:40960
    s_waitcnt lgkmcnt(9)
    v_mfma_f32_16x16x32_bf16 a[92:95], v[148:151], a[236:239], a[92:95]
    buffer_load_dwordx4 a[212:215], v179, s[16:19], s77 offen offset:1024 sc1
    v_mfma_f32_16x16x32_bf16 a[88:91], v[148:151], a[232:235], a[88:91]
    ds_read_b64_tr_b16 v[138:139], v162 offset:45056
    v_mfma_f32_16x16x32_bf16 a[84:87], v[148:151], a[228:231], a[84:87]
    v_mfma_f32_16x16x32_bf16 a[80:83], v[148:151], a[224:227], a[80:83]
    ds_read_b64_tr_b16 v[140:141], v163 offset:40960
    s_waitcnt lgkmcnt(9)
    v_mfma_f32_16x16x32_bf16 a[96:99], v[152:155], a[224:227], a[96:99]
    buffer_load_dwordx4 a[216:219], v179, s[16:19], s77 offen offset:2048 sc1
    v_mfma_f32_16x16x32_bf16 a[100:103], v[152:155], a[228:231], a[100:103]
    ds_read_b64_tr_b16 v[142:143], v163 offset:45056
    v_mfma_f32_16x16x32_bf16 a[104:107], v[152:155], a[232:235], a[104:107]
    v_mfma_f32_16x16x32_bf16 a[108:111], v[152:155], a[236:239], a[108:111]
    ds_read_b64_tr_b16 v[144:145], v164 offset:40960
    s_waitcnt lgkmcnt(9)
    v_mfma_f32_16x16x32_bf16 a[124:127], v[156:159], a[236:239], a[124:127]
    buffer_load_dwordx4 a[220:223], v179, s[16:19], s77 offen offset:3072 sc1
    v_mfma_f32_16x16x32_bf16 a[120:123], v[156:159], a[232:235], a[120:123]
    ds_read_b64_tr_b16 v[146:147], v164 offset:45056
    v_mfma_f32_16x16x32_bf16 a[116:119], v[156:159], a[228:231], a[116:119]
    v_mfma_f32_16x16x32_bf16 a[112:115], v[156:159], a[224:227], a[112:115]
    ds_read_b64_tr_b16 v[148:149], v165 offset:40960
    s_waitcnt lgkmcnt(9)
    v_mfma_f32_16x16x32_bf16 a[0:3], v[128:131], a[240:243], a[0:3]
    v_mfma_f32_16x16x32_bf16 a[4:7], v[128:131], a[244:247], a[4:7]
    ds_read_b64_tr_b16 v[150:151], v165 offset:45056
    v_mfma_f32_16x16x32_bf16 a[8:11], v[128:131], a[248:251], a[8:11]
    v_mfma_f32_16x16x32_bf16 a[12:15], v[128:131], a[252:255], a[12:15]
    ds_read_b64_tr_b16 v[152:153], v166 offset:40960
    s_waitcnt lgkmcnt(9)
    v_mfma_f32_16x16x32_bf16 a[28:31], v[132:135], a[252:255], a[28:31]
    v_mfma_f32_16x16x32_bf16 a[24:27], v[132:135], a[248:251], a[24:27]
    ds_read_b64_tr_b16 v[154:155], v166 offset:45056
    v_mfma_f32_16x16x32_bf16 a[20:23], v[132:135], a[244:247], a[20:23]
    v_mfma_f32_16x16x32_bf16 a[16:19], v[132:135], a[240:243], a[16:19]
    ds_read_b64_tr_b16 v[156:157], v167 offset:40960
    s_waitcnt lgkmcnt(9)
    v_mfma_f32_16x16x32_bf16 a[32:35], v[136:139], a[240:243], a[32:35]
    v_mfma_f32_16x16x32_bf16 a[36:39], v[136:139], a[244:247], a[36:39]
    ds_read_b64_tr_b16 v[158:159], v167 offset:45056
    v_mfma_f32_16x16x32_bf16 a[40:43], v[136:139], a[248:251], a[40:43]
    v_mfma_f32_16x16x32_bf16 a[44:47], v[136:139], a[252:255], a[44:47]
    s_waitcnt lgkmcnt(8)
    v_mfma_f32_16x16x32_bf16 a[60:63], v[140:143], a[252:255], a[60:63]
    v_mfma_f32_16x16x32_bf16 a[56:59], v[140:143], a[248:251], a[56:59]
    v_mfma_f32_16x16x32_bf16 a[52:55], v[140:143], a[244:247], a[52:55]
    v_mfma_f32_16x16x32_bf16 a[48:51], v[140:143], a[240:243], a[48:51]
    s_waitcnt lgkmcnt(6)
    v_mfma_f32_16x16x32_bf16 a[64:67], v[144:147], a[240:243], a[64:67]
    v_mfma_f32_16x16x32_bf16 a[68:71], v[144:147], a[244:247], a[68:71]
    v_mfma_f32_16x16x32_bf16 a[72:75], v[144:147], a[248:251], a[72:75]
    v_mfma_f32_16x16x32_bf16 a[76:79], v[144:147], a[252:255], a[76:79]
    s_waitcnt vmcnt(25) lgkmcnt(0)
    s_barrier
    ds_read_b64_tr_b16 v[128:129], v160 offset:49152
    v_mfma_f32_16x16x32_bf16 a[92:95], v[148:151], a[252:255], a[92:95]
    ds_read_b64_tr_b16 v[130:131], v160 offset:53248
    s_add_u32 m0, s3, 0x8000
    s_lshl_b32 s76, s100, 9
    s_add_u32 s76, s76, 0
    v_mfma_f32_16x16x32_bf16 a[88:91], v[148:151], a[248:251], a[88:91]
    ds_read_b64_tr_b16 v[132:133], v161 offset:49152
    buffer_load_dwordx4 v170, s[12:15], s76 offen offset:0 lds
    v_mfma_f32_16x16x32_bf16 a[84:87], v[148:151], a[244:247], a[84:87]
    ds_read_b64_tr_b16 v[134:135], v161 offset:53248
    v_mfma_f32_16x16x32_bf16 a[80:83], v[148:151], a[240:243], a[80:83]
    ds_read_b64_tr_b16 v[136:137], v162 offset:49152
    buffer_load_dwordx4 v171, s[12:15], s76 offen offset:1024 lds
    v_mfma_f32_16x16x32_bf16 a[96:99], v[152:155], a[240:243], a[96:99]
    ds_read_b64_tr_b16 v[138:139], v162 offset:53248
    v_mfma_f32_16x16x32_bf16 a[100:103], v[152:155], a[244:247], a[100:103]
    ds_read_b64_tr_b16 v[140:141], v163 offset:49152
    buffer_load_dwordx4 v172, s[12:15], s76 offen offset:2048 lds
    v_mfma_f32_16x16x32_bf16 a[104:107], v[152:155], a[248:251], a[104:107]
    ds_read_b64_tr_b16 v[142:143], v163 offset:53248
    v_mfma_f32_16x16x32_bf16 a[108:111], v[152:155], a[252:255], a[108:111]
    ds_read_b64_tr_b16 v[144:145], v164 offset:49152
    buffer_load_dwordx4 v173, s[12:15], s76 offen offset:3072 lds
    v_mfma_f32_16x16x32_bf16 a[124:127], v[156:159], a[252:255], a[124:127]
    ds_read_b64_tr_b16 v[146:147], v164 offset:53248
    v_mfma_f32_16x16x32_bf16 a[120:123], v[156:159], a[248:251], a[120:123]
    v_mfma_f32_16x16x32_bf16 a[116:119], v[156:159], a[244:247], a[116:119]
    v_mfma_f32_16x16x32_bf16 a[112:115], v[156:159], a[240:243], a[112:115]
    ds_read_b64_tr_b16 v[148:149], v165 offset:49152
    s_waitcnt lgkmcnt(9)
    v_mfma_f32_16x16x32_bf16 a[0:3], v[128:131], a[128:131], a[0:3]
    s_waitcnt vmcnt(7)
    v_cmp_eq_u32 vcc, 1, v174
    s_cmp_eq_u64 vcc, -1
    s_cbranch_scc0 chk_7_slow
chk_7_ok:
    s_mul_i32 s77, s100, 0xffff4000
    s_add_u32 s77, s77, s33
    s_add_u32 s77, s77, 0x70000
    buffer_load_dwordx4 a[224:227], v179, s[16:19], s77 offen offset:0 sc1
    v_mfma_f32_16x16x32_bf16 a[4:7], v[128:131], a[132:135], a[4:7]
    ds_read_b64_tr_b16 v[150:151], v165 offset:53248
    v_mfma_f32_16x16x32_bf16 a[8:11], v[128:131], a[136:139], a[8:11]
    v_mfma_f32_16x16x32_bf16 a[12:15], v[128:131], a[140:143], a[12:15]
    ds_read_b64_tr_b16 v[152:153], v166 offset:49152
    s_waitcnt lgkmcnt(9)
    v_mfma_f32_16x16x32_bf16 a[28:31], v[132:135], a[140:143], a[28:31]
    buffer_load_dwordx4 a[228:231], v179, s[16:19], s77 offen offset:1024 sc1
    v_mfma_f32_16x16x32_bf16 a[24:27], v[132:135], a[136:139], a[24:27]
    ds_read_b64_tr_b16 v[154:155], v166 offset:53248
    v_mfma_f32_16x16x32_bf16 a[20:23], v[132:135], a[132:135], a[20:23]
    v_mfma_f32_16x16x32_bf16 a[16:19], v[132:135], a[128:131], a[16:19]
    ds_read_b64_tr_b16 v[156:157], v167 offset:49152
    s_waitcnt lgkmcnt(9)
    v_mfma_f32_16x16x32_bf16 a[32:35], v[136:139], a[128:131], a[32:35]
    buffer_load_dwordx4 a[232:235], v179, s[16:19], s77 offen offset:2048 sc1
    v_mfma_f32_16x16x32_bf16 a[36:39], v[136:139], a[132:135], a[36:39]
    ds_read_b64_tr_b16 v[158:159], v167 offset:53248
    v_mfma_f32_16x16x32_bf16 a[40:43], v[136:139], a[136:139], a[40:43]
    v_mfma_f32_16x16x32_bf16 a[44:47], v[136:139], a[140:143], a[44:47]
    ds_read_b64_tr_b16 v[128:129], v160 offset:57344
    s_waitcnt lgkmcnt(9)
    v_mfma_f32_16x16x32_bf16 a[60:63], v[140:143], a[140:143], a[60:63]
    buffer_load_dwordx4 a[236:239], v179, s[16:19], s77 offen offset:3072 sc1
    v_mfma_f32_16x16x32_bf16 a[56:59], v[140:143], a[136:139], a[56:59]
    ds_read_b64_tr_b16 v[130:131], v160 offset:61440
    v_mfma_f32_16x16x32_bf16 a[52:55], v[140:143], a[132:135], a[52:55]
    v_mfma_f32_16x16x32_bf16 a[48:51], v[140:143], a[128:131], a[48:51]
    ds_read_b64_tr_b16 v[132:133], v161 offset:57344
    s_waitcnt lgkmcnt(9)
    v_mfma_f32_16x16x32_bf16 a[64:67], v[144:147], a[128:131], a[64:67]
    s_mul_i32 s77, s100, 0xffff4000
    s_add_u32 s77, s77, s33
    s_add_u32 s77, s77, 0x71000
    buffer_load_dwordx4 a[240:243], v179, s[16:19], s77 offen offset:0 sc1
    v_mfma_f32_16x16x32_bf16 a[68:71], v[144:147], a[132:135], a[68:71]
    ds_read_b64_tr_b16 v[134:135], v161 offset:61440
    v_mfma_f32_16x16x32_bf16 a[72:75], v[144:147], a[136:139], a[72:75]
    v_mfma_f32_16x16x32_bf16 a[76:79], v[144:147], a[140:143], a[76:79]
    ds_read_b64_tr_b16 v[136:137], v162 offset:57344
    s_waitcnt lgkmcnt(9)
    v_mfma_f32_16x16x32_bf16 a[92:95], v[148:151], a[140:143], a[92:95]
    buffer_load_dwordx4 a[244:247], v179, s[16:19], s77 offen offset:1024 sc1
    v_mfma_f32_16x16x32_bf16 a[88:91], v[148:151], a[136:139], a[88:91]
    ds_read_b64_tr_b16 v[138:139], v162 offset:61440
    v_mfma_f32_16x16x32_bf16 a[84:87], v[148:151], a[132:135], a[84:87]
    v_mfma_f32_16x16x32_bf16 a[80:83], v[148:151], a[128:131], a[80:83]
    ds_read_b64_tr_b16 v[140:141], v163 offset:57344
    s_waitcnt lgkmcnt(9)
    v_mfma_f32_16x16x32_bf16 a[96:99], v[152:155], a[128:131], a[96:99]
    buffer_load_dwordx4 a[248:251], v179, s[16:19], s77 offen offset:2048 sc1
    v_mfma_f32_16x16x32_bf16 a[100:103], v[152:155], a[132:135], a[100:103]
    ds_read_b64_tr_b16 v[142:143], v163 offset:61440
    v_mfma_f32_16x16x32_bf16 a[104:107], v[152:155], a[136:139], a[104:107]
    v_mfma_f32_16x16x32_bf16 a[108:111], v[152:155], a[140:143], a[108:111]
    ds_read_b64_tr_b16 v[144:145], v164 offset:57344
    s_waitcnt lgkmcnt(9)
    v_mfma_f32_16x16x32_bf16 a[124:127], v[156:159], a[140:143], a[124:127]
    buffer_load_dwordx4 a[252:255], v179, s[16:19], s77 offen offset:3072 sc1
    v_mfma_f32_16x16x32_bf16 a[120:123], v[156:159], a[136:139], a[120:123]
    ds_read_b64_tr_b16 v[146:147], v164 offset:61440
    v_mfma_f32_16x16x32_bf16 a[116:119], v[156:159], a[132:135], a[116:119]
    v_mfma_f32_16x16x32_bf16 a[112:115], v[156:159], a[128:131], a[112:115]
    ds_read_b64_tr_b16 v[148:149], v165 offset:57344
    s_waitcnt lgkmcnt(9)
    v_mfma_f32_16x16x32_bf16 a[0:3], v[128:131], a[144:147], a[0:3]
    v_mfma_f32_16x16x32_bf16 a[4:7], v[128:131], a[148:151], a[4:7]
    ds_read_b64_tr_b16 v[150:151], v165 offset:61440
    v_mfma_f32_16x16x32_bf16 a[8:11], v[128:131], a[152:155], a[8:11]
    v_mfma_f32_16x16x32_bf16 a[12:15], v[128:131], a[156:159], a[12:15]
    ds_read_b64_tr_b16 v[152:153], v166 offset:57344
    s_waitcnt lgkmcnt(9)
    v_mfma_f32_16x16x32_bf16 a[28:31], v[132:135], a[156:159], a[28:31]
    v_mfma_f32_16x16x32_bf16 a[24:27], v[132:135], a[152:155], a[24:27]
    ds_read_b64_tr_b16 v[154:155], v166 offset:61440
    v_mfma_f32_16x16x32_bf16 a[20:23], v[132:135], a[148:151], a[20:23]
    v_mfma_f32_16x16x32_bf16 a[16:19], v[132:135], a[144:147], a[16:19]
    ds_read_b64_tr_b16 v[156:157], v167 offset:57344
    s_waitcnt lgkmcnt(9)
    v_mfma_f32_16x16x32_bf16 a[32:35], v[136:139], a[144:147], a[32:35]
    v_mfma_f32_16x16x32_bf16 a[36:39], v[136:139], a[148:151], a[36:39]
    ds_read_b64_tr_b16 v[158:159], v167 offset:61440
    v_mfma_f32_16x16x32_bf16 a[40:43], v[136:139], a[152:155], a[40:43]
    v_mfma_f32_16x16x32_bf16 a[44:47], v[136:139], a[156:159], a[44:47]
    s_waitcnt lgkmcnt(8)
    v_mfma_f32_16x16x32_bf16 a[60:63], v[140:143], a[156:159], a[60:63]
    v_mfma_f32_16x16x32_bf16 a[56:59], v[140:143], a[152:155], a[56:59]
    v_mfma_f32_16x16x32_bf16 a[52:55], v[140:143], a[148:151], a[52:55]
    v_mfma_f32_16x16x32_bf16 a[48:51], v[140:143], a[144:147], a[48:51]
    s_waitcnt lgkmcnt(6)
    v_mfma_f32_16x16x32_bf16 a[64:67], v[144:147], a[144:147], a[64:67]
    v_mfma_f32_16x16x32_bf16 a[68:71], v[144:147], a[148:151], a[68:71]
    v_mfma_f32_16x16x32_bf16 a[72:75], v[144:147], a[152:155], a[72:75]
    v_mfma_f32_16x16x32_bf16 a[76:79], v[144:147], a[156:159], a[76:79]
    s_waitcnt vmcnt(25) lgkmcnt(0)
    s_barrier
    ds_read_b64_tr_b16 v[128:129], v160 offset:0
    v_mfma_f32_16x16x32_bf16 a[92:95], v[148:151], a[156:159], a[92:95]
    ds_read_b64_tr_b16 v[130:131], v160 offset:4096
    s_add_u32 m0, s3, 0xc000
    s_lshl_b32 s76, s100, 9
    s_add_u32 s76, s76, 0
    v_mfma_f32_16x16x32_bf16 a[88:91], v[148:151], a[152:155], a[88:91]
    ds_read_b64_tr_b16 v[132:133], v161 offset:0
    buffer_load_dwordx4 v170, s[24:27], s76 offen offset:0 lds
    v_mfma_f32_16x16x32_bf16 a[84:87], v[148:151], a[148:151], a[84:87]
    ds_read_b64_tr_b16 v[134:135], v161 offset:4096
    v_mfma_f32_16x16x32_bf16 a[80:83], v[148:151], a[144:147], a[80:83]
    ds_read_b64_tr_b16 v[136:137], v162 offset:0
    buffer_load_dwordx4 v171, s[24:27], s76 offen offset:1024 lds
    v_mfma_f32_16x16x32_bf16 a[96:99], v[152:155], a[144:147], a[96:99]
    ds_read_b64_tr_b16 v[138:139], v162 offset:4096
    v_mfma_f32_16x16x32_bf16 a[100:103], v[152:155], a[148:151], a[100:103]
    ds_read_b64_tr_b16 v[140:141], v163 offset:0
    buffer_load_dwordx4 v172, s[24:27], s76 offen offset:2048 lds
    v_mfma_f32_16x16x32_bf16 a[104:107], v[152:155], a[152:155], a[104:107]
    ds_read_b64_tr_b16 v[142:143], v163 offset:4096
    v_mfma_f32_16x16x32_bf16 a[108:111], v[152:155], a[156:159], a[108:111]
    ds_read_b64_tr_b16 v[144:145], v164 offset:0
    buffer_load_dwordx4 v173, s[24:27], s76 offen offset:3072 lds
    v_mfma_f32_16x16x32_bf16 a[124:127], v[156:159], a[156:159], a[124:127]
    ds_read_b64_tr_b16 v[146:147], v164 offset:4096
    v_mfma_f32_16x16x32_bf16 a[120:123], v[156:159], a[152:155], a[120:123]
    v_mfma_f32_16x16x32_bf16 a[116:119], v[156:159], a[148:151], a[116:119]
    v_mfma_f32_16x16x32_bf16 a[112:115], v[156:159], a[144:147], a[112:115]
    ds_read_b64_tr_b16 v[148:149], v165 offset:0
    s_waitcnt lgkmcnt(9)
    v_mfma_f32_16x16x32_bf16 a[0:3], v[128:131], a[160:163], a[0:3]
    s_mul_i32 s77, s100, 0xffff4000
    s_add_u32 s77, s77, s33
    s_add_u32 s77, s77, 0x72000
    buffer_load_dwordx4 a[128:131], v179, s[16:19], s77 offen offset:0 sc1
    v_mfma_f32_16x16x32_bf16 a[4:7], v[128:131], a[164:167], a[4:7]
    ds_read_b64_tr_b16 v[150:151], v165 offset:4096
    v_mfma_f32_16x16x32_bf16 a[8:11], v[128:131], a[168:171], a[8:11]
    v_mfma_f32_16x16x32_bf16 a[12:15], v[128:131], a[172:175], a[12:15]
    ds_read_b64_tr_b16 v[152:153], v166 offset:0
    s_waitcnt lgkmcnt(9)
    v_mfma_f32_16x16x32_bf16 a[28:31], v[132:135], a[172:175], a[28:31]
    buffer_load_dwordx4 a[132:135], v179, s[16:19], s77 offen offset:1024 sc1
    v_mfma_f32_16x16x32_bf16 a[24:27], v[132:135], a[168:171], a[24:27]
    ds_read_b64_tr_b16 v[154:155], v166 offset:4096
    v_mfma_f32_16x16x32_bf16 a[20:23], v[132:135], a[164:167], a[20:23]
    v_mfma_f32_16x16x32_bf16 a[16:19], v[132:135], a[160:163], a[16:19]
    ds_read_b64_tr_b16 v[156:157], v167 offset:0
    s_waitcnt lgkmcnt(9)
    v_mfma_f32_16x16x32_bf16 a[32:35], v[136:139], a[160:163], a[32:35]
    buffer_load_dwordx4 a[136:139], v179, s[16:19], s77 offen offset:2048 sc1
    v_mfma_f32_16x16x32_bf16 a[36:39], v[136:139], a[164:167], a[36:39]
    ds_read_b64_tr_b16 v[158:159], v167 offset:4096
    v_mfma_f32_16x16x32_bf16 a[40:43], v[136:139], a[168:171], a[40:43]
    v_mfma_f32_16x16x32_bf16 a[44:47], v[136:139], a[172:175], a[44:47]
    ds_read_b64_tr_b16 v[128:129], v160 offset:8192
    s_waitcnt lgkmcnt(9)
    v_mfma_f32_16x16x32_bf16 a[60:63], v[140:143], a[172:175], a[60:63]
    buffer_load_dwordx4 a[140:143], v179, s[16:19], s77 offen offset:3072 sc1
    v_mfma_f32_16x16x32_bf16 a[56:59], v[140:143], a[168:171], a[56:59]
    ds_read_b64_tr_b16 v[130:131], v160 offset:12288
    v_mfma_f32_16x16x32_bf16 a[52:55], v[140:143], a[164:167], a[52:55]
    v_mfma_f32_16x16x32_bf16 a[48:51], v[140:143], a[160:163], a[48:51]
    ds_read_b64_tr_b16 v[132:133], v161 offset:8192
    s_waitcnt lgkmcnt(9)
    v_mfma_f32_16x16x32_bf16 a[64:67], v[144:147], a[160:163], a[64:67]
    s_mul_i32 s77, s100, 0xffff4000
    s_add_u32 s77, s77, s33
    s_add_u32 s77, s77, 0x73000
    buffer_load_dwordx4 a[144:147], v179, s[16:19], s77 offen offset:0 sc1
    v_mfma_f32_16x16x32_bf16 a[68:71], v[144:147], a[164:167], a[68:71]
    ds_read_b64_tr_b16 v[134:135], v161 offset:12288
    v_mfma_f32_16x16x32_bf16 a[72:75], v[144:147], a[168:171], a[72:75]
    v_mfma_f32_16x16x32_bf16 a[76:79], v[144:147], a[172:175], a[76:79]
    ds_read_b64_tr_b16 v[136:137], v162 offset:8192
    s_waitcnt lgkmcnt(9)
    v_mfma_f32_16x16x32_bf16 a[92:95], v[148:151], a[172:175], a[92:95]
    buffer_load_dwordx4 a[148:151], v179, s[16:19], s77 offen offset:1024 sc1
    v_mfma_f32_16x16x32_bf16 a[88:91], v[148:151], a[168:171], a[88:91]
    ds_read_b64_tr_b16 v[138:139], v162 offset:12288
    v_mfma_f32_16x16x32_bf16 a[84:87], v[148:151], a[164:167], a[84:87]
    v_mfma_f32_16x16x32_bf16 a[80:83], v[148:151], a[160:163], a[80:83]
    ds_read_b64_tr_b16 v[140:141], v163 offset:8192
    s_waitcnt lgkmcnt(9)
    v_mfma_f32_16x16x32_bf16 a[96:99], v[152:155], a[160:163], a[96:99]
    buffer_load_dwordx4 a[152:155], v179, s[16:19], s77 offen offset:2048 sc1
    v_mfma_f32_16x16x32_bf16 a[100:103], v[152:155], a[164:167], a[100:103]
    ds_read_b64_tr_b16 v[142:143], v163 offset:12288
    v_mfma_f32_16x16x32_bf16 a[104:107], v[152:155], a[168:171], a[104:107]
    v_mfma_f32_16x16x32_bf16 a[108:111], v[152:155], a[172:175], a[108:111]
    ds_read_b64_tr_b16 v[144:145], v164 offset:8192
    s_waitcnt lgkmcnt(9)
    v_mfma_f32_16x16x32_bf16 a[124:127], v[156:159], a[172:175], a[124:127]
    buffer_load_dwordx4 a[156:159], v179, s[16:19], s77 offen offset:3072 sc1
    v_mfma_f32_16x16x32_bf16 a[120:123], v[156:159], a[168:171], a[120:123]
    ds_read_b64_tr_b16 v[146:147], v164 offset:12288
    v_mfma_f32_16x16x32_bf16 a[116:119], v[156:159], a[164:167], a[116:119]
    v_mfma_f32_16x16x32_bf16 a[112:115], v[156:159], a[160:163], a[112:115]
    ds_read_b64_tr_b16 v[148:149], v165 offset:8192
    s_waitcnt lgkmcnt(9)
    v_mfma_f32_16x16x32_bf16 a[0:3], v[128:131], a[176:179], a[0:3]
    v_mfma_f32_16x16x32_bf16 a[4:7], v[128:131], a[180:183], a[4:7]
    ds_read_b64_tr_b16 v[150:151], v165 offset:12288
    v_mfma_f32_16x16x32_bf16 a[8:11], v[128:131], a[184:187], a[8:11]
    v_mfma_f32_16x16x32_bf16 a[12:15], v[128:131], a[188:191], a[12:15]
    ds_read_b64_tr_b16 v[152:153], v166 offset:8192
    s_waitcnt lgkmcnt(9)
    v_mfma_f32_16x16x32_bf16 a[28:31], v[132:135], a[188:191], a[28:31]
    v_mfma_f32_16x16x32_bf16 a[24:27], v[132:135], a[184:187], a[24:27]
    ds_read_b64_tr_b16 v[154:155], v166 offset:12288
    v_mfma_f32_16x16x32_bf16 a[20:23], v[132:135], a[180:183], a[20:23]
    v_mfma_f32_16x16x32_bf16 a[16:19], v[132:135], a[176:179], a[16:19]
    ds_read_b64_tr_b16 v[156:157], v167 offset:8192
    s_waitcnt lgkmcnt(9)
    v_mfma_f32_16x16x32_bf16 a[32:35], v[136:139], a[176:179], a[32:35]
    v_mfma_f32_16x16x32_bf16 a[36:39], v[136:139], a[180:183], a[36:39]
    ds_read_b64_tr_b16 v[158:159], v167 offset:12288
    v_mfma_f32_16x16x32_bf16 a[40:43], v[136:139], a[184:187], a[40:43]
    v_mfma_f32_16x16x32_bf16 a[44:47], v[136:139], a[188:191], a[44:47]
    s_waitcnt lgkmcnt(8)
    v_mfma_f32_16x16x32_bf16 a[60:63], v[140:143], a[188:191], a[60:63]
    v_mfma_f32_16x16x32_bf16 a[56:59], v[140:143], a[184:187], a[56:59]
    v_mfma_f32_16x16x32_bf16 a[52:55], v[140:143], a[180:183], a[52:55]
    v_mfma_f32_16x16x32_bf16 a[48:51], v[140:143], a[176:179], a[48:51]
    s_waitcnt lgkmcnt(6)
    v_mfma_f32_16x16x32_bf16 a[64:67], v[144:147], a[176:179], a[64:67]
    v_mfma_f32_16x16x32_bf16 a[68:71], v[144:147], a[180:183], a[68:71]
    v_mfma_f32_16x16x32_bf16 a[72:75], v[144:147], a[184:187], a[72:75]
    v_mfma_f32_16x16x32_bf16 a[76:79], v[144:147], a[188:191], a[76:79]
    s_waitcnt vmcnt(24) lgkmcnt(0)
    s_barrier
    ds_read_b64_tr_b16 v[128:129], v160 offset:16384
    v_mfma_f32_16x16x32_bf16 a[92:95], v[148:151], a[188:191], a[92:95]
    ds_read_b64_tr_b16 v[130:131], v160 offset:20480
    s_add_u32 m0, s3, 0x0
    s_lshl_b32 s76, s100, 9
    s_add_u32 s76, s76, 128
    v_mfma_f32_16x16x32_bf16 a[88:91], v[148:151], a[184:187], a[88:91]
    ds_read_b64_tr_b16 v[132:133], v161 offset:16384
    buffer_load_dwordx4 v170, s[12:15], s76 offen offset:0 lds
    v_mfma_f32_16x16x32_bf16 a[84:87], v[148:151], a[180:183], a[84:87]
    ds_read_b64_tr_b16 v[134:135], v161 offset:20480
    v_mfma_f32_16x16x32_bf16 a[80:83], v[148:151], a[176:179], a[80:83]
    ds_read_b64_tr_b16 v[136:137], v162 offset:16384
    buffer_load_dwordx4 v171, s[12:15], s76 offen offset:1024 lds
    v_mfma_f32_16x16x32_bf16 a[96:99], v[152:155], a[176:179], a[96:99]
    ds_read_b64_tr_b16 v[138:139], v162 offset:20480
    v_mfma_f32_16x16x32_bf16 a[100:103], v[152:155], a[180:183], a[100:103]
    ds_read_b64_tr_b16 v[140:141], v163 offset:16384
    buffer_load_dwordx4 v172, s[12:15], s76 offen offset:2048 lds
    v_mfma_f32_16x16x32_bf16 a[104:107], v[152:155], a[184:187], a[104:107]
    ds_read_b64_tr_b16 v[142:143], v163 offset:20480
    v_mfma_f32_16x16x32_bf16 a[108:111], v[152:155], a[188:191], a[108:111]
    ds_read_b64_tr_b16 v[144:145], v164 offset:16384
    buffer_load_dwordx4 v173, s[12:15], s76 offen offset:3072 lds
    v_mfma_f32_16x16x32_bf16 a[124:127], v[156:159], a[188:191], a[124:127]
    ds_read_b64_tr_b16 v[146:147], v164 offset:20480
    v_mfma_f32_16x16x32_bf16 a[120:123], v[156:159], a[184:187], a[120:123]
    v_mfma_f32_16x16x32_bf16 a[116:119], v[156:159], a[180:183], a[116:119]
    v_mfma_f32_16x16x32_bf16 a[112:115], v[156:159], a[176:179], a[112:115]
    ds_read_b64_tr_b16 v[148:149], v165 offset:16384
    s_waitcnt lgkmcnt(9)
    v_mfma_f32_16x16x32_bf16 a[0:3], v[128:131], a[192:195], a[0:3]
    s_mul_i32 s77, s100, 0xffff4000
    s_add_u32 s77, s77, s33
    s_add_u32 s77, s77, 0x74000
    buffer_load_dwordx4 a[160:163], v179, s[16:19], s77 offen offset:0 sc1
    v_mfma_f32_16x16x32_bf16 a[4:7], v[128:131], a[196:199], a[4:7]
    ds_read_b64_tr_b16 v[150:151], v165 offset:20480
    v_mfma_f32_16x16x32_bf16 a[8:11], v[128:131], a[200:203], a[8:11]
    v_mfma_f32_16x16x32_bf16 a[12:15], v[128:131], a[204:207], a[12:15]
    ds_read_b64_tr_b16 v[152:153], v166 offset:16384
    s_waitcnt lgkmcnt(9)
    v_mfma_f32_16x16x32_bf16 a[28:31], v[132:135], a[204:207], a[28:31]
    buffer_load_dwordx4 a[164:167], v179, s[16:19], s77 offen offset:1024 sc1
    v_mfma_f32_16x16x32_bf16 a[24:27], v[132:135], a[200:203], a[24:27]
    ds_read_b64_tr_b16 v[154:155], v166 offset:20480
    v_mfma_f32_16x16x32_bf16 a[20:23], v[132:135], a[196:199], a[20:23]
    v_mfma_f32_16x16x32_bf16 a[16:19], v[132:135], a[192:195], a[16:19]
    ds_read_b64_tr_b16 v[156:157], v167 offset:16384
    s_waitcnt lgkmcnt(9)
    v_mfma_f32_16x16x32_bf16 a[32:35], v[136:139], a[192:195], a[32:35]
    buffer_load_dwordx4 a[168:171], v179, s[16:19], s77 offen offset:2048 sc1
    v_mfma_f32_16x16x32_bf16 a[36:39], v[136:139], a[196:199], a[36:39]
    ds_read_b64_tr_b16 v[158:159], v167 offset:20480
    v_mfma_f32_16x16x32_bf16 a[40:43], v[136:139], a[200:203], a[40:43]
    v_mfma_f32_16x16x32_bf16 a[44:47], v[136:139], a[204:207], a[44:47]
    ds_read_b64_tr_b16 v[128:129], v160 offset:24576
    s_waitcnt lgkmcnt(9)
    v_mfma_f32_16x16x32_bf16 a[60:63], v[140:143], a[204:207], a[60:63]
    buffer_load_dwordx4 a[172:175], v179, s[16:19], s77 offen offset:3072 sc1
    v_mfma_f32_16x16x32_bf16 a[56:59], v[140:143], a[200:203], a[56:59]
    ds_read_b64_tr_b16 v[130:131], v160 offset:28672
    v_mfma_f32_16x16x32_bf16 a[52:55], v[140:143], a[196:199], a[52:55]
    v_mfma_f32_16x16x32_bf16 a[48:51], v[140:143], a[192:195], a[48:51]
    ds_read_b64_tr_b16 v[132:133], v161 offset:24576
    s_waitcnt lgkmcnt(9)
    v_mfma_f32_16x16x32_bf16 a[64:67], v[144:147], a[192:195], a[64:67]
    s_mul_i32 s77, s100, 0xffff4000
    s_add_u32 s77, s77, s33
    s_add_u32 s77, s77, 0x75000
    buffer_load_dwordx4 a[176:179], v179, s[16:19], s77 offen offset:0 sc1
    v_mfma_f32_16x16x32_bf16 a[68:71], v[144:147], a[196:199], a[68:71]
    ds_read_b64_tr_b16 v[134:135], v161 offset:28672
    v_mfma_f32_16x16x32_bf16 a[72:75], v[144:147], a[200:203], a[72:75]
    v_mfma_f32_16x16x32_bf16 a[76:79], v[144:147], a[204:207], a[76:79]
    ds_read_b64_tr_b16 v[136:137], v162 offset:24576
    s_waitcnt lgkmcnt(9)
    v_mfma_f32_16x16x32_bf16 a[92:95], v[148:151], a[204:207], a[92:95]
    buffer_load_dwordx4 a[180:183], v179, s[16:19], s77 offen offset:1024 sc1
    v_mfma_f32_16x16x32_bf16 a[88:91], v[148:151], a[200:203], a[88:91]
    ds_read_b64_tr_b16 v[138:139], v162 offset:28672
    v_mfma_f32_16x16x32_bf16 a[84:87], v[148:151], a[196:199], a[84:87]
    v_mfma_f32_16x16x32_bf16 a[80:83], v[148:151], a[192:195], a[80:83]
    ds_read_b64_tr_b16 v[140:141], v163 offset:24576
    s_waitcnt lgkmcnt(9)
    v_mfma_f32_16x16x32_bf16 a[96:99], v[152:155], a[192:195], a[96:99]
    buffer_load_dwordx4 a[184:187], v179, s[16:19], s77 offen offset:2048 sc1
    v_mfma_f32_16x16x32_bf16 a[100:103], v[152:155], a[196:199], a[100:103]
    ds_read_b64_tr_b16 v[142:143], v163 offset:28672
    v_mfma_f32_16x16x32_bf16 a[104:107], v[152:155], a[200:203], a[104:107]
    v_mfma_f32_16x16x32_bf16 a[108:111], v[152:155], a[204:207], a[108:111]
    ds_read_b64_tr_b16 v[144:145], v164 offset:24576
    s_waitcnt lgkmcnt(9)
    v_mfma_f32_16x16x32_bf16 a[124:127], v[156:159], a[204:207], a[124:127]
    buffer_load_dwordx4 a[188:191], v179, s[16:19], s77 offen offset:3072 sc1
    v_mfma_f32_16x16x32_bf16 a[120:123], v[156:159], a[200:203], a[120:123]
    ds_read_b64_tr_b16 v[146:147], v164 offset:28672
    v_mfma_f32_16x16x32_bf16 a[116:119], v[156:159], a[196:199], a[116:119]
    v_mfma_f32_16x16x32_bf16 a[112:115], v[156:159], a[192:195], a[112:115]
    ds_read_b64_tr_b16 v[148:149], v165 offset:24576
    s_waitcnt lgkmcnt(9)
    v_mfma_f32_16x16x32_bf16 a[0:3], v[128:131], a[208:211], a[0:3]
    v_mfma_f32_16x16x32_bf16 a[4:7], v[128:131], a[212:215], a[4:7]
    ds_read_b64_tr_b16 v[150:151], v165 offset:28672
    v_mfma_f32_16x16x32_bf16 a[8:11], v[128:131], a[216:219], a[8:11]
    v_mfma_f32_16x16x32_bf16 a[12:15], v[128:131], a[220:223], a[12:15]
    ds_read_b64_tr_b16 v[152:153], v166 offset:24576
    s_waitcnt lgkmcnt(9)
    v_mfma_f32_16x16x32_bf16 a[28:31], v[132:135], a[220:223], a[28:31]
    v_mfma_f32_16x16x32_bf16 a[24:27], v[132:135], a[216:219], a[24:27]
    ds_read_b64_tr_b16 v[154:155], v166 offset:28672
    v_mfma_f32_16x16x32_bf16 a[20:23], v[132:135], a[212:215], a[20:23]
    v_mfma_f32_16x16x32_bf16 a[16:19], v[132:135], a[208:211], a[16:19]
    ds_read_b64_tr_b16 v[156:157], v167 offset:24576
    s_waitcnt lgkmcnt(9)
    v_mfma_f32_16x16x32_bf16 a[32:35], v[136:139], a[208:211], a[32:35]
    v_mfma_f32_16x16x32_bf16 a[36:39], v[136:139], a[212:215], a[36:39]
    ds_read_b64_tr_b16 v[158:159], v167 offset:28672
    v_mfma_f32_16x16x32_bf16 a[40:43], v[136:139], a[216:219], a[40:43]
    v_mfma_f32_16x16x32_bf16 a[44:47], v[136:139], a[220:223], a[44:47]
    s_waitcnt lgkmcnt(8)
    v_mfma_f32_16x16x32_bf16 a[60:63], v[140:143], a[220:223], a[60:63]
    v_mfma_f32_16x16x32_bf16 a[56:59], v[140:143], a[216:219], a[56:59]
    v_mfma_f32_16x16x32_bf16 a[52:55], v[140:143], a[212:215], a[52:55]
    v_mfma_f32_16x16x32_bf16 a[48:51], v[140:143], a[208:211], a[48:51]
    s_waitcnt lgkmcnt(6)
    v_mfma_f32_16x16x32_bf16 a[64:67], v[144:147], a[208:211], a[64:67]
    v_mfma_f32_16x16x32_bf16 a[68:71], v[144:147], a[212:215], a[68:71]
    v_mfma_f32_16x16x32_bf16 a[72:75], v[144:147], a[216:219], a[72:75]
    v_mfma_f32_16x16x32_bf16 a[76:79], v[144:147], a[220:223], a[76:79]
    s_waitcnt vmcnt(24) lgkmcnt(0)
    s_barrier
    ds_read_b128 v[128:131], v168 offset:32768
    v_mfma_f32_16x16x32_bf16 a[92:95], v[148:151], a[220:223], a[92:95]
    ds_read_b128 v[132:135], v168 offset:34816
    s_add_u32 m0, s3, 0x4000
    s_lshl_b32 s76, s100, 9
    s_add_u32 s76, s76, 128
    v_mfma_f32_16x16x32_bf16 a[88:91], v[148:151], a[216:219], a[88:91]
    ds_read_b128 v[136:139], v168 offset:36864
    buffer_load_dwordx4 v170, s[24:27], s76 offen offset:0 lds
    v_mfma_f32_16x16x32_bf16 a[84:87], v[148:151], a[212:215], a[84:87]
    ds_read_b128 v[140:143], v168 offset:38912
    v_mfma_f32_16x16x32_bf16 a[80:83], v[148:151], a[208:211], a[80:83]
    ds_read_b128 v[144:147], v168 offset:40960
    buffer_load_dwordx4 v171, s[24:27], s76 offen offset:1024 lds
    v_mfma_f32_16x16x32_bf16 a[96:99], v[152:155], a[208:211], a[96:99]
    v_mfma_f32_16x16x32_bf16 a[100:103], v[152:155], a[212:215], a[100:103]
    buffer_load_dwordx4 v172, s[24:27], s76 offen offset:2048 lds
    v_mfma_f32_16x16x32_bf16 a[104:107], v[152:155], a[216:219], a[104:107]
    v_mfma_f32_16x16x32_bf16 a[108:111], v[152:155], a[220:223], a[108:111]
    buffer_load_dwordx4 v173, s[24:27], s76 offen offset:3072 lds
    v_mfma_f32_16x16x32_bf16 a[124:127], v[156:159], a[220:223], a[124:127]
    v_mfma_f32_16x16x32_bf16 a[120:123], v[156:159], a[216:219], a[120:123]
    v_mfma_f32_16x16x32_bf16 a[116:119], v[156:159], a[212:215], a[116:119]
    v_mfma_f32_16x16x32_bf16 a[112:115], v[156:159], a[208:211], a[112:115]
    ds_read_b128 v[148:151], v168 offset:43008
    s_waitcnt lgkmcnt(5)
    v_mfma_f32_16x16x32_bf16 v[0:3], v[128:131], a[224:227], v[0:3]
    s_mul_i32 s77, s100, 0xffff4000
    s_add_u32 s77, s77, s33
    s_add_u32 s77, s77, 0x76000
    buffer_load_dwordx4 a[192:195], v179, s[16:19], s77 offen offset:0 sc1
    v_mfma_f32_16x16x32_bf16 v[4:7], v[128:131], a[228:231], v[4:7]
    v_mfma_f32_16x16x32_bf16 v[8:11], v[128:131], a[232:235], v[8:11]
    v_mfma_f32_16x16x32_bf16 v[12:15], v[128:131], a[236:239], v[12:15]
    ds_read_b128 v[152:155], v168 offset:45056
    s_waitcnt lgkmcnt(5)
    v_mfma_f32_16x16x32_bf16 v[28:31], v[132:135], a[236:239], v[28:31]
    buffer_load_dwordx4 a[196:199], v179, s[16:19], s77 offen offset:1024 sc1
    v_mfma_f32_16x16x32_bf16 v[24:27], v[132:135], a[232:235], v[24:27]
    v_mfma_f32_16x16x32_bf16 v[20:23], v[132:135], a[228:231], v[20:23]
    v_mfma_f32_16x16x32_bf16 v[16:19], v[132:135], a[224:227], v[16:19]
    ds_read_b128 v[156:159], v168 offset:47104
    s_waitcnt lgkmcnt(5)
    v_mfma_f32_16x16x32_bf16 v[32:35], v[136:139], a[224:227], 0
    buffer_load_dwordx4 a[200:203], v179, s[16:19], s77 offen offset:2048 sc1
    v_mfma_f32_16x16x32_bf16 v[36:39], v[136:139], a[228:231], 0
    v_mfma_f32_16x16x32_bf16 v[40:43], v[136:139], a[232:235], 0
    v_mfma_f32_16x16x32_bf16 v[44:47], v[136:139], a[236:239], 0
    ds_read_b128 v[128:131], v169 offset:32768
    s_waitcnt lgkmcnt(5)
    v_mfma_f32_16x16x32_bf16 v[60:63], v[140:143], a[236:239], 0
    buffer_load_dwordx4 a[204:207], v179, s[16:19], s77 offen offset:3072 sc1
    v_mfma_f32_16x16x32_bf16 v[56:59], v[140:143], a[232:235], 0
    v_mfma_f32_16x16x32_bf16 v[52:55], v[140:143], a[228:231], 0
    v_mfma_f32_16x16x32_bf16 v[48:51], v[140:143], a[224:227], 0
    ds_read_b128 v[132:135], v169 offset:34816
    s_waitcnt lgkmcnt(5)
    v_mfma_f32_16x16x32_bf16 v[64:67], v[144:147], a[224:227], 0
    s_mul_i32 s77, s100, 0xffff4000
    s_add_u32 s77, s77, s33
    s_add_u32 s77, s77, 0x77000
    buffer_load_dwordx4 a[208:211], v179, s[16:19], s77 offen offset:0 sc1
    v_mfma_f32_16x16x32_bf16 v[68:71], v[144:147], a[228:231], 0
    v_mfma_f32_16x16x32_bf16 v[72:75], v[144:147], a[232:235], 0
    v_mfma_f32_16x16x32_bf16 v[76:79], v[144:147], a[236:239], 0
    ds_read_b128 v[136:139], v169 offset:36864
    s_waitcnt lgkmcnt(5)
    v_mfma_f32_16x16x32_bf16 v[92:95], v[148:151], a[236:239], 0
    buffer_load_dwordx4 a[212:215], v179, s[16:19], s77 offen offset:1024 sc1
    v_mfma_f32_16x16x32_bf16 v[88:91], v[148:151], a[232:235], 0
    v_mfma_f32_16x16x32_bf16 v[84:87], v[148:151], a[228:231], 0
    v_mfma_f32_16x16x32_bf16 v[80:83], v[148:151], a[224:227], 0
    ds_read_b128 v[140:143], v169 offset:38912
    s_waitcnt lgkmcnt(5)
    v_mfma_f32_16x16x32_bf16 v[96:99], v[152:155], a[224:227], 0
    buffer_load_dwordx4 a[216:219], v179, s[16:19], s77 offen offset:2048 sc1
    v_mfma_f32_16x16x32_bf16 v[100:103], v[152:155], a[228:231], 0
    v_mfma_f32_16x16x32_bf16 v[104:107], v[152:155], a[232:235], 0
    v_mfma_f32_16x16x32_bf16 v[108:111], v[152:155], a[236:239], 0
    ds_read_b128 v[144:147], v169 offset:40960
    s_waitcnt lgkmcnt(5)
    v_mfma_f32_16x16x32_bf16 v[124:127], v[156:159], a[236:239], 0
    buffer_load_dwordx4 a[220:223], v179, s[16:19], s77 offen offset:3072 sc1
    v_mfma_f32_16x16x32_bf16 v[120:123], v[156:159], a[232:235], 0
    v_mfma_f32_16x16x32_bf16 v[116:119], v[156:159], a[228:231], 0
    v_mfma_f32_16x16x32_bf16 v[112:115], v[156:159], a[224:227], 0
    ds_read_b128 v[148:151], v169 offset:43008
    s_waitcnt lgkmcnt(5)
    v_mfma_f32_16x16x32_bf16 v[0:3], v[128:131], a[240:243], v[0:3]
    v_mfma_f32_16x16x32_bf16 v[4:7], v[128:131], a[244:247], v[4:7]
    v_mfma_f32_16x16x32_bf16 v[8:11], v[128:131], a[248:251], v[8:11]
    v_mfma_f32_16x16x32_bf16 v[12:15], v[128:131], a[252:255], v[12:15]
    ds_read_b128 v[152:155], v169 offset:45056
    s_waitcnt lgkmcnt(5)
    v_mfma_f32_16x16x32_bf16 v[28:31], v[132:135], a[252:255], v[28:31]
    v_mfma_f32_16x16x32_bf16 v[24:27], v[132:135], a[248:251], v[24:27]
    v_mfma_f32_16x16x32_bf16 v[20:23], v[132:135], a[244:247], v[20:23]
    v_mfma_f32_16x16x32_bf16 v[16:19], v[132:135], a[240:243], v[16:19]
    ds_read_b128 v[156:159], v169 offset:47104
    s_waitcnt lgkmcnt(5)
    v_mfma_f32_16x16x32_bf16 v[32:35], v[136:139], a[240:243], v[32:35]
    v_mfma_f32_16x16x32_bf16 v[36:39], v[136:139], a[244:247], v[36:39]
    v_mfma_f32_16x16x32_bf16 v[40:43], v[136:139], a[248:251], v[40:43]
    v_mfma_f32_16x16x32_bf16 v[44:47], v[136:139], a[252:255], v[44:47]
    s_waitcnt lgkmcnt(4)
    v_mfma_f32_16x16x32_bf16 v[60:63], v[140:143], a[252:255], v[60:63]
    v_mfma_f32_16x16x32_bf16 v[56:59], v[140:143], a[248:251], v[56:59]
    v_mfma_f32_16x16x32_bf16 v[52:55], v[140:143], a[244:247], v[52:55]
    v_mfma_f32_16x16x32_bf16 v[48:51], v[140:143], a[240:243], v[48:51]
    s_waitcnt lgkmcnt(3)
    v_mfma_f32_16x16x32_bf16 v[64:67], v[144:147], a[240:243], v[64:67]
    v_mfma_f32_16x16x32_bf16 v[68:71], v[144:147], a[244:247], v[68:71]
    v_mfma_f32_16x16x32_bf16 v[72:75], v[144:147], a[248:251], v[72:75]
    v_mfma_f32_16x16x32_bf16 v[76:79], v[144:147], a[252:255], v[76:79]
    s_waitcnt vmcnt(24) lgkmcnt(0)
    s_barrier
    ds_read_b128 v[128:131], v168 offset:49152
    v_mfma_f32_16x16x32_bf16 v[92:95], v[148:151], a[252:255], v[92:95]
    ds_read_b128 v[132:135], v168 offset:51200
    s_add_u32 m0, s3, 0x8000
    s_lshl_b32 s76, s100, 9
    s_add_u32 s76, s76, 256
    v_mfma_f32_16x16x32_bf16 v[88:91], v[148:151], a[248:251], v[88:91]
    ds_read_b128 v[136:139], v168 offset:53248
    buffer_load_dwordx4 v170, s[12:15], s76 offen offset:0 lds
    buffer_load_dword v230, v231, s[16:19], s82 offen offset:512 sc1
    v_mfma_f32_16x16x32_bf16 v[84:87], v[148:151], a[244:247], v[84:87]
    ds_read_b128 v[140:143], v168 offset:55296
    v_mfma_f32_16x16x32_bf16 v[80:83], v[148:151], a[240:243], v[80:83]
    ds_read_b128 v[144:147], v168 offset:57344
    buffer_load_dwordx4 v171, s[12:15], s76 offen offset:1024 lds
    v_mfma_f32_16x16x32_bf16 v[96:99], v[152:155], a[240:243], v[96:99]
    v_mfma_f32_16x16x32_bf16 v[100:103], v[152:155], a[244:247], v[100:103]
    buffer_load_dwordx4 v172, s[12:15], s76 offen offset:2048 lds
    v_mfma_f32_16x16x32_bf16 v[104:107], v[152:155], a[248:251], v[104:107]
    v_mfma_f32_16x16x32_bf16 v[108:111], v[152:155], a[252:255], v[108:111]
    buffer_load_dwordx4 v173, s[12:15], s76 offen offset:3072 lds
    v_mfma_f32_16x16x32_bf16 v[124:127], v[156:159], a[252:255], v[124:127]
    v_mfma_f32_16x16x32_bf16 v[120:123], v[156:159], a[248:251], v[120:123]
    v_mfma_f32_16x16x32_bf16 v[116:119], v[156:159], a[244:247], v[116:119]
    v_mfma_f32_16x16x32_bf16 v[112:115], v[156:159], a[240:243], v[112:115]
    ds_read_b128 v[148:151], v168 offset:59392
    s_waitcnt lgkmcnt(5)
    v_mfma_f32_16x16x32_bf16 v[0:3], v[128:131], a[128:131], v[0:3]
    s_mul_i32 s77, s100, 0xffff4000
    s_add_u32 s77, s77, s33
    s_add_u32 s77, s77, 0x78000
    buffer_load_dwordx4 a[224:227], v179, s[16:19], s77 offen offset:0 sc1
    v_mfma_f32_16x16x32_bf16 v[4:7], v[128:131], a[132:135], v[4:7]
    v_mfma_f32_16x16x32_bf16 v[8:11], v[128:131], a[136:139], v[8:11]
    v_mfma_f32_16x16x32_bf16 v[12:15], v[128:131], a[140:143], v[12:15]
    ds_read_b128 v[152:155], v168 offset:61440
    s_waitcnt lgkmcnt(5)
    v_mfma_f32_16x16x32_bf16 v[28:31], v[132:135], a[140:143], v[28:31]
    buffer_load_dwordx4 a[228:231], v179, s[16:19], s77 offen offset:1024 sc1
    v_mfma_f32_16x16x32_bf16 v[24:27], v[132:135], a[136:139], v[24:27]
    v_mfma_f32_16x16x32_bf16 v[20:23], v[132:135], a[132:135], v[20:23]
    v_mfma_f32_16x16x32_bf16 v[16:19], v[132:135], a[128:131], v[16:19]
    ds_read_b128 v[156:159], v168 offset:63488
    s_waitcnt lgkmcnt(5)
    v_mfma_f32_16x16x32_bf16 v[32:35], v[136:139], a[128:131], v[32:35]
    buffer_load_dwordx4 a[232:235], v179, s[16:19], s77 offen offset:2048 sc1
    v_mfma_f32_16x16x32_bf16 v[36:39], v[136:139], a[132:135], v[36:39]
    v_mfma_f32_16x16x32_bf16 v[40:43], v[136:139], a[136:139], v[40:43]
    v_mfma_f32_16x16x32_bf16 v[44:47], v[136:139], a[140:143], v[44:47]
    ds_read_b128 v[128:131], v169 offset:49152
    s_waitcnt lgkmcnt(5)
    v_mfma_f32_16x16x32_bf16 v[60:63], v[140:143], a[140:143], v[60:63]
    buffer_load_dwordx4 a[236:239], v179, s[16:19], s77 offen offset:3072 sc1
    v_mfma_f32_16x16x32_bf16 v[56:59], v[140:143], a[136:139], v[56:59]
    v_mfma_f32_16x16x32_bf16 v[52:55], v[140:143], a[132:135], v[52:55]
    v_mfma_f32_16x16x32_bf16 v[48:51], v[140:143], a[128:131], v[48:51]
    ds_read_b128 v[132:135], v169 offset:51200
    s_waitcnt lgkmcnt(5)
    v_mfma_f32_16x16x32_bf16 v[64:67], v[144:147], a[128:131], v[64:67]
    s_mul_i32 s77, s100, 0xffff4000
    s_add_u32 s77, s77, s33
    s_add_u32 s77, s77, 0x79000
    buffer_load_dwordx4 a[240:243], v179, s[16:19], s77 offen offset:0 sc1
    v_mfma_f32_16x16x32_bf16 v[68:71], v[144:147], a[132:135], v[68:71]
    v_mfma_f32_16x16x32_bf16 v[72:75], v[144:147], a[136:139], v[72:75]
    v_mfma_f32_16x16x32_bf16 v[76:79], v[144:147], a[140:143], v[76:79]
    ds_read_b128 v[136:139], v169 offset:53248
    s_waitcnt lgkmcnt(5)
    v_mfma_f32_16x16x32_bf16 v[92:95], v[148:151], a[140:143], v[92:95]
    buffer_load_dwordx4 a[244:247], v179, s[16:19], s77 offen offset:1024 sc1
    v_mfma_f32_16x16x32_bf16 v[88:91], v[148:151], a[136:139], v[88:91]
    v_mfma_f32_16x16x32_bf16 v[84:87], v[148:151], a[132:135], v[84:87]
    v_mfma_f32_16x16x32_bf16 v[80:83], v[148:151], a[128:131], v[80:83]
    ds_read_b128 v[140:143], v169 offset:55296
    s_waitcnt lgkmcnt(5)
    v_mfma_f32_16x16x32_bf16 v[96:99], v[152:155], a[128:131], v[96:99]
    buffer_load_dwordx4 a[248:251], v179, s[16:19], s77 offen offset:2048 sc1
    v_mfma_f32_16x16x32_bf16 v[100:103], v[152:155], a[132:135], v[100:103]
    v_mfma_f32_16x16x32_bf16 v[104:107], v[152:155], a[136:139], v[104:107]
    v_mfma_f32_16x16x32_bf16 v[108:111], v[152:155], a[140:143], v[108:111]
    ds_read_b128 v[144:147], v169 offset:57344
    s_waitcnt lgkmcnt(5)
    v_mfma_f32_16x16x32_bf16 v[124:127], v[156:159], a[140:143], v[124:127]
    buffer_load_dwordx4 a[252:255], v179, s[16:19], s77 offen offset:3072 sc1
    v_mfma_f32_16x16x32_bf16 v[120:123], v[156:159], a[136:139], v[120:123]
    v_mfma_f32_16x16x32_bf16 v[116:119], v[156:159], a[132:135], v[116:119]
    v_mfma_f32_16x16x32_bf16 v[112:115], v[156:159], a[128:131], v[112:115]
    ds_read_b128 v[148:151], v169 offset:59392
    s_waitcnt lgkmcnt(5)
    v_mfma_f32_16x16x32_bf16 v[0:3], v[128:131], a[144:147], v[0:3]
    v_mfma_f32_16x16x32_bf16 v[4:7], v[128:131], a[148:151], v[4:7]
    v_mfma_f32_16x16x32_bf16 v[8:11], v[128:131], a[152:155], v[8:11]
    v_mfma_f32_16x16x32_bf16 v[12:15], v[128:131], a[156:159], v[12:15]
    ds_read_b128 v[152:155], v169 offset:61440
    s_waitcnt lgkmcnt(5)
    v_mfma_f32_16x16x32_bf16 v[28:31], v[132:135], a[156:159], v[28:31]
    v_mfma_f32_16x16x32_bf16 v[24:27], v[132:135], a[152:155], v[24:27]
    v_mfma_f32_16x16x32_bf16 v[20:23], v[132:135], a[148:151], v[20:23]
    v_mfma_f32_16x16x32_bf16 v[16:19], v[132:135], a[144:147], v[16:19]
    ds_read_b128 v[156:159], v169 offset:63488
    s_waitcnt lgkmcnt(5)
    v_mfma_f32_16x16x32_bf16 v[32:35], v[136:139], a[144:147], v[32:35]
    v_mfma_f32_16x16x32_bf16 v[36:39], v[136:139], a[148:151], v[36:39]
    v_mfma_f32_16x16x32_bf16 v[40:43], v[136:139], a[152:155], v[40:43]
    v_mfma_f32_16x16x32_bf16 v[44:47], v[136:139], a[156:159], v[44:47]
    s_waitcnt lgkmcnt(4)
    v_mfma_f32_16x16x32_bf16 v[60:63], v[140:143], a[156:159], v[60:63]
    v_mfma_f32_16x16x32_bf16 v[56:59], v[140:143], a[152:155], v[56:59]
    v_mfma_f32_16x16x32_bf16 v[52:55], v[140:143], a[148:151], v[52:55]
    v_mfma_f32_16x16x32_bf16 v[48:51], v[140:143], a[144:147], v[48:51]
    s_waitcnt lgkmcnt(3)
    v_mfma_f32_16x16x32_bf16 v[64:67], v[144:147], a[144:147], v[64:67]
    v_mfma_f32_16x16x32_bf16 v[68:71], v[144:147], a[148:151], v[68:71]
    v_mfma_f32_16x16x32_bf16 v[72:75], v[144:147], a[152:155], v[72:75]
    v_mfma_f32_16x16x32_bf16 v[76:79], v[144:147], a[156:159], v[76:79]
    s_waitcnt vmcnt(25) lgkmcnt(0)
    s_barrier
    ds_read_b128 v[128:131], v168 offset:0
    v_mfma_f32_16x16x32_bf16 v[92:95], v[148:151], a[156:159], v[92:95]
    ds_read_b128 v[132:135], v168 offset:2048
    s_add_u32 m0, s3, 0xc000
    s_lshl_b32 s76, s100, 9
    s_add_u32 s76, s76, 256
    v_mfma_f32_16x16x32_bf16 v[88:91], v[148:151], a[152:155], v[88:91]
    ds_read_b128 v[136:139], v168 offset:4096
    buffer_load_dwordx4 v170, s[24:27], s76 offen offset:0 lds
    v_mfma_f32_16x16x32_bf16 v[84:87], v[148:151], a[148:151], v[84:87]
    ds_read_b128 v[140:143], v168 offset:6144
    v_mfma_f32_16x16x32_bf16 v[80:83], v[148:151], a[144:147], v[80:83]
    ds_read_b128 v[144:147], v168 offset:8192
    buffer_load_dwordx4 v171, s[24:27], s76 offen offset:1024 lds
    v_mfma_f32_16x16x32_bf16 v[96:99], v[152:155], a[144:147], v[96:99]
    v_mfma_f32_16x16x32_bf16 v[100:103], v[152:155], a[148:151], v[100:103]
    buffer_load_dwordx4 v172, s[24:27], s76 offen offset:2048 lds
    v_mfma_f32_16x16x32_bf16 v[104:107], v[152:155], a[152:155], v[104:107]
    v_mfma_f32_16x16x32_bf16 v[108:111], v[152:155], a[156:159], v[108:111]
    buffer_load_dwordx4 v173, s[24:27], s76 offen offset:3072 lds
    v_mfma_f32_16x16x32_bf16 v[124:127], v[156:159], a[156:159], v[124:127]
    v_mfma_f32_16x16x32_bf16 v[120:123], v[156:159], a[152:155], v[120:123]
    v_mfma_f32_16x16x32_bf16 v[116:119], v[156:159], a[148:151], v[116:119]
    v_mfma_f32_16x16x32_bf16 v[112:115], v[156:159], a[144:147], v[112:115]
    ds_read_b128 v[148:151], v168 offset:10240
    s_waitcnt lgkmcnt(5)
    v_mfma_f32_16x16x32_bf16 v[0:3], v[128:131], a[160:163], v[0:3]
    s_mul_i32 s77, s100, 0xffff4000
    s_add_u32 s77, s77, s33
    s_add_u32 s77, s77, 0x7a000
    buffer_load_dwordx4 a[128:131], v179, s[16:19], s77 offen offset:0 sc1
    v_mfma_f32_16x16x32_bf16 v[4:7], v[128:131], a[164:167], v[4:7]
    v_mfma_f32_16x16x32_bf16 v[8:11], v[128:131], a[168:171], v[8:11]
    v_mfma_f32_16x16x32_bf16 v[12:15], v[128:131], a[172:175], v[12:15]
    ds_read_b128 v[152:155], v168 offset:12288
    s_waitcnt lgkmcnt(5)
    v_mfma_f32_16x16x32_bf16 v[28:31], v[132:135], a[172:175], v[28:31]
    buffer_load_dwordx4 a[132:135], v179, s[16:19], s77 offen offset:1024 sc1
    v_mfma_f32_16x16x32_bf16 v[24:27], v[132:135], a[168:171], v[24:27]
    v_mfma_f32_16x16x32_bf16 v[20:23], v[132:135], a[164:167], v[20:23]
    v_mfma_f32_16x16x32_bf16 v[16:19], v[132:135], a[160:163], v[16:19]
    ds_read_b128 v[156:159], v168 offset:14336
    s_waitcnt lgkmcnt(5)
    v_mfma_f32_16x16x32_bf16 v[32:35], v[136:139], a[160:163], v[32:35]
    buffer_load_dwordx4 a[136:139], v179, s[16:19], s77 offen offset:2048 sc1
    v_mfma_f32_16x16x32_bf16 v[36:39], v[136:139], a[164:167], v[36:39]
    v_mfma_f32_16x16x32_bf16 v[40:43], v[136:139], a[168:171], v[40:43]
    v_mfma_f32_16x16x32_bf16 v[44:47], v[136:139], a[172:175], v[44:47]
    ds_read_b128 v[128:131], v169 offset:0
    s_waitcnt lgkmcnt(5)
    v_mfma_f32_16x16x32_bf16 v[60:63], v[140:143], a[172:175], v[60:63]
    buffer_load_dwordx4 a[140:143], v179, s[16:19], s77 offen offset:3072 sc1
    v_mfma_f32_16x16x32_bf16 v[56:59], v[140:143], a[168:171], v[56:59]
    v_mfma_f32_16x16x32_bf16 v[52:55], v[140:143], a[164:167], v[52:55]
    v_mfma_f32_16x16x32_bf16 v[48:51], v[140:143], a[160:163], v[48:51]
    ds_read_b128 v[132:135], v169 offset:2048
    s_waitcnt lgkmcnt(5)
    v_mfma_f32_16x16x32_bf16 v[64:67], v[144:147], a[160:163], v[64:67]
    s_mul_i32 s77, s100, 0xffff4000
    s_add_u32 s77, s77, s33
    s_add_u32 s77, s77, 0x7b000
    buffer_load_dwordx4 a[144:147], v179, s[16:19], s77 offen offset:0 sc1
    v_mfma_f32_16x16x32_bf16 v[68:71], v[144:147], a[164:167], v[68:71]
    v_mfma_f32_16x16x32_bf16 v[72:75], v[144:147], a[168:171], v[72:75]
    v_mfma_f32_16x16x32_bf16 v[76:79], v[144:147], a[172:175], v[76:79]
    ds_read_b128 v[136:139], v169 offset:4096
    s_waitcnt lgkmcnt(5)
    v_mfma_f32_16x16x32_bf16 v[92:95], v[148:151], a[172:175], v[92:95]
    buffer_load_dwordx4 a[148:151], v179, s[16:19], s77 offen offset:1024 sc1
    v_mfma_f32_16x16x32_bf16 v[88:91], v[148:151], a[168:171], v[88:91]
    v_mfma_f32_16x16x32_bf16 v[84:87], v[148:151], a[164:167], v[84:87]
    v_mfma_f32_16x16x32_bf16 v[80:83], v[148:151], a[160:163], v[80:83]
    ds_read_b128 v[140:143], v169 offset:6144
    s_waitcnt lgkmcnt(5)
    v_mfma_f32_16x16x32_bf16 v[96:99], v[152:155], a[160:163], v[96:99]
    buffer_load_dwordx4 a[152:155], v179, s[16:19], s77 offen offset:2048 sc1
    v_mfma_f32_16x16x32_bf16 v[100:103], v[152:155], a[164:167], v[100:103]
    v_mfma_f32_16x16x32_bf16 v[104:107], v[152:155], a[168:171], v[104:107]
    v_mfma_f32_16x16x32_bf16 v[108:111], v[152:155], a[172:175], v[108:111]
    ds_read_b128 v[144:147], v169 offset:8192
    s_waitcnt lgkmcnt(5)
    v_mfma_f32_16x16x32_bf16 v[124:127], v[156:159], a[172:175], v[124:127]
    buffer_load_dwordx4 a[156:159], v179, s[16:19], s77 offen offset:3072 sc1
    v_mfma_f32_16x16x32_bf16 v[120:123], v[156:159], a[168:171], v[120:123]
    v_mfma_f32_16x16x32_bf16 v[116:119], v[156:159], a[164:167], v[116:119]
    v_mfma_f32_16x16x32_bf16 v[112:115], v[156:159], a[160:163], v[112:115]
    ds_read_b128 v[148:151], v169 offset:10240
    s_waitcnt lgkmcnt(5)
    v_mfma_f32_16x16x32_bf16 v[0:3], v[128:131], a[176:179], v[0:3]
    v_mfma_f32_16x16x32_bf16 v[4:7], v[128:131], a[180:183], v[4:7]
    v_mfma_f32_16x16x32_bf16 v[8:11], v[128:131], a[184:187], v[8:11]
    v_mfma_f32_16x16x32_bf16 v[12:15], v[128:131], a[188:191], v[12:15]
    ds_read_b128 v[152:155], v169 offset:12288
    s_waitcnt lgkmcnt(5)
    v_mfma_f32_16x16x32_bf16 v[28:31], v[132:135], a[188:191], v[28:31]
    v_mfma_f32_16x16x32_bf16 v[24:27], v[132:135], a[184:187], v[24:27]
    v_mfma_f32_16x16x32_bf16 v[20:23], v[132:135], a[180:183], v[20:23]
    v_mfma_f32_16x16x32_bf16 v[16:19], v[132:135], a[176:179], v[16:19]
    ds_read_b128 v[156:159], v169 offset:14336
    s_waitcnt lgkmcnt(5)
    v_mfma_f32_16x16x32_bf16 v[32:35], v[136:139], a[176:179], v[32:35]
    v_mfma_f32_16x16x32_bf16 v[36:39], v[136:139], a[180:183], v[36:39]
    v_mfma_f32_16x16x32_bf16 v[40:43], v[136:139], a[184:187], v[40:43]
    v_mfma_f32_16x16x32_bf16 v[44:47], v[136:139], a[188:191], v[44:47]
    s_waitcnt lgkmcnt(4)
    v_mfma_f32_16x16x32_bf16 v[60:63], v[140:143], a[188:191], v[60:63]
    v_mfma_f32_16x16x32_bf16 v[56:59], v[140:143], a[184:187], v[56:59]
    v_mfma_f32_16x16x32_bf16 v[52:55], v[140:143], a[180:183], v[52:55]
    v_mfma_f32_16x16x32_bf16 v[48:51], v[140:143], a[176:179], v[48:51]
    s_waitcnt lgkmcnt(3)
    v_mfma_f32_16x16x32_bf16 v[64:67], v[144:147], a[176:179], v[64:67]
    v_mfma_f32_16x16x32_bf16 v[68:71], v[144:147], a[180:183], v[68:71]
    v_mfma_f32_16x16x32_bf16 v[72:75], v[144:147], a[184:187], v[72:75]
    v_mfma_f32_16x16x32_bf16 v[76:79], v[144:147], a[188:191], v[76:79]
    s_waitcnt vmcnt(25) lgkmcnt(0)
    s_barrier
    ds_read_b128 v[128:131], v168 offset:16384
    v_mfma_f32_16x16x32_bf16 v[92:95], v[148:151], a[188:191], v[92:95]
    ds_read_b128 v[132:135], v168 offset:18432
    s_add_u32 m0, s3, 0x0
    s_lshl_b32 s76, s100, 9
    s_add_u32 s76, s76, 384
    v_mfma_f32_16x16x32_bf16 v[88:91], v[148:151], a[184:187], v[88:91]
    ds_read_b128 v[136:139], v168 offset:20480
    buffer_load_dwordx4 v170, s[12:15], s76 offen offset:0 lds
    s_waitcnt vmcnt(24)
    v_cmp_eq_u32 vcc, 1, v230
    s_cmp_eq_u64 vcc, -1
    s_cbranch_scc0 chk_3_slow
chk_3_ok:
    v_mfma_f32_16x16x32_bf16 v[84:87], v[148:151], a[180:183], v[84:87]
    ds_read_b128 v[140:143], v168 offset:22528
    v_mfma_f32_16x16x32_bf16 v[80:83], v[148:151], a[176:179], v[80:83]
    ds_read_b128 v[144:147], v168 offset:24576
    buffer_load_dwordx4 v171, s[12:15], s76 offen offset:1024 lds
    v_mfma_f32_16x16x32_bf16 v[96:99], v[152:155], a[176:179], v[96:99]
    v_mfma_f32_16x16x32_bf16 v[100:103], v[152:155], a[180:183], v[100:103]
    buffer_load_dwordx4 v172, s[12:15], s76 offen offset:2048 lds
    v_mfma_f32_16x16x32_bf16 v[104:107], v[152:155], a[184:187], v[104:107]
    v_mfma_f32_16x16x32_bf16 v[108:111], v[152:155], a[188:191], v[108:111]
    buffer_load_dwordx4 v173, s[12:15], s76 offen offset:3072 lds
    v_mfma_f32_16x16x32_bf16 v[124:127], v[156:159], a[188:191], v[124:127]
    v_mfma_f32_16x16x32_bf16 v[120:123], v[156:159], a[184:187], v[120:123]
    v_mfma_f32_16x16x32_bf16 v[116:119], v[156:159], a[180:183], v[116:119]
    v_mfma_f32_16x16x32_bf16 v[112:115], v[156:159], a[176:179], v[112:115]
    ds_read_b128 v[148:151], v168 offset:26624
    s_waitcnt lgkmcnt(5)
    v_mfma_f32_16x16x32_bf16 v[0:3], v[128:131], a[192:195], v[0:3]
    s_mul_i32 s77, s100, 0xffff4000
    s_add_u32 s77, s77, s33
    s_add_u32 s77, s77, 0x7c000
    buffer_load_dwordx4 a[160:163], v179, s[16:19], s77 offen offset:0 sc1
    v_mfma_f32_16x16x32_bf16 v[4:7], v[128:131], a[196:199], v[4:7]
    v_mfma_f32_16x16x32_bf16 v[8:11], v[128:131], a[200:203], v[8:11]
    v_mfma_f32_16x16x32_bf16 v[12:15], v[128:131], a[204:207], v[12:15]
    ds_read_b128 v[152:155], v168 offset:28672
    s_waitcnt lgkmcnt(5)
    v_mfma_f32_16x16x32_bf16 v[28:31], v[132:135], a[204:207], v[28:31]
    buffer_load_dwordx4 a[164:167], v179, s[16:19], s77 offen offset:1024 sc1
    v_mfma_f32_16x16x32_bf16 v[24:27], v[132:135], a[200:203], v[24:27]
    v_mfma_f32_16x16x32_bf16 v[20:23], v[132:135], a[196:199], v[20:23]
    v_mfma_f32_16x16x32_bf16 v[16:19], v[132:135], a[192:195], v[16:19]
    ds_read_b128 v[156:159], v168 offset:30720
    s_waitcnt lgkmcnt(5)
    v_mfma_f32_16x16x32_bf16 v[32:35], v[136:139], a[192:195], v[32:35]
    buffer_load_dwordx4 a[168:171], v179, s[16:19], s77 offen offset:2048 sc1
    v_mfma_f32_16x16x32_bf16 v[36:39], v[136:139], a[196:199], v[36:39]
    v_mfma_f32_16x16x32_bf16 v[40:43], v[136:139], a[200:203], v[40:43]
    v_mfma_f32_16x16x32_bf16 v[44:47], v[136:139], a[204:207], v[44:47]
    ds_read_b128 v[128:131], v169 offset:16384
    s_waitcnt lgkmcnt(5)
    v_mfma_f32_16x16x32_bf16 v[60:63], v[140:143], a[204:207], v[60:63]
    buffer_load_dwordx4 a[172:175], v179, s[16:19], s77 offen offset:3072 sc1
    v_mfma_f32_16x16x32_bf16 v[56:59], v[140:143], a[200:203], v[56:59]
    v_mfma_f32_16x16x32_bf16 v[52:55], v[140:143], a[196:199], v[52:55]
    v_mfma_f32_16x16x32_bf16 v[48:51], v[140:143], a[192:195], v[48:51]
    ds_read_b128 v[132:135], v169 offset:18432
    s_waitcnt lgkmcnt(5)
    v_mfma_f32_16x16x32_bf16 v[64:67], v[144:147], a[192:195], v[64:67]
    s_mul_i32 s77, s100, 0xffff4000
    s_add_u32 s77, s77, s33
    s_add_u32 s77, s77, 0x7d000
    buffer_load_dwordx4 a[176:179], v179, s[16:19], s77 offen offset:0 sc1
    v_mfma_f32_16x16x32_bf16 v[68:71], v[144:147], a[196:199], v[68:71]
    v_mfma_f32_16x16x32_bf16 v[72:75], v[144:147], a[200:203], v[72:75]
    v_mfma_f32_16x16x32_bf16 v[76:79], v[144:147], a[204:207], v[76:79]
    ds_read_b128 v[136:139], v169 offset:20480
    s_waitcnt lgkmcnt(5)
    v_mfma_f32_16x16x32_bf16 v[92:95], v[148:151], a[204:207], v[92:95]
    buffer_load_dwordx4 a[180:183], v179, s[16:19], s77 offen offset:1024 sc1
    v_mfma_f32_16x16x32_bf16 v[88:91], v[148:151], a[200:203], v[88:91]
    v_mfma_f32_16x16x32_bf16 v[84:87], v[148:151], a[196:199], v[84:87]
    v_mfma_f32_16x16x32_bf16 v[80:83], v[148:151], a[192:195], v[80:83]
    ds_read_b128 v[140:143], v169 offset:22528
    s_waitcnt lgkmcnt(5)
    v_mfma_f32_16x16x32_bf16 v[96:99], v[152:155], a[192:195], v[96:99]
    buffer_load_dwordx4 a[184:187], v179, s[16:19], s77 offen offset:2048 sc1
    v_mfma_f32_16x16x32_bf16 v[100:103], v[152:155], a[196:199], v[100:103]
    v_mfma_f32_16x16x32_bf16 v[104:107], v[152:155], a[200:203], v[104:107]
    v_mfma_f32_16x16x32_bf16 v[108:111], v[152:155], a[204:207], v[108:111]
    ds_read_b128 v[144:147], v169 offset:24576
    s_waitcnt lgkmcnt(5)
    v_mfma_f32_16x16x32_bf16 v[124:127], v[156:159], a[204:207], v[124:127]
    buffer_load_dwordx4 a[188:191], v179, s[16:19], s77 offen offset:3072 sc1
    v_mfma_f32_16x16x32_bf16 v[120:123], v[156:159], a[200:203], v[120:123]
    v_mfma_f32_16x16x32_bf16 v[116:119], v[156:159], a[196:199], v[116:119]
    v_mfma_f32_16x16x32_bf16 v[112:115], v[156:159], a[192:195], v[112:115]
    ds_read_b128 v[148:151], v169 offset:26624
    s_waitcnt lgkmcnt(5)
    v_mfma_f32_16x16x32_bf16 v[0:3], v[128:131], a[208:211], v[0:3]
    v_mfma_f32_16x16x32_bf16 v[4:7], v[128:131], a[212:215], v[4:7]
    v_mfma_f32_16x16x32_bf16 v[8:11], v[128:131], a[216:219], v[8:11]
    v_mfma_f32_16x16x32_bf16 v[12:15], v[128:131], a[220:223], v[12:15]
    ds_read_b128 v[152:155], v169 offset:28672
    s_waitcnt lgkmcnt(5)
    v_mfma_f32_16x16x32_bf16 v[28:31], v[132:135], a[220:223], v[28:31]
    v_mfma_f32_16x16x32_bf16 v[24:27], v[132:135], a[216:219], v[24:27]
    v_mfma_f32_16x16x32_bf16 v[20:23], v[132:135], a[212:215], v[20:23]
    v_mfma_f32_16x16x32_bf16 v[16:19], v[132:135], a[208:211], v[16:19]
    ds_read_b128 v[156:159], v169 offset:30720
    s_waitcnt lgkmcnt(5)
    v_mfma_f32_16x16x32_bf16 v[32:35], v[136:139], a[208:211], v[32:35]
    v_mfma_f32_16x16x32_bf16 v[36:39], v[136:139], a[212:215], v[36:39]
    v_mfma_f32_16x16x32_bf16 v[40:43], v[136:139], a[216:219], v[40:43]
    v_mfma_f32_16x16x32_bf16 v[44:47], v[136:139], a[220:223], v[44:47]
    s_waitcnt lgkmcnt(4)
    v_mfma_f32_16x16x32_bf16 v[60:63], v[140:143], a[220:223], v[60:63]
    v_mfma_f32_16x16x32_bf16 v[56:59], v[140:143], a[216:219], v[56:59]
    v_mfma_f32_16x16x32_bf16 v[52:55], v[140:143], a[212:215], v[52:55]
    v_mfma_f32_16x16x32_bf16 v[48:51], v[140:143], a[208:211], v[48:51]
    s_waitcnt lgkmcnt(3)
    v_mfma_f32_16x16x32_bf16 v[64:67], v[144:147], a[208:211], v[64:67]
    v_mfma_f32_16x16x32_bf16 v[68:71], v[144:147], a[212:215], v[68:71]
    v_mfma_f32_16x16x32_bf16 v[72:75], v[144:147], a[216:219], v[72:75]
    v_mfma_f32_16x16x32_bf16 v[76:79], v[144:147], a[220:223], v[76:79]
    s_waitcnt vmcnt(0) lgkmcnt(0)
    s_barrier
    ds_read_b128 v[128:131], v168 offset:47104
    s_add_u32 s80, s28, s100
    s_and_b32 s80, s80, 3
    s_sub_u32 s80, s100, s80
    s_lshl_b32 s80, s80, 16
    v_add_u32 v170, s80, v170
    v_mfma_f32_16x16x32_bf16 v[92:95], v[148:151], a[220:223], v[92:95]
    ds_read_b128 v[132:135], v169 offset:47104
    v_add_u32 v171, s80, v171
    v_add_u32 v172, s80, v172
    v_add_u32 v173, s80, v173
    s_add_u32 m0, s3, 0x4000
    s_lshl_b32 s76, s28, 9
    s_add_u32 s76, s76, 384
    v_mfma_f32_16x16x32_bf16 v[88:91], v[148:151], a[216:219], v[88:91]
    ds_read_b128 v[136:139], v168 offset:63488
    buffer_load_dwordx4 v170, s[24:27], s76 offen offset:0 lds
    v_mfma_f32_16x16x32_bf16 v[84:87], v[148:151], a[212:215], v[84:87]
    ds_read_b128 v[140:143], v169 offset:63488
    v_mfma_f32_16x16x32_bf16 v[80:83], v[148:151], a[208:211], v[80:83]
    ds_read_b128 v[144:147], v168 offset:14336
    buffer_load_dwordx4 v171, s[24:27], s76 offen offset:1024 lds
    v_mfma_f32_16x16x32_bf16 v[96:99], v[152:155], a[208:211], v[96:99]
    v_mfma_f32_16x16x32_bf16 v[100:103], v[152:155], a[212:215], v[100:103]
    buffer_load_dwordx4 v172, s[24:27], s76 offen offset:2048 lds
    v_mfma_f32_16x16x32_bf16 v[104:107], v[152:155], a[216:219], v[104:107]
    v_mfma_f32_16x16x32_bf16 v[108:111], v[152:155], a[220:223], v[108:111]
    buffer_load_dwordx4 v173, s[24:27], s76 offen offset:3072 lds
    v_mfma_f32_16x16x32_bf16 v[124:127], v[156:159], a[220:223], v[124:127]
    v_mfma_f32_16x16x32_bf16 v[120:123], v[156:159], a[216:219], v[120:123]
    v_mfma_f32_16x16x32_bf16 v[116:119], v[156:159], a[212:215], v[116:119]
    v_mfma_f32_16x16x32_bf16 v[112:115], v[156:159], a[208:211], v[112:115]
    ds_read_b128 v[148:151], v169 offset:14336
    s_waitcnt lgkmcnt(5)
    v_mfma_f32_16x16x32_bf16 v[112:115], v[128:131], a[224:227], v[112:115]
    s_mul_i32 s77, s100, 0xfffe4000
    s_add_u32 s77, s77, s33
    s_add_u32 s77, s77, 0x7e000
    buffer_load_dwordx4 a[192:195], v179, s[16:19], s77 offen offset:0 sc1
    v_mfma_f32_16x16x32_bf16 v[116:119], v[128:131], a[228:231], v[116:119]
    v_mfma_f32_16x16x32_bf16 v[120:123], v[128:131], a[232:235], v[120:123]
    buffer_load_dwordx4 a[196:199], v179, s[16:19], s77 offen offset:1024 sc1
    v_mfma_f32_16x16x32_bf16 v[124:127], v[128:131], a[236:239], v[124:127]
    ds_read_b128 v[152:155], v168 offset:45056
    s_waitcnt lgkmcnt(5)
    v_mfma_f32_16x16x32_bf16 v[124:127], v[132:135], a[252:255], v[124:127]
    buffer_load_dwordx4 a[200:203], v179, s[16:19], s77 offen offset:2048 sc1
    v_mfma_f32_16x16x32_bf16 v[120:123], v[132:135], a[248:251], v[120:123]
    v_mfma_f32_16x16x32_bf16 v[116:119], v[132:135], a[244:247], v[116:119]
    buffer_load_dwordx4 a[204:207], v179, s[16:19], s77 offen offset:3072 sc1
    v_mfma_f32_16x16x32_bf16 v[112:115], v[132:135], a[240:243], v[112:115]
    ds_read_b128 v[156:159], v169 offset:45056
    s_waitcnt lgkmcnt(5)
    v_mfma_f32_16x16x32_bf16 v[112:115], v[136:139], a[128:131], v[112:115]
    s_mul_i32 s77, s100, 0xfffe4000
    s_add_u32 s77, s77, s33
    s_add_u32 s77, s77, 0x7f000
    buffer_load_dwordx4 a[208:211], v179, s[16:19], s77 offen offset:0 sc1
    v_mfma_f32_16x16x32_bf16 v[116:119], v[136:139], a[132:135], v[116:119]
    v_mfma_f32_16x16x32_bf16 v[120:123], v[136:139], a[136:139], v[120:123]
    buffer_load_dwordx4 a[212:215], v179, s[16:19], s77 offen offset:1024 sc1
    v_mfma_f32_16x16x32_bf16 v[124:127], v[136:139], a[140:143], v[124:127]
    ds_read_b128 v[128:131], v168 offset:61440
    s_waitcnt lgkmcnt(5)
    v_mfma_f32_16x16x32_bf16 v[124:127], v[140:143], a[156:159], v[124:127]
    buffer_load_dwordx4 a[216:219], v179, s[16:19], s77 offen offset:2048 sc1
    v_mfma_f32_16x16x32_bf16 v[120:123], v[140:143], a[152:155], v[120:123]
    v_mfma_f32_16x16x32_bf16 v[116:119], v[140:143], a[148:151], v[116:119]
    buffer_load_dwordx4 a[220:223], v179, s[16:19], s77 offen offset:3072 sc1
    v_mfma_f32_16x16x32_bf16 v[112:115], v[140:143], a[144:147], v[112:115]
    ds_read_b128 v[132:135], v169 offset:61440
    s_waitcnt lgkmcnt(5)
    v_mfma_f32_16x16x32_bf16 v[112:115], v[144:147], a[160:163], v[112:115]
    v_mfma_f32_16x16x32_bf16 v[116:119], v[144:147], a[164:167], v[116:119]
    v_mfma_f32_16x16x32_bf16 v[120:123], v[144:147], a[168:171], v[120:123]
    v_mfma_f32_16x16x32_bf16 v[124:127], v[144:147], a[172:175], v[124:127]
    ds_read_b128 v[136:139], v168 offset:12288
    s_waitcnt lgkmcnt(5)
    v_mfma_f32_16x16x32_bf16 v[124:127], v[148:151], a[188:191], v[124:127]
    v_mfma_f32_16x16x32_bf16 v[120:123], v[148:151], a[184:187], v[120:123]
    v_mfma_f32_16x16x32_bf16 v[116:119], v[148:151], a[180:183], v[116:119]
    v_mfma_f32_16x16x32_bf16 v[112:115], v[148:151], a[176:179], v[112:115]
    ds_read_b128 v[140:143], v169 offset:12288
    s_waitcnt lgkmcnt(5)
    v_mfma_f32_16x16x32_bf16 v[96:99], v[152:155], a[224:227], v[96:99]
    v_mfma_f32_16x16x32_bf16 v[100:103], v[152:155], a[228:231], v[100:103]
    v_mfma_f32_16x16x32_bf16 v[104:107], v[152:155], a[232:235], v[104:107]
    v_mfma_f32_16x16x32_bf16 v[108:111], v[152:155], a[236:239], v[108:111]
    ds_read_b128 v[144:147], v168 offset:43008
    s_waitcnt lgkmcnt(5)
    v_mfma_f32_16x16x32_bf16 v[108:111], v[156:159], a[252:255], v[108:111]
    v_mfma_f32_16x16x32_bf16 v[104:107], v[156:159], a[248:251], v[104:107]
    v_mfma_f32_16x16x32_bf16 v[100:103], v[156:159], a[244:247], v[100:103]
    v_mfma_f32_16x16x32_bf16 v[96:99], v[156:159], a[240:243], v[96:99]
    ds_read_b128 v[148:151], v169 offset:43008
    v_accvgpr_read_b32 v240, a112
    v_accvgpr_read_b32 v241, a113
    v_accvgpr_read_b32 v242, a114
    v_accvgpr_read_b32 v243, a115
    v_mul_f32 v112, v236, v112
    s_waitcnt lgkmcnt(5)
    v_mfma_f32_16x16x32_bf16 v[96:99], v[128:131], a[128:131], v[96:99]
    v_mul_f32 v113, v236, v113
    v_mul_f32 v114, v236, v114
    v_mul_f32 v115, v236, v115
    v_fmac_f32 v112, v232, v240
    v_fmac_f32 v113, v232, v241
    v_fmac_f32 v114, v232, v242
    v_mfma_f32_16x16x32_bf16 v[100:103], v[128:131], a[132:135], v[100:103]
    v_fmac_f32 v115, v232, v243
    v_cvt_pk_bf16_f32 v112, v112, v113
    v_cvt_pk_bf16_f32 v113, v114, v115
    v_accvgpr_read_b32 v244, a116
    v_accvgpr_read_b32 v245, a117
    v_accvgpr_read_b32 v246, a118
    v_mfma_f32_16x16x32_bf16 v[104:107], v[128:131], a[136:139], v[104:107]
    v_accvgpr_read_b32 v247, a119
    v_mul_f32 v116, v237, v116
    v_mul_f32 v117, v237, v117
    v_mul_f32 v118, v237, v118
    v_mul_f32 v119, v237, v119
    v_fmac_f32 v116, v233, v244
    v_mfma_f32_16x16x32_bf16 v[108:111], v[128:131], a[140:143], v[108:111]
    ds_read_b128 v[152:155], v168 offset:59392
    v_fmac_f32 v117, v233, v245
    v_fmac_f32 v118, v233, v246
    v_fmac_f32 v119, v233, v247
    v_cvt_pk_bf16_f32 v114, v116, v117
    v_cvt_pk_bf16_f32 v115, v118, v119
    s_waitcnt lgkmcnt(5)
    v_mfma_f32_16x16x32_bf16 v[108:111], v[132:135], a[156:159], v[108:111]
    buffer_store_dwordx4 v[112:115], v179, s[16:19], s85 offen offset:2048 sc1
    v_accvgpr_read_b32 v240, a120
    v_accvgpr_read_b32 v241, a121
    v_accvgpr_read_b32 v242, a122
    v_accvgpr_read_b32 v243, a123
    v_mul_f32 v120, v238, v120
    v_mfma_f32_16x16x32_bf16 v[104:107], v[132:135], a[152:155], v[104:107]
    v_mul_f32 v121, v238, v121
    v_mul_f32 v122, v238, v122
    v_mul_f32 v123, v238, v123
    v_fmac_f32 v120, v234, v240
    v_fmac_f32 v121, v234, v241
    v_fmac_f32 v122, v234, v242
    v_mfma_f32_16x16x32_bf16 v[100:103], v[132:135], a[148:151], v[100:103]
    v_fmac_f32 v123, v234, v243
    v_cvt_pk_bf16_f32 v120, v120, v121
    v_cvt_pk_bf16_f32 v121, v122, v123
    v_accvgpr_read_b32 v244, a124
    v_accvgpr_read_b32 v245, a125
    v_accvgpr_read_b32 v246, a126
    v_mfma_f32_16x16x32_bf16 v[96:99], v[132:135], a[144:147], v[96:99]
    ds_read_b128 v[156:159], v169 offset:59392
    v_accvgpr_read_b32 v247, a127
    v_mul_f32 v124, v239, v124
    v_mul_f32 v125, v239, v125
    v_mul_f32 v126, v239, v126
    v_mul_f32 v127, v239, v127
    s_waitcnt lgkmcnt(5)
    v_mfma_f32_16x16x32_bf16 v[96:99], v[136:139], a[160:163], v[96:99]
    v_fmac_f32 v124, v235, v244
    v_fmac_f32 v125, v235, v245
    v_fmac_f32 v126, v235, v246
    v_fmac_f32 v127, v235, v247
    v_cvt_pk_bf16_f32 v122, v124, v125
    v_cvt_pk_bf16_f32 v123, v126, v127
    v_mfma_f32_16x16x32_bf16 v[100:103], v[136:139], a[164:167], v[100:103]
    buffer_store_dwordx4 v[120:123], v179, s[16:19], s85 offen offset:3072 sc1
    v_mfma_f32_16x16x32_bf16 v[104:107], v[136:139], a[168:171], v[104:107]
    v_mfma_f32_16x16x32_bf16 v[108:111], v[136:139], a[172:175], v[108:111]
    ds_read_b128 v[128:131], v168 offset:10240
    s_waitcnt lgkmcnt(5)
    v_mfma_f32_16x16x32_bf16 v[108:111], v[140:143], a[188:191], v[108:111]
    v_mfma_f32_16x16x32_bf16 v[104:107], v[140:143], a[184:187], v[104:107]
    v_mfma_f32_16x16x32_bf16 v[100:103], v[140:143], a[180:183], v[100:103]
    v_mfma_f32_16x16x32_bf16 v[96:99], v[140:143], a[176:179], v[96:99]
    ds_read_b128 v[132:135], v169 offset:10240
    s_waitcnt lgkmcnt(5)
    v_mfma_f32_16x16x32_bf16 v[80:83], v[144:147], a[224:227], v[80:83]
    v_mfma_f32_16x16x32_bf16 v[84:87], v[144:147], a[228:231], v[84:87]
    v_mfma_f32_16x16x32_bf16 v[88:91], v[144:147], a[232:235], v[88:91]
    v_mfma_f32_16x16x32_bf16 v[92:95], v[144:147], a[236:239], v[92:95]
    ds_read_b128 v[136:139], v168 offset:40960
    s_waitcnt lgkmcnt(5)
    v_mfma_f32_16x16x32_bf16 v[92:95], v[148:151], a[252:255], v[92:95]
    v_mfma_f32_16x16x32_bf16 v[88:91], v[148:151], a[248:251], v[88:91]
    v_mfma_f32_16x16x32_bf16 v[84:87], v[148:151], a[244:247], v[84:87]
    v_mfma_f32_16x16x32_bf16 v[80:83], v[148:151], a[240:243], v[80:83]
    ds_read_b128 v[140:143], v169 offset:40960
    v_accvgpr_read_b32 v240, a96
    v_accvgpr_read_b32 v241, a97
    v_accvgpr_read_b32 v242, a98
    v_accvgpr_read_b32 v243, a99
    v_mul_f32 v96, v236, v96
    s_waitcnt lgkmcnt(5)
    v_mfma_f32_16x16x32_bf16 v[80:83], v[152:155], a[128:131], v[80:83]
    v_mul_f32 v97, v236, v97
    v_mul_f32 v98, v236, v98
    v_mul_f32 v99, v236, v99
    v_fmac_f32 v96, v232, v240
    v_fmac_f32 v97, v232, v241
    v_fmac_f32 v98, v232, v242
    v_mfma_f32_16x16x32_bf16 v[84:87], v[152:155], a[132:135], v[84:87]
    v_fmac_f32 v99, v232, v243
    v_cvt_pk_bf16_f32 v96, v96, v97
    v_cvt_pk_bf16_f32 v97, v98, v99
    v_accvgpr_read_b32 v244, a100
    v_accvgpr_read_b32 v245, a101
    v_accvgpr_read_b32 v246, a102
    v_mfma_f32_16x16x32_bf16 v[88:91], v[152:155], a[136:139], v[88:91]
    v_accvgpr_read_b32 v247, a103
    v_mul_f32 v100, v237, v100
    v_mul_f32 v101, v237, v101
    v_mul_f32 v102, v237, v102
    v_mul_f32 v103, v237, v103
    v_fmac_f32 v100, v233, v244
    v_mfma_f32_16x16x32_bf16 v[92:95], v[152:155], a[140:143], v[92:95]
    ds_read_b128 v[144:147], v168 offset:57344
    v_fmac_f32 v101, v233, v245
    v_fmac_f32 v102, v233, v246
    v_fmac_f32 v103, v233, v247
    v_cvt_pk_bf16_f32 v98, v100, v101
    v_cvt_pk_bf16_f32 v99, v102, v103
    s_waitcnt lgkmcnt(5)
    v_mfma_f32_16x16x32_bf16 v[92:95], v[156:159], a[156:159], v[92:95]
    buffer_store_dwordx4 v[96:99], v179, s[16:19], s85 offen offset:0 sc1
    v_accvgpr_read_b32 v240, a104
    v_accvgpr_read_b32 v241, a105
    v_accvgpr_read_b32 v242, a106
    v_accvgpr_read_b32 v243, a107
    v_mul_f32 v104, v238, v104
    v_mfma_f32_16x16x32_bf16 v[88:91], v[156:159], a[152:155], v[88:91]
    v_mul_f32 v105, v238, v105
    v_mul_f32 v106, v238, v106
    v_mul_f32 v107, v238, v107
    v_fmac_f32 v104, v234, v240
    v_fmac_f32 v105, v234, v241
    v_fmac_f32 v106, v234, v242
    v_mfma_f32_16x16x32_bf16 v[84:87], v[156:159], a[148:151], v[84:87]
    v_fmac_f32 v107, v234, v243
    v_cvt_pk_bf16_f32 v104, v104, v105
    v_cvt_pk_bf16_f32 v105, v106, v107
    v_accvgpr_read_b32 v244, a108
    v_accvgpr_read_b32 v245, a109
    v_accvgpr_read_b32 v246, a110
    v_mfma_f32_16x16x32_bf16 v[80:83], v[156:159], a[144:147], v[80:83]
    ds_read_b128 v[148:151], v169 offset:57344
    v_accvgpr_read_b32 v247, a111
    v_mul_f32 v108, v239, v108
    v_mul_f32 v109, v239, v109
    v_mul_f32 v110, v239, v110
    v_mul_f32 v111, v239, v111
    s_waitcnt lgkmcnt(5)
    v_mfma_f32_16x16x32_bf16 v[80:83], v[128:131], a[160:163], v[80:83]
    v_fmac_f32 v108, v235, v244
    v_fmac_f32 v109, v235, v245
    v_fmac_f32 v110, v235, v246
    v_fmac_f32 v111, v235, v247
    v_cvt_pk_bf16_f32 v106, v108, v109
    v_cvt_pk_bf16_f32 v107, v110, v111
    v_mfma_f32_16x16x32_bf16 v[84:87], v[128:131], a[164:167], v[84:87]
    buffer_store_dwordx4 v[104:107], v179, s[16:19], s85 offen offset:1024 sc1
    s_mul_i32 s77, s100, 0xfffe4000
    s_add_u32 s77, s77, s33
    s_add_u32 s77, s77, 0x8e000
    buffer_load_dwordx4 a[96:99], v179, s[16:19], s77 offen offset:0 sc1
    v_mfma_f32_16x16x32_bf16 v[88:91], v[128:131], a[168:171], v[88:91]
    v_mfma_f32_16x16x32_bf16 v[92:95], v[128:131], a[172:175], v[92:95]
    ds_read_b128 v[152:155], v168 offset:8192
    buffer_load_dwordx4 a[100:103], v179, s[16:19], s77 offen offset:1024 sc1
    s_waitcnt lgkmcnt(5)
    v_mfma_f32_16x16x32_bf16 v[92:95], v[132:135], a[188:191], v[92:95]
    v_mfma_f32_16x16x32_bf16 v[88:91], v[132:135], a[184:187], v[88:91]
    buffer_load_dwordx4 a[104:107], v179, s[16:19], s77 offen offset:2048 sc1
    v_mfma_f32_16x16x32_bf16 v[84:87], v[132:135], a[180:183], v[84:87]
    v_mfma_f32_16x16x32_bf16 v[80:83], v[132:135], a[176:179], v[80:83]
    ds_read_b128 v[156:159], v169 offset:8192
    buffer_load_dwordx4 a[108:111], v179, s[16:19], s77 offen offset:3072 sc1
    s_waitcnt lgkmcnt(5)
    v_mfma_f32_16x16x32_bf16 v[64:67], v[136:139], a[224:227], v[64:67]
    v_mfma_f32_16x16x32_bf16 v[68:71], v[136:139], a[228:231], v[68:71]
    s_mul_i32 s77, s100, 0xfffe4000
    s_add_u32 s77, s77, s33
    s_add_u32 s77, s77, 0x8f000
    buffer_load_dwordx4 a[112:115], v179, s[16:19], s77 offen offset:0 sc1
    v_mfma_f32_16x16x32_bf16 v[72:75], v[136:139], a[232:235], v[72:75]
    v_mfma_f32_16x16x32_bf16 v[76:79], v[136:139], a[236:239], v[76:79]
    ds_read_b128 v[128:131], v168 offset:38912
    buffer_load_dwordx4 a[116:119], v179, s[16:19], s77 offen offset:1024 sc1
    s_waitcnt lgkmcnt(5)
    v_mfma_f32_16x16x32_bf16 v[76:79], v[140:143], a[252:255], v[76:79]
    v_mfma_f32_16x16x32_bf16 v[72:75], v[140:143], a[248:251], v[72:75]
    buffer_load_dwordx4 a[120:123], v179, s[16:19], s77 offen offset:2048 sc1
    v_mfma_f32_16x16x32_bf16 v[68:71], v[140:143], a[244:247], v[68:71]
    v_mfma_f32_16x16x32_bf16 v[64:67], v[140:143], a[240:243], v[64:67]
    ds_read_b128 v[132:135], v169 offset:38912
    buffer_load_dwordx4 a[124:127], v179, s[16:19], s77 offen offset:3072 sc1
    s_waitcnt lgkmcnt(5)
    v_mfma_f32_16x16x32_bf16 v[64:67], v[144:147], a[128:131], v[64:67]
    v_mfma_f32_16x16x32_bf16 v[68:71], v[144:147], a[132:135], v[68:71]
    v_accvgpr_read_b32 v240, a80
    v_accvgpr_read_b32 v241, a81
    v_accvgpr_read_b32 v242, a82
    v_accvgpr_read_b32 v243, a83
    v_mul_f32 v80, v236, v80
    v_mul_f32 v81, v236, v81
    v_mfma_f32_16x16x32_bf16 v[72:75], v[144:147], a[136:139], v[72:75]
    v_mul_f32 v82, v236, v82
    v_mul_f32 v83, v236, v83
    v_fmac_f32 v80, v232, v240
    v_fmac_f32 v81, v232, v241
    v_fmac_f32 v82, v232, v242
    v_fmac_f32 v83, v232, v243
    v_mfma_f32_16x16x32_bf16 v[76:79], v[144:147], a[140:143], v[76:79]
    ds_read_b128 v[136:139], v168 offset:55296
    v_cvt_pk_bf16_f32 v80, v80, v81
    v_cvt_pk_bf16_f32 v81, v82, v83
    v_accvgpr_read_b32 v244, a84
    v_accvgpr_read_b32 v245, a85
    v_accvgpr_read_b32 v246, a86
    s_waitcnt lgkmcnt(5)
    v_mfma_f32_16x16x32_bf16 v[76:79], v[148:151], a[156:159], v[76:79]
    v_accvgpr_read_b32 v247, a87
    v_mul_f32 v84, v237, v84
    v_mul_f32 v85, v237, v85
    v_mul_f32 v86, v237, v86
    v_mul_f32 v87, v237, v87
    v_fmac_f32 v84, v233, v244
    v_mfma_f32_16x16x32_bf16 v[72:75], v[148:151], a[152:155], v[72:75]
    v_fmac_f32 v85, v233, v245
    v_fmac_f32 v86, v233, v246
    v_fmac_f32 v87, v233, v247
    v_cvt_pk_bf16_f32 v82, v84, v85
    v_cvt_pk_bf16_f32 v83, v86, v87
    buffer_store_dwordx4 v[80:83], v179, s[16:19], s84 offen offset:2048 sc1
    v_mfma_f32_16x16x32_bf16 v[68:71], v[148:151], a[148:151], v[68:71]
    v_accvgpr_read_b32 v240, a88
    v_accvgpr_read_b32 v241, a89
    v_accvgpr_read_b32 v242, a90
    v_accvgpr_read_b32 v243, a91
    v_mul_f32 v88, v238, v88
    v_mul_f32 v89, v238, v89
    v_mfma_f32_16x16x32_bf16 v[64:67], v[148:151], a[144:147], v[64:67]
    ds_read_b128 v[140:143], v169 offset:55296
    v_mul_f32 v90, v238, v90
    v_mul_f32 v91, v238, v91
    v_fmac_f32 v88, v234, v240
    v_fmac_f32 v89, v234, v241
    v_fmac_f32 v90, v234, v242
    s_waitcnt lgkmcnt(5)
    v_mfma_f32_16x16x32_bf16 v[64:67], v[152:155], a[160:163], v[64:67]
    v_fmac_f32 v91, v234, v243
    v_cvt_pk_bf16_f32 v88, v88, v89
    v_cvt_pk_bf16_f32 v89, v90, v91
    v_accvgpr_read_b32 v244, a92
    v_accvgpr_read_b32 v245, a93
    v_accvgpr_read_b32 v246, a94
    v_mfma_f32_16x16x32_bf16 v[68:71], v[152:155], a[164:167], v[68:71]
    v_accvgpr_read_b32 v247, a95
    v_mul_f32 v92, v239, v92
    v_mul_f32 v93, v239, v93
    v_mul_f32 v94, v239, v94
    v_mul_f32 v95, v239, v95
    v_fmac_f32 v92, v235, v244
    v_mfma_f32_16x16x32_bf16 v[72:75], v[152:155], a[168:171], v[72:75]
    v_fmac_f32 v93, v235, v245
    v_fmac_f32 v94, v235, v246
    v_fmac_f32 v95, v235, v247
    v_cvt_pk_bf16_f32 v90, v92, v93
    v_cvt_pk_bf16_f32 v91, v94, v95
    buffer_store_dwordx4 v[88:91], v179, s[16:19], s84 offen offset:3072 sc1
    v_mfma_f32_16x16x32_bf16 v[76:79], v[152:155], a[172:175], v[76:79]
    ds_read_b128 v[144:147], v168 offset:6144
    s_waitcnt lgkmcnt(5)
    v_mfma_f32_16x16x32_bf16 v[76:79], v[156:159], a[188:191], v[76:79]
    v_mfma_f32_16x16x32_bf16 v[72:75], v[156:159], a[184:187], v[72:75]
    v_mfma_f32_16x16x32_bf16 v[68:71], v[156:159], a[180:183], v[68:71]
    v_mfma_f32_16x16x32_bf16 v[64:67], v[156:159], a[176:179], v[64:67]
    ds_read_b128 v[148:151], v169 offset:6144
    s_waitcnt lgkmcnt(5)
    v_mfma_f32_16x16x32_bf16 v[48:51], v[128:131], a[224:227], v[48:51]
    v_mfma_f32_16x16x32_bf16 v[52:55], v[128:131], a[228:231], v[52:55]
    v_mfma_f32_16x16x32_bf16 v[56:59], v[128:131], a[232:235], v[56:59]
    v_mfma_f32_16x16x32_bf16 v[60:63], v[128:131], a[236:239], v[60:63]
    ds_read_b128 v[152:155], v168 offset:36864
    s_waitcnt lgkmcnt(5)
    v_mfma_f32_16x16x32_bf16 v[60:63], v[132:135], a[252:255], v[60:63]
    v_mfma_f32_16x16x32_bf16 v[56:59], v[132:135], a[248:251], v[56:59]
    v_mfma_f32_16x16x32_bf16 v[52:55], v[132:135], a[244:247], v[52:55]
    v_mfma_f32_16x16x32_bf16 v[48:51], v[132:135], a[240:243], v[48:51]
    ds_read_b128 v[156:159], v169 offset:36864
    v_accvgpr_read_b32 v240, a64
    v_accvgpr_read_b32 v241, a65
    v_accvgpr_read_b32 v242, a66
    v_accvgpr_read_b32 v243, a67
    v_mul_f32 v64, v236, v64
    s_waitcnt lgkmcnt(5)
    v_mfma_f32_16x16x32_bf16 v[48:51], v[136:139], a[128:131], v[48:51]
    v_mul_f32 v65, v236, v65
    v_mul_f32 v66, v236, v66
    v_mul_f32 v67, v236, v67
    v_fmac_f32 v64, v232, v240
    v_fmac_f32 v65, v232, v241
    v_fmac_f32 v66, v232, v242
    v_mfma_f32_16x16x32_bf16 v[52:55], v[136:139], a[132:135], v[52:55]
    v_fmac_f32 v67, v232, v243
    v_cvt_pk_bf16_f32 v64, v64, v65
    v_cvt_pk_bf16_f32 v65, v66, v67
    v_accvgpr_read_b32 v244, a68
    v_accvgpr_read_b32 v245, a69
    v_accvgpr_read_b32 v246, a70
    v_mfma_f32_16x16x32_bf16 v[56:59], v[136:139], a[136:139], v[56:59]
    v_accvgpr_read_b32 v247, a71
    v_mul_f32 v68, v237, v68
    v_mul_f32 v69, v237, v69
    v_mul_f32 v70, v237, v70
    v_mul_f32 v71, v237, v71
    v_fmac_f32 v68, v233, v244
    v_mfma_f32_16x16x32_bf16 v[60:63], v[136:139], a[140:143], v[60:63]
    ds_read_b128 v[128:131], v168 offset:53248
    v_fmac_f32 v69, v233, v245
    v_fmac_f32 v70, v233, v246
    v_fmac_f32 v71, v233, v247
    v_cvt_pk_bf16_f32 v66, v68, v69
    v_cvt_pk_bf16_f32 v67, v70, v71
    s_waitcnt lgkmcnt(5)
    v_mfma_f32_16x16x32_bf16 v[60:63], v[140:143], a[156:159], v[60:63]
    buffer_store_dwordx4 v[64:67], v179, s[16:19], s84 offen offset:0 sc1
    v_accvgpr_read_b32 v240, a72
    v_accvgpr_read_b32 v241, a73
    v_accvgpr_read_b32 v242, a74
    v_accvgpr_read_b32 v243, a75
    v_mul_f32 v72, v238, v72
    v_mfma_f32_16x16x32_bf16 v[56:59], v[140:143], a[152:155], v[56:59]
    v_mul_f32 v73, v238, v73
    v_mul_f32 v74, v238, v74
    v_mul_f32 v75, v238, v75
    v_fmac_f32 v72, v234, v240
    v_fmac_f32 v73, v234, v241
    v_fmac_f32 v74, v234, v242
    v_mfma_f32_16x16x32_bf16 v[52:55], v[140:143], a[148:151], v[52:55]
    v_fmac_f32 v75, v234, v243
    v_cvt_pk_bf16_f32 v72, v72, v73
    v_cvt_pk_bf16_f32 v73, v74, v75
    v_accvgpr_read_b32 v244, a76
    v_accvgpr_read_b32 v245, a77
    v_accvgpr_read_b32 v246, a78
    v_mfma_f32_16x16x32_bf16 v[48:51], v[140:143], a[144:147], v[48:51]
    ds_read_b128 v[132:135], v169 offset:53248
    v_accvgpr_read_b32 v247, a79
    v_mul_f32 v76, v239, v76
    v_mul_f32 v77, v239, v77
    v_mul_f32 v78, v239, v78
    v_mul_f32 v79, v239, v79
    s_waitcnt lgkmcnt(5)
    v_mfma_f32_16x16x32_bf16 v[48:51], v[144:147], a[160:163], v[48:51]
    v_fmac_f32 v76, v235, v244
    v_fmac_f32 v77, v235, v245
    v_fmac_f32 v78, v235, v246
    v_fmac_f32 v79, v235, v247
    v_cvt_pk_bf16_f32 v74, v76, v77
    v_cvt_pk_bf16_f32 v75, v78, v79
    v_mfma_f32_16x16x32_bf16 v[52:55], v[144:147], a[164:167], v[52:55]
    buffer_store_dwordx4 v[72:75], v179, s[16:19], s84 offen offset:1024 sc1
    s_mul_i32 s77, s100, 0xfffe4000
    s_add_u32 s77, s77, s33
    s_add_u32 s77, s77, 0x9e000
    buffer_load_dwordx4 a[64:67], v179, s[16:19], s77 offen offset:0 sc1
    v_mfma_f32_16x16x32_bf16 v[56:59], v[144:147], a[168:171], v[56:59]
    v_mfma_f32_16x16x32_bf16 v[60:63], v[144:147], a[172:175], v[60:63]
    ds_read_b128 v[136:139], v168 offset:4096
    buffer_load_dwordx4 a[68:71], v179, s[16:19], s77 offen offset:1024 sc1
    s_waitcnt lgkmcnt(5)
    v_mfma_f32_16x16x32_bf16 v[60:63], v[148:151], a[188:191], v[60:63]
    v_mfma_f32_16x16x32_bf16 v[56:59], v[148:151], a[184:187], v[56:59]
    buffer_load_dwordx4 a[72:75], v179, s[16:19], s77 offen offset:2048 sc1
    v_mfma_f32_16x16x32_bf16 v[52:55], v[148:151], a[180:183], v[52:55]
    v_mfma_f32_16x16x32_bf16 v[48:51], v[148:151], a[176:179], v[48:51]
    ds_read_b128 v[140:143], v169 offset:4096
    buffer_load_dwordx4 a[76:79], v179, s[16:19], s77 offen offset:3072 sc1
    s_waitcnt lgkmcnt(5)
    v_mfma_f32_16x16x32_bf16 v[32:35], v[152:155], a[224:227], v[32:35]
    v_mfma_f32_16x16x32_bf16 v[36:39], v[152:155], a[228:231], v[36:39]
    s_mul_i32 s77, s100, 0xfffe4000
    s_add_u32 s77, s77, s33
    s_add_u32 s77, s77, 0x9f000
    buffer_load_dwordx4 a[80:83], v179, s[16:19], s77 offen offset:0 sc1
    v_mfma_f32_16x16x32_bf16 v[40:43], v[152:155], a[232:235], v[40:43]
    v_mfma_f32_16x16x32_bf16 v[44:47], v[152:155], a[236:239], v[44:47]
    ds_read_b128 v[144:147], v168 offset:32768
    buffer_load_dwordx4 a[84:87], v179, s[16:19], s77 offen offset:1024 sc1
    s_waitcnt lgkmcnt(5)
    v_mfma_f32_16x16x32_bf16 v[44:47], v[156:159], a[252:255], v[44:47]
    v_mfma_f32_16x16x32_bf16 v[40:43], v[156:159], a[248:251], v[40:43]
    buffer_load_dwordx4 a[88:91], v179, s[16:19], s77 offen offset:2048 sc1
    v_mfma_f32_16x16x32_bf16 v[36:39], v[156:159], a[244:247], v[36:39]
    v_mfma_f32_16x16x32_bf16 v[32:35], v[156:159], a[240:243], v[32:35]
    ds_read_b128 v[148:151], v169 offset:32768
    buffer_load_dwordx4 a[92:95], v179, s[16:19], s77 offen offset:3072 sc1
    s_waitcnt lgkmcnt(5)
    v_mfma_f32_16x16x32_bf16 v[32:35], v[128:131], a[128:131], v[32:35]
    v_mfma_f32_16x16x32_bf16 v[36:39], v[128:131], a[132:135], v[36:39]
    v_accvgpr_read_b32 v240, a48
    v_accvgpr_read_b32 v241, a49
    v_accvgpr_read_b32 v242, a50
    v_accvgpr_read_b32 v243, a51
    v_mul_f32 v48, v236, v48
    v_mul_f32 v49, v236, v49
    v_mfma_f32_16x16x32_bf16 v[40:43], v[128:131], a[136:139], v[40:43]
    v_mul_f32 v50, v236, v50
    v_mul_f32 v51, v236, v51
    v_fmac_f32 v48, v232, v240
    v_fmac_f32 v49, v232, v241
    v_fmac_f32 v50, v232, v242
    v_fmac_f32 v51, v232, v243
    v_mfma_f32_16x16x32_bf16 v[44:47], v[128:131], a[140:143], v[44:47]
    ds_read_b128 v[152:155], v168 offset:49152
    v_cvt_pk_bf16_f32 v48, v48, v49
    v_cvt_pk_bf16_f32 v49, v50, v51
    v_accvgpr_read_b32 v244, a52
    v_accvgpr_read_b32 v245, a53
    v_accvgpr_read_b32 v246, a54
    s_waitcnt lgkmcnt(5)
    v_mfma_f32_16x16x32_bf16 v[44:47], v[132:135], a[156:159], v[44:47]
    v_accvgpr_read_b32 v247, a55
    v_mul_f32 v52, v237, v52
    v_mul_f32 v53, v237, v53
    v_mul_f32 v54, v237, v54
    v_mul_f32 v55, v237, v55
    v_fmac_f32 v52, v233, v244
    v_mfma_f32_16x16x32_bf16 v[40:43], v[132:135], a[152:155], v[40:43]
    v_fmac_f32 v53, v233, v245
    v_fmac_f32 v54, v233, v246
    v_fmac_f32 v55, v233, v247
    v_cvt_pk_bf16_f32 v50, v52, v53
    v_cvt_pk_bf16_f32 v51, v54, v55
    buffer_store_dwordx4 v[48:51], v179, s[16:19], s83 offen offset:2048 sc1
    v_mfma_f32_16x16x32_bf16 v[36:39], v[132:135], a[148:151], v[36:39]
    v_accvgpr_read_b32 v240, a56
    v_accvgpr_read_b32 v241, a57
    v_accvgpr_read_b32 v242, a58
    v_accvgpr_read_b32 v243, a59
    v_mul_f32 v56, v238, v56
    v_mul_f32 v57, v238, v57
    v_mfma_f32_16x16x32_bf16 v[32:35], v[132:135], a[144:147], v[32:35]
    ds_read_b128 v[156:159], v169 offset:49152
    v_mul_f32 v58, v238, v58
    v_mul_f32 v59, v238, v59
    v_fmac_f32 v56, v234, v240
    v_fmac_f32 v57, v234, v241
    v_fmac_f32 v58, v234, v242
    s_waitcnt lgkmcnt(5)
    v_mfma_f32_16x16x32_bf16 v[32:35], v[136:139], a[160:163], v[32:35]
    v_fmac_f32 v59, v234, v243
    v_cvt_pk_bf16_f32 v56, v56, v57
    v_cvt_pk_bf16_f32 v57, v58, v59
    v_accvgpr_read_b32 v244, a60
    v_accvgpr_read_b32 v245, a61
    v_accvgpr_read_b32 v246, a62
    v_mfma_f32_16x16x32_bf16 v[36:39], v[136:139], a[164:167], v[36:39]
    v_accvgpr_read_b32 v247, a63
    v_mul_f32 v60, v239, v60
    v_mul_f32 v61, v239, v61
    v_mul_f32 v62, v239, v62
    v_mul_f32 v63, v239, v63
    v_fmac_f32 v60, v235, v244
    v_mfma_f32_16x16x32_bf16 v[40:43], v[136:139], a[168:171], v[40:43]
    v_fmac_f32 v61, v235, v245
    v_fmac_f32 v62, v235, v246
    v_fmac_f32 v63, v235, v247
    v_cvt_pk_bf16_f32 v58, v60, v61
    v_cvt_pk_bf16_f32 v59, v62, v63
    buffer_store_dwordx4 v[56:59], v179, s[16:19], s83 offen offset:3072 sc1
    v_mfma_f32_16x16x32_bf16 v[44:47], v[136:139], a[172:175], v[44:47]
    ds_read_b128 v[128:131], v168 offset:0
    s_waitcnt lgkmcnt(5)
    v_mfma_f32_16x16x32_bf16 v[44:47], v[140:143], a[188:191], v[44:47]
    v_mfma_f32_16x16x32_bf16 v[40:43], v[140:143], a[184:187], v[40:43]
    v_mfma_f32_16x16x32_bf16 v[36:39], v[140:143], a[180:183], v[36:39]
    v_mfma_f32_16x16x32_bf16 v[32:35], v[140:143], a[176:179], v[32:35]
    ds_read_b128 v[132:135], v169 offset:0
    s_waitcnt lgkmcnt(5)
    v_mfma_f32_16x16x32_bf16 v[0:3], v[144:147], a[224:227], v[0:3]
    v_mfma_f32_16x16x32_bf16 v[4:7], v[144:147], a[228:231], v[4:7]
    v_mfma_f32_16x16x32_bf16 v[8:11], v[144:147], a[232:235], v[8:11]
    v_mfma_f32_16x16x32_bf16 v[12:15], v[144:147], a[236:239], v[12:15]
    ds_read_b128 v[136:139], v168 offset:34816
    s_waitcnt lgkmcnt(5)
    v_mfma_f32_16x16x32_bf16 v[12:15], v[148:151], a[252:255], v[12:15]
    v_mfma_f32_16x16x32_bf16 v[8:11], v[148:151], a[248:251], v[8:11]
    v_mfma_f32_16x16x32_bf16 v[4:7], v[148:151], a[244:247], v[4:7]
    v_mfma_f32_16x16x32_bf16 v[0:3], v[148:151], a[240:243], v[0:3]
    ds_read_b128 v[140:143], v169 offset:34816
    v_accvgpr_read_b32 v240, a32
    v_accvgpr_read_b32 v241, a33
    v_accvgpr_read_b32 v242, a34
    v_accvgpr_read_b32 v243, a35
    v_mul_f32 v32, v236, v32
    s_waitcnt lgkmcnt(5)
    v_mfma_f32_16x16x32_bf16 v[0:3], v[152:155], a[128:131], v[0:3]
    v_mul_f32 v33, v236, v33
    v_mul_f32 v34, v236, v34
    v_mul_f32 v35, v236, v35
    v_fmac_f32 v32, v232, v240
    v_fmac_f32 v33, v232, v241
    v_fmac_f32 v34, v232, v242
    v_mfma_f32_16x16x32_bf16 v[4:7], v[152:155], a[132:135], v[4:7]
    v_fmac_f32 v35, v232, v243
    v_cvt_pk_bf16_f32 v32, v32, v33
    v_cvt_pk_bf16_f32 v33, v34, v35
    v_accvgpr_read_b32 v244, a36
    v_accvgpr_read_b32 v245, a37
    v_accvgpr_read_b32 v246, a38
    v_mfma_f32_16x16x32_bf16 v[8:11], v[152:155], a[136:139], v[8:11]
    v_accvgpr_read_b32 v247, a39
    v_mul_f32 v36, v237, v36
    v_mul_f32 v37, v237, v37
    v_mul_f32 v38, v237, v38
    v_mul_f32 v39, v237, v39
    v_fmac_f32 v36, v233, v244
    v_mfma_f32_16x16x32_bf16 v[12:15], v[152:155], a[140:143], v[12:15]
    ds_read_b128 v[144:147], v168 offset:51200
    v_fmac_f32 v37, v233, v245
    v_fmac_f32 v38, v233, v246
    v_fmac_f32 v39, v233, v247
    v_cvt_pk_bf16_f32 v34, v36, v37
    v_cvt_pk_bf16_f32 v35, v38, v39
    s_waitcnt lgkmcnt(5)
    v_mfma_f32_16x16x32_bf16 v[12:15], v[156:159], a[156:159], v[12:15]
    buffer_store_dwordx4 v[32:35], v179, s[16:19], s83 offen offset:0 sc1
    v_accvgpr_read_b32 v240, a40
    v_accvgpr_read_b32 v241, a41
    v_accvgpr_read_b32 v242, a42
    v_accvgpr_read_b32 v243, a43
    v_mul_f32 v40, v238, v40
    v_mfma_f32_16x16x32_bf16 v[8:11], v[156:159], a[152:155], v[8:11]
    v_mul_f32 v41, v238, v41
    v_mul_f32 v42, v238, v42
    v_mul_f32 v43, v238, v43
    v_fmac_f32 v40, v234, v240
    v_fmac_f32 v41, v234, v241
    v_fmac_f32 v42, v234, v242
    v_mfma_f32_16x16x32_bf16 v[4:7], v[156:159], a[148:151], v[4:7]
    v_fmac_f32 v43, v234, v243
    v_cvt_pk_bf16_f32 v40, v40, v41
    v_cvt_pk_bf16_f32 v41, v42, v43
    v_accvgpr_read_b32 v244, a44
    v_accvgpr_read_b32 v245, a45
    v_accvgpr_read_b32 v246, a46
    v_mfma_f32_16x16x32_bf16 v[0:3], v[156:159], a[144:147], v[0:3]
    ds_read_b128 v[148:151], v169 offset:51200
    v_accvgpr_read_b32 v247, a47
    v_mul_f32 v44, v239, v44
    v_mul_f32 v45, v239, v45
    v_mul_f32 v46, v239, v46
    v_mul_f32 v47, v239, v47
    s_waitcnt lgkmcnt(5)
    v_mfma_f32_16x16x32_bf16 v[0:3], v[128:131], a[160:163], v[0:3]
    v_fmac_f32 v44, v235, v244
    v_fmac_f32 v45, v235, v245
    v_fmac_f32 v46, v235, v246
    v_fmac_f32 v47, v235, v247
    v_cvt_pk_bf16_f32 v42, v44, v45
    v_cvt_pk_bf16_f32 v43, v46, v47
    v_mfma_f32_16x16x32_bf16 v[4:7], v[128:131], a[164:167], v[4:7]
    buffer_store_dwordx4 v[40:43], v179, s[16:19], s83 offen offset:1024 sc1
    s_mul_i32 s77, s100, 0xfffe4000
    s_add_u32 s77, s77, s33
    s_add_u32 s77, s77, 0xae000
    buffer_load_dwordx4 a[32:35], v179, s[16:19], s77 offen offset:0 sc1
    v_mfma_f32_16x16x32_bf16 v[8:11], v[128:131], a[168:171], v[8:11]
    v_mfma_f32_16x16x32_bf16 v[12:15], v[128:131], a[172:175], v[12:15]
    ds_read_b128 v[152:155], v168 offset:2048
    buffer_load_dwordx4 a[36:39], v179, s[16:19], s77 offen offset:1024 sc1
    s_waitcnt lgkmcnt(5)
    v_mfma_f32_16x16x32_bf16 v[12:15], v[132:135], a[188:191], v[12:15]
    v_mfma_f32_16x16x32_bf16 v[8:11], v[132:135], a[184:187], v[8:11]
    buffer_load_dwordx4 a[40:43], v179, s[16:19], s77 offen offset:2048 sc1
    v_mfma_f32_16x16x32_bf16 v[4:7], v[132:135], a[180:183], v[4:7]
    v_mfma_f32_16x16x32_bf16 v[0:3], v[132:135], a[176:179], v[0:3]
    ds_read_b128 v[156:159], v169 offset:2048
    buffer_load_dwordx4 a[44:47], v179, s[16:19], s77 offen offset:3072 sc1
    s_waitcnt lgkmcnt(5)
    v_mfma_f32_16x16x32_bf16 v[16:19], v[136:139], a[224:227], v[16:19]
    v_mfma_f32_16x16x32_bf16 v[20:23], v[136:139], a[228:231], v[20:23]
    s_mul_i32 s77, s100, 0xfffe4000
    s_add_u32 s77, s77, s33
    s_add_u32 s77, s77, 0xaf000
    buffer_load_dwordx4 a[48:51], v179, s[16:19], s77 offen offset:0 sc1
    v_mfma_f32_16x16x32_bf16 v[24:27], v[136:139], a[232:235], v[24:27]
    v_mfma_f32_16x16x32_bf16 v[28:31], v[136:139], a[236:239], v[28:31]
    s_waitcnt vmcnt(41)
    s_barrier
    ds_read_b128 v[128:131], v168 offset:16384
    buffer_load_dwordx4 a[52:55], v179, s[16:19], s77 offen offset:1024 sc1
    s_waitcnt lgkmcnt(5)
    v_mfma_f32_16x16x32_bf16 v[28:31], v[140:143], a[252:255], v[28:31]
    v_mfma_f32_16x16x32_bf16 v[24:27], v[140:143], a[248:251], v[24:27]
    buffer_load_dwordx4 a[56:59], v179, s[16:19], s77 offen offset:2048 sc1
    v_mfma_f32_16x16x32_bf16 v[20:23], v[140:143], a[244:247], v[20:23]
    v_mfma_f32_16x16x32_bf16 v[16:19], v[140:143], a[240:243], v[16:19]
    ds_read_b128 v[132:135], v168 offset:18432
    buffer_load_dwordx4 a[60:63], v179, s[16:19], s77 offen offset:3072 sc1
    s_waitcnt lgkmcnt(5)
    v_mfma_f32_16x16x32_bf16 v[16:19], v[144:147], a[128:131], v[16:19]
    v_mfma_f32_16x16x32_bf16 v[20:23], v[144:147], a[132:135], v[20:23]
    s_lshl_b32 s81, 1, s100
    s_xor_b32 s81, s81, 15
    v_mfma_f32_16x16x32_bf16 v[24:27], v[144:147], a[136:139], v[24:27]
    v_mfma_f32_16x16x32_bf16 v[28:31], v[144:147], a[140:143], v[28:31]
    ds_read_b128 v[136:139], v169 offset:16384
    s_waitcnt lgkmcnt(5)
    v_mfma_f32_16x16x32_bf16 v[28:31], v[148:151], a[156:159], v[28:31]
    v_mfma_f32_16x16x32_bf16 v[24:27], v[148:151], a[152:155], v[24:27]
    v_mfma_f32_16x16x32_bf16 v[20:23], v[148:151], a[148:151], v[20:23]
    v_mfma_f32_16x16x32_bf16 v[16:19], v[148:151], a[144:147], v[16:19]
    ds_read_b128 v[140:143], v169 offset:18432
    s_waitcnt lgkmcnt(5)
    v_mfma_f32_16x16x32_bf16 v[16:19], v[152:155], a[160:163], v[16:19]
    v_mfma_f32_16x16x32_bf16 v[20:23], v[152:155], a[164:167], v[20:23]
    v_mfma_f32_16x16x32_bf16 v[24:27], v[152:155], a[168:171], v[24:27]
    v_mfma_f32_16x16x32_bf16 v[28:31], v[152:155], a[172:175], v[28:31]
    ds_read_b128 v[144:147], v168 offset:20480
    s_waitcnt lgkmcnt(5)
    v_mfma_f32_16x16x32_bf16 v[28:31], v[156:159], a[188:191], v[28:31]
    v_mfma_f32_16x16x32_bf16 v[24:27], v[156:159], a[184:187], v[24:27]
    v_mfma_f32_16x16x32_bf16 v[20:23], v[156:159], a[180:183], v[20:23]
    v_mfma_f32_16x16x32_bf16 v[16:19], v[156:159], a[176:179], v[16:19]
    ds_read_b128 v[148:151], v168 offset:22528
    s_waitcnt vmcnt(36)
    s_waitcnt vmcnt(8)
    s_mov_b64 exec, 0x20
    buffer_store_dword v203, v248, s[16:19], 0 offen sc1
    s_mov_b64 exec, -1
    s_waitcnt lgkmcnt(5)
    v_mfma_f32_16x16x32_bf16 v[0:3], v[128:131], a[192:195], v[0:3]
    v_mfma_f32_16x16x32_bf16 v[4:7], v[128:131], a[196:199], v[4:7]
    v_mfma_f32_16x16x32_bf16 v[8:11], v[128:131], a[200:203], v[8:11]
    v_mfma_f32_16x16x32_bf16 v[12:15], v[128:131], a[204:207], v[12:15]
    ds_read_b128 v[152:155], v169 offset:20480
    s_waitcnt lgkmcnt(5)
    v_mfma_f32_16x16x32_bf16 v[28:31], v[132:135], a[204:207], v[28:31]
    v_mfma_f32_16x16x32_bf16 v[24:27], v[132:135], a[200:203], v[24:27]
    v_mfma_f32_16x16x32_bf16 v[20:23], v[132:135], a[196:199], v[20:23]
    v_mfma_f32_16x16x32_bf16 v[16:19], v[132:135], a[192:195], v[16:19]
    ds_read_b128 v[156:159], v169 offset:22528
    s_waitcnt lgkmcnt(5)
    v_mfma_f32_16x16x32_bf16 v[0:3], v[136:139], a[208:211], v[0:3]
    v_mfma_f32_16x16x32_bf16 v[4:7], v[136:139], a[212:215], v[4:7]
    v_mfma_f32_16x16x32_bf16 v[8:11], v[136:139], a[216:219], v[8:11]
    v_mfma_f32_16x16x32_bf16 v[12:15], v[136:139], a[220:223], v[12:15]
    ds_read_b128 v[128:131], v168 offset:24576
    s_waitcnt lgkmcnt(5)
    v_mfma_f32_16x16x32_bf16 v[28:31], v[140:143], a[220:223], v[28:31]
    v_mfma_f32_16x16x32_bf16 v[24:27], v[140:143], a[216:219], v[24:27]
    v_mfma_f32_16x16x32_bf16 v[20:23], v[140:143], a[212:215], v[20:23]
    v_mfma_f32_16x16x32_bf16 v[16:19], v[140:143], a[208:211], v[16:19]
    ds_read_b128 v[132:135], v168 offset:26624
    s_waitcnt lgkmcnt(5)
    v_mfma_f32_16x16x32_bf16 v[0:3], v[144:147], a[96:99], v[0:3]
    v_mfma_f32_16x16x32_bf16 v[4:7], v[144:147], a[100:103], v[4:7]
    v_mfma_f32_16x16x32_bf16 v[8:11], v[144:147], a[104:107], v[8:11]
    v_mfma_f32_16x16x32_bf16 v[12:15], v[144:147], a[108:111], v[12:15]
    ds_read_b128 v[136:139], v169 offset:24576
    s_waitcnt lgkmcnt(5)
    v_mfma_f32_16x16x32_bf16 v[28:31], v[148:151], a[108:111], v[28:31]
    v_mfma_f32_16x16x32_bf16 v[24:27], v[148:151], a[104:107], v[24:27]
    v_mfma_f32_16x16x32_bf16 v[20:23], v[148:151], a[100:103], v[20:23]
    v_mfma_f32_16x16x32_bf16 v[16:19], v[148:151], a[96:99], v[16:19]
    ds_read_b128 v[140:143], v169 offset:26624
    s_waitcnt lgkmcnt(5)
    v_mfma_f32_16x16x32_bf16 v[0:3], v[152:155], a[112:115], v[0:3]
    v_mfma_f32_16x16x32_bf16 v[4:7], v[152:155], a[116:119], v[4:7]
    v_mfma_f32_16x16x32_bf16 v[8:11], v[152:155], a[120:123], v[8:11]
    v_mfma_f32_16x16x32_bf16 v[12:15], v[152:155], a[124:127], v[12:15]
    ds_read_b128 v[144:147], v168 offset:28672
    s_waitcnt lgkmcnt(5)
    v_mfma_f32_16x16x32_bf16 v[28:31], v[156:159], a[124:127], v[28:31]
    v_mfma_f32_16x16x32_bf16 v[24:27], v[156:159], a[120:123], v[24:27]
    v_mfma_f32_16x16x32_bf16 v[20:23], v[156:159], a[116:119], v[20:23]
    v_mfma_f32_16x16x32_bf16 v[16:19], v[156:159], a[112:115], v[16:19]
    ds_read_b128 v[148:151], v168 offset:30720
    s_waitcnt lgkmcnt(5)
    v_mfma_f32_16x16x32_bf16 v[0:3], v[128:131], a[64:67], v[0:3]
    v_mfma_f32_16x16x32_bf16 v[4:7], v[128:131], a[68:71], v[4:7]
    v_mfma_f32_16x16x32_bf16 v[8:11], v[128:131], a[72:75], v[8:11]
    v_mfma_f32_16x16x32_bf16 v[12:15], v[128:131], a[76:79], v[12:15]
    ds_read_b128 v[152:155], v169 offset:28672
    s_waitcnt lgkmcnt(5)
    v_mfma_f32_16x16x32_bf16 v[28:31], v[132:135], a[76:79], v[28:31]
    v_mfma_f32_16x16x32_bf16 v[24:27], v[132:135], a[72:75], v[24:27]
    v_mfma_f32_16x16x32_bf16 v[20:23], v[132:135], a[68:71], v[20:23]
    v_mfma_f32_16x16x32_bf16 v[16:19], v[132:135], a[64:67], v[16:19]
    ds_read_b128 v[156:159], v169 offset:30720
    s_waitcnt lgkmcnt(5)
    v_mfma_f32_16x16x32_bf16 v[0:3], v[136:139], a[80:83], v[0:3]
    v_mfma_f32_16x16x32_bf16 v[4:7], v[136:139], a[84:87], v[4:7]
    v_mfma_f32_16x16x32_bf16 v[8:11], v[136:139], a[88:91], v[8:11]
    v_mfma_f32_16x16x32_bf16 v[12:15], v[136:139], a[92:95], v[12:15]
    s_waitcnt lgkmcnt(4)
    v_mfma_f32_16x16x32_bf16 v[28:31], v[140:143], a[92:95], v[28:31]
    v_mfma_f32_16x16x32_bf16 v[24:27], v[140:143], a[88:91], v[24:27]
    v_mfma_f32_16x16x32_bf16 v[20:23], v[140:143], a[84:87], v[20:23]
    v_mfma_f32_16x16x32_bf16 v[16:19], v[140:143], a[80:83], v[16:19]
    s_waitcnt vmcnt(1)
    s_waitcnt lgkmcnt(3)
    v_mfma_f32_16x16x32_bf16 v[0:3], v[144:147], a[32:35], v[0:3]
    v_mfma_f32_16x16x32_bf16 v[4:7], v[144:147], a[36:39], v[4:7]
    buffer_load_dword v174, v175, s[16:19], s87 offen offset:0 sc1
    v_mfma_f32_16x16x32_bf16 v[8:11], v[144:147], a[40:43], v[8:11]
    v_mfma_f32_16x16x32_bf16 v[12:15], v[144:147], a[44:47], v[12:15]
    s_waitcnt lgkmcnt(2)
    v_mfma_f32_16x16x32_bf16 v[28:31], v[148:151], a[44:47], v[28:31]
    v_mfma_f32_16x16x32_bf16 v[24:27], v[148:151], a[40:43], v[24:27]
    v_mfma_f32_16x16x32_bf16 v[20:23], v[148:151], a[36:39], v[20:23]
    v_mfma_f32_16x16x32_bf16 v[16:19], v[148:151], a[32:35], v[16:19]
    s_waitcnt lgkmcnt(1)
    v_mfma_f32_16x16x32_bf16 v[0:3], v[152:155], a[48:51], v[0:3]
    v_mfma_f32_16x16x32_bf16 v[4:7], v[152:155], a[52:55], v[4:7]
    v_mfma_f32_16x16x32_bf16 v[8:11], v[152:155], a[56:59], v[8:11]
    v_mfma_f32_16x16x32_bf16 v[12:15], v[152:155], a[60:63], v[12:15]
    s_waitcnt lgkmcnt(0)
    v_mfma_f32_16x16x32_bf16 v[28:31], v[156:159], a[60:63], v[28:31]
    v_mfma_f32_16x16x32_bf16 v[24:27], v[156:159], a[56:59], v[24:27]
    v_mfma_f32_16x16x32_bf16 v[20:23], v[156:159], a[52:55], v[20:23]
    v_mfma_f32_16x16x32_bf16 v[16:19], v[156:159], a[48:51], v[16:19]
    s_nop 7
    v_accvgpr_read_b32 v240, a0
    v_accvgpr_read_b32 v241, a1
    v_accvgpr_read_b32 v242, a2
    v_accvgpr_read_b32 v243, a3
    v_mul_f32 v0, v236, v0
    v_mul_f32 v1, v236, v1
    v_mul_f32 v2, v236, v2
    v_mul_f32 v3, v236, v3
    v_fmac_f32 v0, v232, v240
    v_fmac_f32 v1, v232, v241
    v_fmac_f32 v2, v232, v242
    v_fmac_f32 v3, v232, v243
    v_accvgpr_read_b32 v244, a4
    v_accvgpr_read_b32 v245, a5
    v_accvgpr_read_b32 v246, a6
    v_accvgpr_read_b32 v247, a7
    v_mul_f32 v4, v237, v4
    v_mul_f32 v5, v237, v5
    v_mul_f32 v6, v237, v6
    v_mul_f32 v7, v237, v7
    v_fmac_f32 v4, v233, v244
    v_fmac_f32 v5, v233, v245
    v_fmac_f32 v6, v233, v246
    v_fmac_f32 v7, v233, v247
    v_accvgpr_read_b32 v240, a8
    v_accvgpr_read_b32 v241, a9
    v_accvgpr_read_b32 v242, a10
    v_accvgpr_read_b32 v243, a11
    v_mul_f32 v8, v238, v8
    v_mul_f32 v9, v238, v9
    v_mul_f32 v10, v238, v10
    v_mul_f32 v11, v238, v11
    v_fmac_f32 v8, v234, v240
    v_fmac_f32 v9, v234, v241
    v_fmac_f32 v10, v234, v242
    v_fmac_f32 v11, v234, v243
    v_accvgpr_read_b32 v244, a12
    v_accvgpr_read_b32 v245, a13
    v_accvgpr_read_b32 v246, a14
    v_accvgpr_read_b32 v247, a15
    v_mul_f32 v12, v239, v12
    v_mul_f32 v13, v239, v13
    v_mul_f32 v14, v239, v14
    v_mul_f32 v15, v239, v15
    v_fmac_f32 v12, v235, v244
    v_fmac_f32 v13, v235, v245
    v_fmac_f32 v14, v235, v246
    v_fmac_f32 v15, v235, v247
    s_waitcnt vmcnt(0)
    v_cmp_eq_u32 vcc, 1, v174
    s_and_b32 s89, vcc_lo, s81
    s_cmp_eq_u32 s89, s81
    s_cbranch_scc0 chk_8_slow
chk_8_ok:
    s_add_u32 s80, s86, 0x0
    buffer_load_dwordx4 v[32:35], v179, s[16:19], s80 offen offset:0 sc1
    buffer_load_dwordx4 v[36:39], v179, s[16:19], s80 offen offset:1024 sc1
    buffer_load_dwordx4 v[40:43], v179, s[16:19], s80 offen offset:2048 sc1
    buffer_load_dwordx4 v[44:47], v179, s[16:19], s80 offen offset:3072 sc1
    s_add_u32 s80, s86, 0x4000
    buffer_load_dwordx4 v[48:51], v179, s[16:19], s80 offen offset:0 sc1
    buffer_load_dwordx4 v[52:55], v179, s[16:19], s80 offen offset:1024 sc1
    buffer_load_dwordx4 v[56:59], v179, s[16:19], s80 offen offset:2048 sc1
    buffer_load_dwordx4 v[60:63], v179, s[16:19], s80 offen offset:3072 sc1
    s_add_u32 s80, s86, 0x8000
    buffer_load_dwordx4 v[64:67], v179, s[16:19], s80 offen offset:0 sc1
    buffer_load_dwordx4 v[68:71], v179, s[16:19], s80 offen offset:1024 sc1
    buffer_load_dwordx4 v[72:75], v179, s[16:19], s80 offen offset:2048 sc1
    buffer_load_dwordx4 v[76:79], v179, s[16:19], s80 offen offset:3072 sc1
k_tlate_done:
    v_accvgpr_read_b32 v240, a16
    v_accvgpr_read_b32 v241, a17
    v_accvgpr_read_b32 v242, a18
    v_accvgpr_read_b32 v243, a19
    v_mul_f32 v16, v236, v16
    v_mul_f32 v17, v236, v17
    v_mul_f32 v18, v236, v18
    v_mul_f32 v19, v236, v19
    v_fmac_f32 v16, v232, v240
    v_fmac_f32 v17, v232, v241
    v_fmac_f32 v18, v232, v242
    v_fmac_f32 v19, v232, v243
    v_accvgpr_read_b32 v244, a20
    v_accvgpr_read_b32 v245, a21
    v_accvgpr_read_b32 v246, a22
    v_accvgpr_read_b32 v247, a23
    v_mul_f32 v20, v237, v20
    v_mul_f32 v21, v237, v21
    v_mul_f32 v22, v237, v22
    v_mul_f32 v23, v237, v23
    v_fmac_f32 v20, v233, v244
    v_fmac_f32 v21, v233, v245
    v_fmac_f32 v22, v233, v246
    v_fmac_f32 v23, v233, v247
    v_accvgpr_read_b32 v240, a24
    v_accvgpr_read_b32 v241, a25
    v_accvgpr_read_b32 v242, a26
    v_accvgpr_read_b32 v243, a27
    v_mul_f32 v24, v238, v24
    v_mul_f32 v25, v238, v25
    v_mul_f32 v26, v238, v26
    v_mul_f32 v27, v238, v27
    v_fmac_f32 v24, v234, v240
    v_fmac_f32 v25, v234, v241
    v_fmac_f32 v26, v234, v242
    v_fmac_f32 v27, v234, v243
    v_accvgpr_read_b32 v244, a28
    v_accvgpr_read_b32 v245, a29
    v_accvgpr_read_b32 v246, a30
    v_accvgpr_read_b32 v247, a31
    v_mul_f32 v28, v239, v28
    v_mul_f32 v29, v239, v29
    v_mul_f32 v30, v239, v30
    v_mul_f32 v31, v239, v31
    v_fmac_f32 v28, v235, v244
    v_fmac_f32 v29, v235, v245
    v_fmac_f32 v30, v235, v246
    v_fmac_f32 v31, v235, v247
    s_waitcnt vmcnt(3)
    v_lshlrev_b32 v228, 16, v32
    v_and_b32 v229, 0xffff0000, v32
    v_lshlrev_b32 v230, 16, v33
    v_and_b32 v231, 0xffff0000, v33
    v_add_f32 v0, v0, v228
    v_add_f32 v1, v1, v229
    v_add_f32 v2, v2, v230
    v_add_f32 v3, v3, v231
    v_lshlrev_b32 v228, 16, v48
    v_and_b32 v229, 0xffff0000, v48
    v_lshlrev_b32 v230, 16, v49
    v_and_b32 v231, 0xffff0000, v49
    v_add_f32 v0, v0, v228
    v_add_f32 v1, v1, v229
    v_add_f32 v2, v2, v230
    v_add_f32 v3, v3, v231
    v_lshlrev_b32 v228, 16, v64
    v_and_b32 v229, 0xffff0000, v64
    v_lshlrev_b32 v230, 16, v65
    v_and_b32 v231, 0xffff0000, v65
    v_add_f32 v0, v0, v228
    v_add_f32 v1, v1, v229
    v_add_f32 v2, v2, v230
    v_add_f32 v3, v3, v231
    buffer_store_dwordx4 v[0:3], v180, s[96:99], 0 offen offset:0
    v_lshlrev_b32 v228, 16, v34
    v_and_b32 v229, 0xffff0000, v34
    v_lshlrev_b32 v230, 16, v35
    v_and_b32 v231, 0xffff0000, v35
    v_add_f32 v4, v4, v228
    v_add_f32 v5, v5, v229
    v_add_f32 v6, v6, v230
    v_add_f32 v7, v7, v231
    v_lshlrev_b32 v228, 16, v50
    v_and_b32 v229, 0xffff0000, v50
    v_lshlrev_b32 v230, 16, v51
    v_and_b32 v231, 0xffff0000, v51
    v_add_f32 v4, v4, v228
    v_add_f32 v5, v5, v229
    v_add_f32 v6, v6, v230
    v_add_f32 v7, v7, v231
    v_lshlrev_b32 v228, 16, v66
    v_and_b32 v229, 0xffff0000, v66
    v_lshlrev_b32 v230, 16, v67
    v_and_b32 v231, 0xffff0000, v67
    v_add_f32 v4, v4, v228
    v_add_f32 v5, v5, v229
    v_add_f32 v6, v6, v230
    v_add_f32 v7, v7, v231
    buffer_store_dwordx4 v[4:7], v181, s[96:99], 0 offen offset:0
    s_waitcnt vmcnt(4)
    v_lshlrev_b32 v228, 16, v36
    v_and_b32 v229, 0xffff0000, v36
    v_lshlrev_b32 v230, 16, v37
    v_and_b32 v231, 0xffff0000, v37
    v_add_f32 v8, v8, v228
    v_add_f32 v9, v9, v229
    v_add_f32 v10, v10, v230
    v_add_f32 v11, v11, v231
    v_lshlrev_b32 v228, 16, v52
    v_and_b32 v229, 0xffff0000, v52
    v_lshlrev_b32 v230, 16, v53
    v_and_b32 v231, 0xffff0000, v53
    v_add_f32 v8, v8, v228
    v_add_f32 v9, v9, v229
    v_add_f32 v10, v10, v230
    v_add_f32 v11, v11, v231
    v_lshlrev_b32 v228, 16, v68
    v_and_b32 v229, 0xffff0000, v68
    v_lshlrev_b32 v230, 16, v69
    v_and_b32 v231, 0xffff0000, v69
    v_add_f32 v8, v8, v228
    v_add_f32 v9, v9, v229
    v_add_f32 v10, v10, v230
    v_add_f32 v11, v11, v231
    buffer_store_dwordx4 v[8:11], v182, s[96:99], 0 offen offset:0
    v_lshlrev_b32 v228, 16, v38
    v_and_b32 v229, 0xffff0000, v38
    v_lshlrev_b32 v230, 16, v39
    v_and_b32 v231, 0xffff0000, v39
    v_add_f32 v12, v12, v228
    v_add_f32 v13, v13, v229
    v_add_f32 v14, v14, v230
    v_add_f32 v15, v15, v231
    v_lshlrev_b32 v228, 16, v54
    v_and_b32 v229, 0xffff0000, v54
    v_lshlrev_b32 v230, 16, v55
    v_and_b32 v231, 0xffff0000, v55
    v_add_f32 v12, v12, v228
    v_add_f32 v13, v13, v229
    v_add_f32 v14, v14, v230
    v_add_f32 v15, v15, v231
    v_lshlrev_b32 v228, 16, v70
    v_and_b32 v229, 0xffff0000, v70
    v_lshlrev_b32 v230, 16, v71
    v_and_b32 v231, 0xffff0000, v71
    v_add_f32 v12, v12, v228
    v_add_f32 v13, v13, v229
    v_add_f32 v14, v14, v230
    v_add_f32 v15, v15, v231
    buffer_store_dwordx4 v[12:15], v183, s[96:99], 0 offen offset:0
    s_waitcnt vmcnt(5)
    v_lshlrev_b32 v228, 16, v40
    v_and_b32 v229, 0xffff0000, v40
    v_lshlrev_b32 v230, 16, v41
    v_and_b32 v231, 0xffff0000, v41
    v_add_f32 v16, v16, v228
    v_add_f32 v17, v17, v229
    v_add_f32 v18, v18, v230
    v_add_f32 v19, v19, v231
    v_lshlrev_b32 v228, 16, v56
    v_and_b32 v229, 0xffff0000, v56
    v_lshlrev_b32 v230, 16, v57
    v_and_b32 v231, 0xffff0000, v57
    v_add_f32 v16, v16, v228
    v_add_f32 v17, v17, v229
    v_add_f32 v18, v18, v230
    v_add_f32 v19, v19, v231
    v_lshlrev_b32 v228, 16, v72
    v_and_b32 v229, 0xffff0000, v72
    v_lshlrev_b32 v230, 16, v73
    v_and_b32 v231, 0xffff0000, v73
    v_add_f32 v16, v16, v228
    v_add_f32 v17, v17, v229
    v_add_f32 v18, v18, v230
    v_add_f32 v19, v19, v231
    buffer_store_dwordx4 v[16:19], v180, s[96:99], 0 offen offset:64
    v_lshlrev_b32 v228, 16, v42
    v_and_b32 v229, 0xffff0000, v42
    v_lshlrev_b32 v230, 16, v43
    v_and_b32 v231, 0xffff0000, v43
    v_add_f32 v20, v20, v228
    v_add_f32 v21, v21, v229
    v_add_f32 v22, v22, v230
    v_add_f32 v23, v23, v231
    v_lshlrev_b32 v228, 16, v58
    v_and_b32 v229, 0xffff0000, v58
    v_lshlrev_b32 v230, 16, v59
    v_and_b32 v231, 0xffff0000, v59
    v_add_f32 v20, v20, v228
    v_add_f32 v21, v21, v229
    v_add_f32 v22, v22, v230
    v_add_f32 v23, v23, v231
    v_lshlrev_b32 v228, 16, v74
    v_and_b32 v229, 0xffff0000, v74
    v_lshlrev_b32 v230, 16, v75
    v_and_b32 v231, 0xffff0000, v75
    v_add_f32 v20, v20, v228
    v_add_f32 v21, v21, v229
    v_add_f32 v22, v22, v230
    v_add_f32 v23, v23, v231
    buffer_store_dwordx4 v[20:23], v181, s[96:99], 0 offen offset:64
    s_waitcnt vmcnt(6)
    v_lshlrev_b32 v228, 16, v44
    v_and_b32 v229, 0xffff0000, v44
    v_lshlrev_b32 v230, 16, v45
    v_and_b32 v231, 0xffff0000, v45
    v_add_f32 v24, v24, v228
    v_add_f32 v25, v25, v229
    v_add_f32 v26, v26, v230
    v_add_f32 v27, v27, v231
    v_lshlrev_b32 v228, 16, v60
    v_and_b32 v229, 0xffff0000, v60
    v_lshlrev_b32 v230, 16, v61
    v_and_b32 v231, 0xffff0000, v61
    v_add_f32 v24, v24, v228
    v_add_f32 v25, v25, v229
    v_add_f32 v26, v26, v230
    v_add_f32 v27, v27, v231
    v_lshlrev_b32 v228, 16, v76
    v_and_b32 v229, 0xffff0000, v76
    v_lshlrev_b32 v230, 16, v77
    v_and_b32 v231, 0xffff0000, v77
    v_add_f32 v24, v24, v228
    v_add_f32 v25, v25, v229
    v_add_f32 v26, v26, v230
    v_add_f32 v27, v27, v231
    buffer_store_dwordx4 v[24:27], v182, s[96:99], 0 offen offset:64
    v_lshlrev_b32 v228, 16, v46
    v_and_b32 v229, 0xffff0000, v46
    v_lshlrev_b32 v230, 16, v47
    v_and_b32 v231, 0xffff0000, v47
    v_add_f32 v28, v28, v228
    v_add_f32 v29, v29, v229
    v_add_f32 v30, v30, v230
    v_add_f32 v31, v31, v231
    v_lshlrev_b32 v228, 16, v62
    v_and_b32 v229, 0xffff0000, v62
    v_lshlrev_b32 v230, 16, v63
    v_and_b32 v231, 0xffff0000, v63
    v_add_f32 v28, v28, v228
    v_add_f32 v29, v29, v229
    v_add_f32 v30, v30, v230
    v_add_f32 v31, v31, v231
    v_lshlrev_b32 v228, 16, v78
    v_and_b32 v229, 0xffff0000, v78
    v_lshlrev_b32 v230, 16, v79
    v_and_b32 v231, 0xffff0000, v79
    v_add_f32 v28, v28, v228
    v_add_f32 v29, v29, v229
    v_add_f32 v30, v30, v230
    v_add_f32 v31, v31, v231
    buffer_store_dwordx4 v[28:31], v183, s[96:99], 0 offen offset:64
k_done:
    s_endpgm
chk_1_slow:
    s_mov_b32 s79, 0x200000
chk_1_loop:
    s_sleep 1
    buffer_load_dword v166, v167, s[20:23], s84 offen offset:0 sc1
    s_waitcnt vmcnt(0)
    v_cmp_lt_u32 vcc, s85, v166
    s_cmp_eq_u64 vcc, -1
    s_cbranch_scc1 chk_1_ok
    s_sub_u32 s79, s79, 1
    s_cmp_lg_u32 s79, 0
    s_cbranch_scc1 chk_1_loop
    s_branch chk_1_ok
chk_2_slow:
    s_mov_b32 s79, 0x200000
chk_2_loop:
    s_sleep 1
    buffer_load_dword v153, v254, s[16:19], s78 offen offset:0 sc1
    s_waitcnt vmcnt(0)
    v_cmp_eq_u32 vcc, 1, v153
    s_cmp_eq_u64 vcc, -1
    s_cbranch_scc1 chk_2_ok
    s_sub_u32 s79, s79, 1
    s_cmp_lg_u32 s79, 0
    s_cbranch_scc1 chk_2_loop
    s_branch chk_2_ok
lbc_slow:
    s_mov_b32 s79, 0x200000
lbc_loop:
    s_sleep 1
    v_add_u32 v64, 0x0, v92
    buffer_load_dwordx4 v[64:67], v64, s[92:95], 0 offen sc1
    v_add_u32 v68, 0x100, v92
    buffer_load_dwordx4 v[68:71], v68, s[92:95], 0 offen sc1
    v_add_u32 v72, 0x200, v92
    buffer_load_dwordx4 v[72:75], v72, s[92:95], 0 offen sc1
    v_add_u32 v76, 0x300, v92
    buffer_load_dwordx4 v[76:79], v76, s[92:95], 0 offen sc1
    v_add_u32 v80, 0x400, v92
    buffer_load_dwordx4 v[80:83], v80, s[92:95], 0 offen sc1
    v_add_u32 v84, 0x500, v92
    buffer_load_dwordx4 v[84:87], v84, s[92:95], 0 offen sc1
    v_add_u32 v88, 0x600, v92
    buffer_load_dwordx4 v[88:91], v88, s[92:95], 0 offen sc1
    s_waitcnt vmcnt(0)
    v_max3_u32 v93, v64, v65, v66
    v_max3_u32 v94, v67, v68, v69
    v_max3_u32 v93, v93, v70, v71
    v_max3_u32 v94, v94, v72, v73
    v_max3_u32 v93, v93, v74, v75
    v_max3_u32 v94, v94, v76, v77
    v_max3_u32 v93, v93, v78, v79
    v_max3_u32 v94, v94, v80, v81
    v_max3_u32 v93, v93, v82, v83
    v_max3_u32 v94, v94, v84, v85
    v_max3_u32 v93, v93, v86, v87
    v_max3_u32 v94, v94, v88, v89
    v_max3_u32 v93, v93, v90, v91
    v_max_u32 v93, v93, v94
    v_cmp_eq_u32 vcc, -1, v93
    s_cmp_eq_u64 vcc, 0
    s_cbranch_scc1 lbc_ok
    s_sub_u32 s79, s79, 1
    s_cmp_lg_u32 s79, 0
    s_cbranch_scc1 lbc_loop
    s_branch lbc_ok
chk_3_slow:
    s_mov_b32 s79, 0x200000
chk_3_loop:
    s_sleep 1
    buffer_load_dword v230, v231, s[16:19], s82 offen offset:512 sc1
    s_waitcnt vmcnt(0)
    v_cmp_eq_u32 vcc, 1, v230
    s_cmp_eq_u64 vcc, -1
    s_cbranch_scc1 chk_3_ok
    s_sub_u32 s79, s79, 1
    s_cmp_lg_u32 s79, 0
    s_cbranch_scc1 chk_3_loop
    s_branch chk_3_ok
chk_4_slow:
    s_mov_b32 s79, 0x200000
chk_4_loop:
    s_sleep 1
    buffer_load_dword v174, v254, s[16:19], s78 offen offset:128 sc1
    s_waitcnt vmcnt(0)
    v_cmp_eq_u32 vcc, 1, v174
    s_cmp_eq_u64 vcc, -1
    s_cbranch_scc1 chk_4_ok
    s_sub_u32 s79, s79, 1
    s_cmp_lg_u32 s79, 0
    s_cbranch_scc1 chk_4_loop
    s_branch chk_4_ok
chk_5_slow:
    s_mov_b32 s79, 0x200000
chk_5_loop:
    s_sleep 1
    buffer_load_dword v174, v254, s[16:19], s78 offen offset:256 sc1
    s_waitcnt vmcnt(0)
    v_cmp_eq_u32 vcc, 1, v174
    s_cmp_eq_u64 vcc, -1
    s_cbranch_scc1 chk_5_ok
    s_sub_u32 s79, s79, 1
    s_cmp_lg_u32 s79, 0
    s_cbranch_scc1 chk_5_loop
    s_branch chk_5_ok
chk_6_slow:
    s_mov_b32 s79, 0x200000
chk_6_loop:
    s_sleep 1
    buffer_load_dword v174, v254, s[16:19], s78 offen offset:384 sc1
    s_waitcnt vmcnt(0)
    v_cmp_eq_u32 vcc, 1, v174
    s_cmp_eq_u64 vcc, -1
    s_cbranch_scc1 chk_6_ok
    s_sub_u32 s79, s79, 1
    s_cmp_lg_u32 s79, 0
    s_cbranch_scc1 chk_6_loop
    s_branch chk_6_ok
chk_7_slow:
    s_mov_b32 s79, 0x200000
chk_7_loop:
    s_sleep 1
    buffer_load_dword v174, v254, s[16:19], s78 offen offset:512 sc1
    s_waitcnt vmcnt(0)
    v_cmp_eq_u32 vcc, 1, v174
    s_cmp_eq_u64 vcc, -1
    s_cbranch_scc1 chk_7_ok
    s_sub_u32 s79, s79, 1
    s_cmp_lg_u32 s79, 0
    s_cbranch_scc1 chk_7_loop
    s_branch chk_7_ok
chk_8_slow:
    s_mov_b32 s79, 0x200000
chk_8_loop:
    s_sleep 1
    buffer_load_dword v174, v175, s[16:19], s87 offen offset:0 sc1
    s_waitcnt vmcnt(0)
    v_cmp_eq_u32 vcc, 1, v174
    s_and_b32 s89, vcc_lo, s81
    s_cmp_eq_u32 s89, s81
    s_cbranch_scc1 chk_8_ok
    s_sub_u32 s79, s79, 1
    s_cmp_lg_u32 s79, 0
    s_cbranch_scc1 chk_8_loop
    s_branch chk_8_ok
k_end:
.section .rodata,"a"
.p2align 6
.amdhsa_kernel gated_mix__ssm_conv_s5__glu_gated_reglu__prompt_kernel
  .amdhsa_next_free_vgpr 512
  .amdhsa_next_free_sgpr 102
  .amdhsa_accum_offset 256
  .amdhsa_group_segment_fixed_size 0
  .amdhsa_kernarg_size 136
  .amdhsa_user_sgpr_count 2
  .amdhsa_user_sgpr_kernarg_segment_ptr 1
  .amdhsa_system_sgpr_workgroup_id_x 1
.end_amdhsa_kernel
```
